```python
import torch

def _softmax(x, axis=-1):
    return torch.softmax(x, dim=axis)

def _gelu(x):
    return torch.nn.functional.gelu(x, approximate='tanh')

def _silu(x):
    return torch.nn.functional.silu(x)

def _sigmoid(x):
    return torch.sigmoid(x)

def _layernorm(x, axis=-1, eps=1e-05):
    m = x.mean(dim=axis, keepdim=True)
    v = x.var(dim=axis, keepdim=True, unbiased=False)
    return (x - m) / torch.sqrt(v + eps)

def _scatter_add(tgt, idx, src, axis=0):
    return tgt.clone().index_add_(axis, idx, src)

def _segment_sum(src, seg, n):
    out = torch.zeros((n,) + src.shape[1:], dtype=src.dtype)
    return out.index_add_(0, seg, src)

def _pad(x, pw):
    flat = tuple((v for pair in reversed(pw) for v in pair))
    return torch.nn.functional.pad(x, flat)
kernel_name = 'adaLN_cond__memory_aug_recurrent_mem_tr__glu_gated_swiglu__prompt'

def setup_inputs():

    _w = lambda a: (lambda t: t.to(torch.bfloat16) if t.is_floating_point() else t)(torch.as_tensor(a))

    def _A_setup():
        B, S, Dm = (1, 2048, 512)
        H, Dh = (32, 128)
        M, seg = (8, 32)
        seg = min(seg, S)
        S = S // seg * seg
        return {'x': _w((lambda *s: torch.randn(*s, dtype=torch.bfloat16) * 0.05)(B, S, Dm)), 'mem0': _w((lambda *s: torch.randn(*s, dtype=torch.bfloat16) * 0.8)(B, M, Dm)), 'Wq': _w((lambda *s: torch.randn(*s, dtype=torch.bfloat16) * 0.8)(Dm, H, Dh) * Dm ** (-0.5)), 'Wk': _w((lambda *s: torch.randn(*s, dtype=torch.bfloat16) * 0.8)(Dm, H, Dh) * Dm ** (-0.5)), 'Wv': _w((lambda *s: torch.randn(*s, dtype=torch.bfloat16) * 0.8)(Dm, H, Dh) * Dm ** (-0.5)), 'Wo': _w((lambda *s: torch.randn(*s, dtype=torch.bfloat16) * 0.8)(H, Dh, Dm) * (H * Dh) ** (-0.5)), 'seg_len': seg}
    _A_in = _A_setup()

    def _B_setup():
        B, S, D, F = (1, 2048, 512, 1376)
        return {'x': _w((lambda *s: torch.randn(*s, dtype=torch.bfloat16) * 0.05)(B, S, D)), 'w1': _w((lambda *s: torch.randn(*s, dtype=torch.bfloat16) * 0.4)(D, F) * (2.0 / D) ** 0.5), 'w3': _w((lambda *s: torch.randn(*s, dtype=torch.bfloat16) * 0.4)(D, F) * (2.0 / D) ** 0.5), 'w2': _w((lambda *s: torch.randn(*s, dtype=torch.bfloat16) * 0.4)(F, D) * (2.0 / F) ** 0.5)}
    _B_in = _B_setup()
    return {'A_x': _A_in['x'], 'A_mem0': _A_in['mem0'], 'A_Wq': _A_in['Wq'], 'A_Wk': _A_in['Wk'], 'A_Wv': _A_in['Wv'], 'A_Wo': _A_in['Wo'], 'A_seg_len': _A_in['seg_len'], 'B_x': _B_in['x'], 'B_w1': _B_in['w1'], 'B_w3': _B_in['w3'], 'B_w2': _B_in['w2'], 'c': _w((lambda *s: torch.randn(*s, dtype=torch.bfloat16) * 0.1)(1, 512) * 8.0), 'w_mod': _w((lambda *s: torch.randn(*s, dtype=torch.bfloat16) * 0.1)(512, 6 * 512) * 512 ** (-0.5) * 8.0)}

def reference(A_x, A_mem0, A_Wq, A_Wk, A_Wv, A_Wo, A_seg_len, B_x, B_w1, B_w3, B_w2, c, w_mod):

    def _A_ref(x, mem0, Wq, Wk, Wv, Wo, seg_len):
        B, S, Dm = x.shape
        H, Dh = (Wq.shape[1], Wq.shape[2])
        M = mem0.shape[1]
        scale = Dh ** (-0.5)
        n_seg = S // seg_len
        L = M + seg_len
        idx = torch.arange(L)
        mask = (idx[:, None] < M) | (idx[:, None] >= idx[None, :])
        mem = mem0
        outs = []
        for s in range(n_seg):
            xs = x[:, s * seg_len:(s + 1) * seg_len, :].clone()
            h = torch.concatenate([mem, xs], axis=1)
            q = torch.einsum('btd,dhe->bhte', h, Wq)
            k = torch.einsum('btd,dhe->bhte', h, Wk)
            v = torch.einsum('btd,dhe->bhte', h, Wv)
            scores = torch.einsum('bhqe,bhke->bhqk', q, k) * scale
            scores = torch.where(mask[None, None], scores, -1000000000.0)
            p = _softmax(scores, axis=-1)
            o = torch.einsum('bhqk,bhke->bhqe', p, v)
            o = torch.einsum('bhte,hed->btd', o, Wo)
            mem = o[:, :M, :].clone()
            outs.append(o[:, M:, :])
        return torch.concatenate(outs, axis=1)

    def _B_ref(x, w1, w3, w2):
        gate = torch.einsum('bsd,df->bsf', x, w1)
        up = torch.einsum('bsd,df->bsf', x, w3)
        h = _silu(gate) * up
        out = torch.einsum('bsf,fd->bsd', h, w2)
        return out
    x = A_x
    mod = (_silu(c) @ w_mod).reshape(c.shape[0], 6, 1, -1)
    sa, ca, ga, sb, cb, gb = (mod[:, 0].clone(), mod[:, 1].clone(), mod[:, 2].clone(), mod[:, 3].clone(), mod[:, 4].clone(), mod[:, 5].clone())
    h = _layernorm(x, axis=-1) * (1 + ca) + sa
    x = x + ga * _A_ref(h, A_mem0, A_Wq, A_Wk, A_Wv, A_Wo, A_seg_len)
    h = _layernorm(x, axis=-1) * (1 + cb) + sb
    x = x + gb * _B_ref(h, B_w1, B_w3, B_w2)
    return x
```

```asm
; @launch grid=(256,1,1) block=(256,1,1) lds=163840
.amdgcn_target "amdgcn-amd-amdhsa--gfx950"
.text
.globl adaLN_cond__memory_aug_recurrent_mem_tr__glu_gated_swiglu__prompt_kernel
.p2align 8
.type adaLN_cond__memory_aug_recurrent_mem_tr__glu_gated_swiglu__prompt_kernel,@function
adaLN_cond__memory_aug_recurrent_mem_tr__glu_gated_swiglu__prompt_kernel:
    s_cmp_lt_u32 s2, 256
    s_cbranch_scc0 L_end
    s_load_dwordx4 s[92:95], s[0:1], 112
    s_load_dwordx16 s[60:75], s[0:1], 0
    s_load_dwordx16 s[76:91], s[0:1], 64
    s_cmp_lt_u32 s2, 32
    s_cbranch_scc0 L_nopf
    s_getpc_b64 s[8:9]
L_pc:
    s_mov_b32 s10, L_codeend-L_pc
    s_mov_b32 s11, 0x00020000
    s_mov_b32 s3, 0x8000
    v_lshlrev_b32 v2, 7, v0
    buffer_load_dword v255, v2, s[8:11], 0 offen
    buffer_load_dword v254, v2, s[8:11], s3 offen
L_nopf:
    v_lshrrev_b32 v1, 6, v0
    s_nop 0
    v_readfirstlane_b32 s13, v1
    s_add_u32 s3, s2, 7
    s_and_b32 s3, s3, 7
    s_lshr_b32 s14, s2, 3
    s_waitcnt lgkmcnt(0)
    s_mov_b32 s4, s94
    s_mov_b32 s5, s95
    s_mov_b32 s6, 0x10000000
    s_mov_b32 s7, 0x00020000
    s_cmp_eq_u32 s3, 0
    s_cbranch_scc0 L_roles
    s_getreg_b32 s15, hwreg(HW_REG_XCC_ID, 0, 4)
    s_mov_b32 s44, s64
    s_mov_b32 s45, s65
    s_mov_b32 s46, 0x400000
    s_mov_b32 s47, 0x00020000
    s_mov_b32 s48, s66
    s_mov_b32 s49, s67
    s_mov_b32 s50, 0x400000
    s_mov_b32 s51, 0x00020000
    s_mov_b32 s52, s68
    s_mov_b32 s53, s69
    s_mov_b32 s54, 0x400000
    s_mov_b32 s55, 0x00020000
    s_mov_b32 s56, s70
    s_mov_b32 s57, s71
    s_mov_b32 s58, 0x400000
    s_mov_b32 s59, 0x00020000
    s_mov_b32 s60, s62
    s_mov_b32 s61, s63
    s_mov_b32 s62, 0x2000
    s_mov_b32 s63, 0x00020000
    v_and_b32 v19, 63, v0
    v_lshlrev_b32 v11, 4, v19
    s_and_b32 s43, s14, 2
    s_xor_b32 s36, s13, s43
    s_and_b32 s37, s14, 1
    s_and_b32 s15, s15, 7
    s_mul_i32 s15, s15, 6
    s_lshl_b64 s[90:91], 1, s15
    s_lshl_b32 s43, s14, 8
    s_add_u32 s15, s43, 1572864
    v_lshrrev_b32 v19, 4, v11
    v_bfe_u32 v20, v19, 4, 1
    v_lshlrev_b32 v18, 14, v20
    v_bfe_u32 v20, v19, 5, 1
    v_lshl_add_u32 v18, v20, 12, v18
    v_and_b32 v20, 15, v19
    v_lshl_add_u32 v18, v20, 4, v18
    s_lshl_b32 s69, s14, 17
    s_lshl_b32 s43, s13, 8
    s_add_u32 s69, s69, s43
    s_xor_b32 s43, s13, 0
    s_lshl_b32 s43, s43, 15
    s_add_u32 s43, s43, s69
    buffer_load_dwordx4 v[64:67], v18, s[56:59], s43 offen offset:0 nt
    buffer_load_dwordx4 v[68:71], v18, s[56:59], s43 offen offset:1024 nt
    buffer_load_dwordx4 v[72:75], v18, s[56:59], s43 offen offset:2048 nt
    buffer_load_dwordx4 v[76:79], v18, s[56:59], s43 offen offset:3072 nt
    s_add_u32 s43, s43, 8192
    buffer_load_dwordx4 v[80:83], v18, s[56:59], s43 offen offset:0 nt
    buffer_load_dwordx4 v[84:87], v18, s[56:59], s43 offen offset:1024 nt
    buffer_load_dwordx4 v[88:91], v18, s[56:59], s43 offen offset:2048 nt
    buffer_load_dwordx4 v[92:95], v18, s[56:59], s43 offen offset:3072 nt
    s_xor_b32 s43, s13, 1
    s_lshl_b32 s43, s43, 15
    s_add_u32 s43, s43, s69
    buffer_load_dwordx4 v[96:99], v18, s[56:59], s43 offen offset:0 nt
    buffer_load_dwordx4 v[100:103], v18, s[56:59], s43 offen offset:1024 nt
    buffer_load_dwordx4 v[104:107], v18, s[56:59], s43 offen offset:2048 nt
    buffer_load_dwordx4 v[108:111], v18, s[56:59], s43 offen offset:3072 nt
    s_add_u32 s43, s43, 8192
    buffer_load_dwordx4 v[112:115], v18, s[56:59], s43 offen offset:0 nt
    buffer_load_dwordx4 v[116:119], v18, s[56:59], s43 offen offset:1024 nt
    buffer_load_dwordx4 v[120:123], v18, s[56:59], s43 offen offset:2048 nt
    buffer_load_dwordx4 v[124:127], v18, s[56:59], s43 offen offset:3072 nt
    s_xor_b32 s43, s13, 2
    s_lshl_b32 s43, s43, 15
    s_add_u32 s43, s43, s69
    buffer_load_dwordx4 v[128:131], v18, s[56:59], s43 offen offset:0 nt
    buffer_load_dwordx4 v[132:135], v18, s[56:59], s43 offen offset:1024 nt
    buffer_load_dwordx4 v[136:139], v18, s[56:59], s43 offen offset:2048 nt
    buffer_load_dwordx4 v[140:143], v18, s[56:59], s43 offen offset:3072 nt
    s_add_u32 s43, s43, 8192
    buffer_load_dwordx4 v[144:147], v18, s[56:59], s43 offen offset:0 nt
    buffer_load_dwordx4 v[148:151], v18, s[56:59], s43 offen offset:1024 nt
    buffer_load_dwordx4 v[152:155], v18, s[56:59], s43 offen offset:2048 nt
    buffer_load_dwordx4 v[156:159], v18, s[56:59], s43 offen offset:3072 nt
    s_xor_b32 s43, s13, 3
    s_lshl_b32 s43, s43, 15
    s_add_u32 s43, s43, s69
    buffer_load_dwordx4 v[160:163], v18, s[56:59], s43 offen offset:0 nt
    buffer_load_dwordx4 v[164:167], v18, s[56:59], s43 offen offset:1024 nt
    buffer_load_dwordx4 v[168:171], v18, s[56:59], s43 offen offset:2048 nt
    buffer_load_dwordx4 v[172:175], v18, s[56:59], s43 offen offset:3072 nt
    s_add_u32 s43, s43, 8192
    buffer_load_dwordx4 v[176:179], v18, s[56:59], s43 offen offset:0 nt
    buffer_load_dwordx4 v[180:183], v18, s[56:59], s43 offen offset:1024 nt
    buffer_load_dwordx4 v[184:187], v18, s[56:59], s43 offen offset:2048 nt
    buffer_load_dwordx4 v[188:191], v18, s[56:59], s43 offen offset:3072 nt
    v_lshrrev_b32 v20, 3, v19
    v_lshlrev_b32 v16, 13, v20
    v_and_b32 v20, 7, v19
    v_lshl_add_u32 v16, v20, 4, v16
    v_and_b32 v20, 32, v19
    v_xor_b32 v16, v16, v20
    v_xor_b32 v17, 64, v16
    v_bfe_u32 v20, v19, 5, 1
    v_lshlrev_b32 v22, 11, v20
    v_bfe_u32 v20, v19, 3, 1
    v_mul_u32_u24 v20, 1088, v20
    v_add_u32 v22, v22, v20
    v_bfe_u32 v20, v19, 4, 1
    v_mul_u32_u24 v20, 544, v20
    v_add_u32 v22, v22, v20
    v_bfe_u32 v20, v19, 2, 1
    v_lshl_add_u32 v22, v20, 7, v22
    v_and_b32 v20, 3, v19
    v_lshl_add_u32 v22, v20, 3, v22
    s_and_b32 s43, s13, 1
    s_lshl_b32 s43, s43, 6
    v_xor_b32 v22, s43, v22
    s_lshl_b32 s43, s13, 12
    s_add_u32 s68, s43, 94208
    s_xor_b32 s43, s43, 4096
    s_add_u32 s43, s43, 94208
    v_xor_b32 v23, 32, v22
    v_add_u32 v24, s43, v22
    v_add_u32 v25, s43, v23
    v_add_u32 v23, s68, v23
    v_add_u32 v22, s68, v22
    s_lshl_b32 s74, s14, 8
    s_lshr_b32 s43, s13, 1
    s_lshl_b32 s43, s43, 7
    s_add_u32 s74, s74, s43
    s_xor_b32 s43, s36, 0
    s_lshl_b32 s43, s43, 19
    s_add_u32 s43, s43, s74
    s_xor_b32 s75, s37, 0
    s_lshl_b32 s75, s75, 21
    s_add_u32 s43, s43, s75
    s_add_u32 s75, s43, 0
    s_add_u32 m0, s68, 0
    s_nop 0
    buffer_load_dwordx4 v16, s[48:51], s75 offen nt lds
    s_add_u32 s75, s43, 65536
    s_add_u32 m0, s68, 1024
    s_nop 0
    buffer_load_dwordx4 v17, s[48:51], s75 offen nt lds
    s_add_u32 s75, s43, 131072
    s_add_u32 m0, s68, 2048
    s_nop 0
    buffer_load_dwordx4 v16, s[48:51], s75 offen nt lds
    s_add_u32 s75, s43, 196608
    s_add_u32 m0, s68, 3072
    s_nop 0
    buffer_load_dwordx4 v17, s[48:51], s75 offen nt lds
    s_xor_b32 s43, s36, 0
    s_lshl_b32 s43, s43, 19
    s_add_u32 s43, s43, s74
    s_xor_b32 s75, s37, 0
    s_lshl_b32 s75, s75, 21
    s_add_u32 s43, s43, s75
    s_add_u32 s75, s43, 262144
    s_add_u32 m0, s68, 16384
    s_nop 0
    buffer_load_dwordx4 v16, s[48:51], s75 offen nt lds
    s_add_u32 s75, s43, 327680
    s_add_u32 m0, s68, 17408
    s_nop 0
    buffer_load_dwordx4 v17, s[48:51], s75 offen nt lds
    s_add_u32 s75, s43, 393216
    s_add_u32 m0, s68, 18432
    s_nop 0
    buffer_load_dwordx4 v16, s[48:51], s75 offen nt lds
    s_add_u32 s75, s43, 458752
    s_add_u32 m0, s68, 19456
    s_nop 0
    buffer_load_dwordx4 v17, s[48:51], s75 offen nt lds
    s_xor_b32 s43, s36, 0
    s_lshl_b32 s43, s43, 19
    s_add_u32 s43, s43, s74
    s_xor_b32 s75, s37, 1
    s_lshl_b32 s75, s75, 21
    s_add_u32 s43, s43, s75
    s_add_u32 s75, s43, 0
    s_add_u32 m0, s68, 32768
    s_nop 0
    buffer_load_dwordx4 v16, s[48:51], s75 offen nt lds
    s_add_u32 s75, s43, 65536
    s_add_u32 m0, s68, 33792
    s_nop 0
    buffer_load_dwordx4 v17, s[48:51], s75 offen nt lds
    s_add_u32 s75, s43, 131072
    s_add_u32 m0, s68, 34816
    s_nop 0
    buffer_load_dwordx4 v16, s[48:51], s75 offen nt lds
    s_add_u32 s75, s43, 196608
    s_add_u32 m0, s68, 35840
    s_nop 0
    buffer_load_dwordx4 v17, s[48:51], s75 offen nt lds
    s_xor_b32 s43, s36, 0
    s_lshl_b32 s43, s43, 19
    s_add_u32 s43, s43, s74
    s_xor_b32 s75, s37, 1
    s_lshl_b32 s75, s75, 21
    s_add_u32 s43, s43, s75
    s_add_u32 s75, s43, 262144
    s_add_u32 m0, s68, 49152
    s_nop 0
    buffer_load_dwordx4 v16, s[48:51], s75 offen nt lds
    s_add_u32 s75, s43, 327680
    s_add_u32 m0, s68, 50176
    s_nop 0
    buffer_load_dwordx4 v17, s[48:51], s75 offen nt lds
    s_add_u32 s75, s43, 393216
    s_add_u32 m0, s68, 51200
    s_nop 0
    buffer_load_dwordx4 v16, s[48:51], s75 offen nt lds
    s_add_u32 s75, s43, 458752
    s_add_u32 m0, s68, 52224
    s_nop 0
    buffer_load_dwordx4 v17, s[48:51], s75 offen nt lds
    v_lshrrev_b32 v28, 4, v11
    s_lshl_b32 s43, s13, 10
    v_add_u32 v0, s43, v11
    v_add_u32 v1, 0x10000, v0
    v_lshrrev_b32 v26, 4, v28
    v_mul_u32_u24 v3, 576, v26
    v_and_b32 v26, 15, v28
    v_lshl_add_u32 v3, v26, 2, v3
    s_lshl_b32 s43, s13, 6
    v_add_u32 v3, s43, v3
    v_bfe_u32 v26, v28, 2, 2
    v_and_b32 v27, 1, v28
    v_lshl_add_u32 v26, v26, 1, v27
    v_mul_u32_u24 v4, 288, v26
    v_lshrrev_b32 v26, 4, v28
    v_lshl_add_u32 v4, v26, 4, v4
    v_bfe_u32 v26, v28, 1, 1
    s_mov_b32 s43, 0xaaaaaaaa
    v_mul_lo_u32 v26, v26, s43
    v_add_u32 v5, 0x44444444, v26
    v_bfe_u32 v26, v28, 2, 4
    v_lshlrev_b32 v6, 7, v26
    v_bfe_u32 v26, v28, 0, 2
    v_lshl_add_u32 v6, v26, 4, v6
    v_bfe_u32 v26, v28, 3, 3
    v_mul_u32_u24 v7, 8448, v26
    v_bfe_u32 v26, v28, 0, 3
    v_lshl_add_u32 v7, v26, 4, v7
    v_bfe_u32 v26, v28, 1, 1
    v_lshlrev_b32 v8, 8, v26
    v_bfe_u32 v26, v28, 0, 1
    v_lshl_add_u32 v8, v26, 5, v8
    v_bfe_u32 v26, v28, 4, 1
    v_lshl_add_u32 v8, v26, 4, v8
    v_bfe_u32 v26, v28, 2, 1
    v_lshl_add_u32 v8, v26, 3, v8
    v_bfe_u32 v26, v28, 5, 1
    v_lshl_add_u32 v8, v26, 2, v8
    v_and_b32 v26, 0x880, v0
    v_cmp_eq_u32 vcc, 0, v26
    v_mov_b32 v27, 0x7fff0000
    s_nop 0
    v_cndmask_b32 v8, v27, v8, vcc
    v_and_b32 v26, 36, v28
    v_cmp_eq_u32 vcc, 36, v26
    s_nop 1
    v_cndmask_b32 v2, 0, 1, vcc
    v_add_u32 v9, 0x20000, v0
    s_lshr_b32 s43, s14, 3
    s_lshl_b32 s43, s43, 4
    s_mov_b64 s[34:35], 0xffff
    s_lshl_b64 s[34:35], s[34:35], s43
    s_bfe_u32 s43, s14, 0x10002
    s_or_b32 s43, s43, 2
    s_cmp_eq_u32 s43, s13
    s_cselect_b64 s[34:35], s[34:35], 0
    v_and_b32 v26, 1, v28
    v_lshlrev_b32 v26, 4, v26
    v_mov_b32 v27, 0x3f80
    v_lshlrev_b32 v27, v26, v27
    v_and_b32 v26, 14, v28
    v_cmp_eq_u32 vcc, 0, v26
    s_nop 1
    v_cndmask_b32 v12, 0, v27, vcc
    v_cmp_eq_u32 vcc, 4, v26
    s_nop 1
    v_cndmask_b32 v13, 0, v27, vcc
    v_cmp_eq_u32 vcc, 8, v26
    s_nop 1
    v_cndmask_b32 v14, 0, v27, vcc
    v_cmp_eq_u32 vcc, 12, v26
    s_nop 1
    v_cndmask_b32 v15, 0, v27, vcc
    s_mov_b32 s30, 0x3e0293ee
    s_mov_b32 s31, 0x3e0293ee
    s_mov_b32 s32, 0x3f803f80
    s_mov_b32 s33, 0x3f803f80
    s_mov_b32 s66, 0x05040100
    s_mov_b32 s67, 0x07060302
    s_mul_i32 s16, s14, 8448
    s_lshl_b32 s43, s13, 11
    s_add_u32 s16, s16, s43
    s_and_b32 s43, s13, 1
    s_lshl_b32 s64, s14, 1
    s_add_u32 s64, s64, s43
    s_lshl_b32 s8, s64, 7
    s_add_u32 s9, s8, 67584
    s_add_u32 s10, s8, 135168
    s_add_u32 s11, s8, 202752
    s_lshr_b32 s43, s64, 4
    s_lshl_b32 s19, s43, 11
    s_and_b32 s43, s64, 3
    s_lshl_b32 s43, s43, 9
    s_add_u32 s19, s19, s43
    s_bfe_u32 s43, s64, 0x20002
    s_lshl_b32 s43, s43, 6
    s_add_u32 s19, s19, s43
    s_add_u32 s19, s19, 1048576
    s_sub_u32 s43, s36, s13
    s_lshl_b32 s43, s43, 10
    s_lshl_b32 s64, s37, 12
    s_add_u32 s28, s43, s64
    s_add_u32 s20, s28, 1048576
    s_add_u32 s28, s28, 58982400
    s_lshl_b32 s40, s14, 12
    s_add_u32 s40, s40, 58851328
    s_xor_b32 s64, s64, 4096
    s_add_u32 s21, s43, s64
    s_add_u32 s21, s21, 1048576
    s_lshl_b32 s43, s13, 10
    s_add_u32 s22, s43, 8192
    s_mov_b32 s18, -1
    s_lshl_b32 s23, s14, 14
    s_add_u32 s23, s23, 16777216
    s_mov_b32 s12, 0
    v_mov_b32 v28, -1
    v_mov_b32 v29, -1
    v_mov_b32 v30, -1
    v_mov_b32 v31, -1
    buffer_store_dwordx4 v[28:31], v6, s[4:7], s16 offen offset:0 sc1
    buffer_store_dwordx4 v[28:31], v6, s[4:7], s16 offen offset:64 sc1
    buffer_store_dword v28, v8, s[4:7], s19 offen sc1
    s_waitcnt vmcnt(43)
    v_perm_b32 v200, v68, v64, s66
    v_perm_b32 v201, v68, v64, s67
    v_perm_b32 v202, v76, v72, s66
    v_perm_b32 v203, v76, v72, s67
    v_perm_b32 v204, v84, v80, s66
    v_perm_b32 v205, v84, v80, s67
    v_perm_b32 v206, v92, v88, s66
    v_perm_b32 v207, v92, v88, s67
    v_perm_b32 v208, v69, v65, s66
    v_perm_b32 v209, v69, v65, s67
    v_perm_b32 v210, v77, v73, s66
    v_perm_b32 v211, v77, v73, s67
    v_perm_b32 v212, v85, v81, s66
    v_perm_b32 v213, v85, v81, s67
    v_perm_b32 v214, v93, v89, s66
    v_perm_b32 v215, v93, v89, s67
    v_perm_b32 v216, v70, v66, s66
    v_perm_b32 v217, v70, v66, s67
    v_perm_b32 v218, v78, v74, s66
    v_perm_b32 v219, v78, v74, s67
    v_perm_b32 v220, v86, v82, s66
    v_perm_b32 v221, v86, v82, s67
    v_perm_b32 v222, v94, v90, s66
    v_perm_b32 v223, v94, v90, s67
    v_perm_b32 v224, v71, v67, s66
    v_perm_b32 v225, v71, v67, s67
    v_perm_b32 v226, v79, v75, s66
    v_perm_b32 v227, v79, v75, s67
    v_perm_b32 v228, v87, v83, s66
    v_perm_b32 v229, v87, v83, s67
    v_perm_b32 v230, v95, v91, s66
    v_perm_b32 v231, v95, v91, s67
    s_waitcnt lgkmcnt(0)
    s_waitcnt vmcnt(35)
    v_perm_b32 v232, v100, v96, s66
    v_perm_b32 v233, v100, v96, s67
    v_perm_b32 v234, v108, v104, s66
    v_perm_b32 v235, v108, v104, s67
    v_perm_b32 v236, v116, v112, s66
    v_perm_b32 v237, v116, v112, s67
    v_perm_b32 v238, v124, v120, s66
    v_perm_b32 v239, v124, v120, s67
    v_perm_b32 v240, v101, v97, s66
    v_perm_b32 v241, v101, v97, s67
    v_perm_b32 v242, v109, v105, s66
    v_perm_b32 v243, v109, v105, s67
    v_perm_b32 v244, v117, v113, s66
    v_perm_b32 v245, v117, v113, s67
    v_perm_b32 v246, v125, v121, s66
    v_perm_b32 v247, v125, v121, s67
    v_perm_b32 v48, v102, v98, s66
    v_perm_b32 v49, v102, v98, s67
    v_perm_b32 v50, v110, v106, s66
    v_perm_b32 v51, v110, v106, s67
    v_perm_b32 v52, v118, v114, s66
    v_perm_b32 v53, v118, v114, s67
    v_perm_b32 v54, v126, v122, s66
    v_perm_b32 v55, v126, v122, s67
    ds_write_b128 v0, v[48:51] offset:45056
    ds_write_b128 v0, v[52:55] offset:49152
    v_perm_b32 v56, v103, v99, s66
    v_perm_b32 v57, v103, v99, s67
    v_perm_b32 v58, v111, v107, s66
    v_perm_b32 v59, v111, v107, s67
    v_perm_b32 v60, v119, v115, s66
    v_perm_b32 v61, v119, v115, s67
    v_perm_b32 v62, v127, v123, s66
    v_perm_b32 v63, v127, v123, s67
    ds_write_b128 v0, v[56:59] offset:53248
    ds_write_b128 v0, v[60:63] offset:57344
    s_waitcnt lgkmcnt(0)
    s_waitcnt vmcnt(27)
    v_perm_b32 v248, v132, v128, s66
    v_perm_b32 v249, v132, v128, s67
    v_perm_b32 v250, v140, v136, s66
    v_perm_b32 v251, v140, v136, s67
    v_perm_b32 v252, v148, v144, s66
    v_perm_b32 v253, v148, v144, s67
    v_perm_b32 v254, v156, v152, s66
    v_perm_b32 v255, v156, v152, s67
    v_perm_b32 v40, v133, v129, s66
    v_perm_b32 v41, v133, v129, s67
    v_perm_b32 v42, v141, v137, s66
    v_perm_b32 v43, v141, v137, s67
    v_perm_b32 v44, v149, v145, s66
    v_perm_b32 v45, v149, v145, s67
    v_perm_b32 v46, v157, v153, s66
    v_perm_b32 v47, v157, v153, s67
    ds_write_b128 v0, v[40:43] offset:20480
    ds_write_b128 v0, v[44:47] offset:24576
    v_perm_b32 v48, v134, v130, s66
    v_perm_b32 v49, v134, v130, s67
    v_perm_b32 v50, v142, v138, s66
    v_perm_b32 v51, v142, v138, s67
    v_perm_b32 v52, v150, v146, s66
    v_perm_b32 v53, v150, v146, s67
    v_perm_b32 v54, v158, v154, s66
    v_perm_b32 v55, v158, v154, s67
    ds_write_b128 v0, v[48:51] offset:61440
    ds_write_b128 v1, v[52:55] offset:0
    v_perm_b32 v56, v135, v131, s66
    v_perm_b32 v57, v135, v131, s67
    v_perm_b32 v58, v143, v139, s66
    v_perm_b32 v59, v143, v139, s67
    v_perm_b32 v60, v151, v147, s66
    v_perm_b32 v61, v151, v147, s67
    v_perm_b32 v62, v159, v155, s66
    v_perm_b32 v63, v159, v155, s67
    ds_write_b128 v1, v[56:59] offset:4096
    ds_write_b128 v1, v[60:63] offset:8192
    s_waitcnt lgkmcnt(0)
    s_waitcnt vmcnt(19)
    v_perm_b32 v32, v164, v160, s66
    v_perm_b32 v33, v164, v160, s67
    v_perm_b32 v34, v172, v168, s66
    v_perm_b32 v35, v172, v168, s67
    v_perm_b32 v36, v180, v176, s66
    v_perm_b32 v37, v180, v176, s67
    v_perm_b32 v38, v188, v184, s66
    v_perm_b32 v39, v188, v184, s67
    ds_write_b128 v0, v[32:35] offset:28672
    ds_write_b128 v0, v[36:39] offset:32768
    v_perm_b32 v40, v165, v161, s66
    v_perm_b32 v41, v165, v161, s67
    v_perm_b32 v42, v173, v169, s66
    v_perm_b32 v43, v173, v169, s67
    v_perm_b32 v44, v181, v177, s66
    v_perm_b32 v45, v181, v177, s67
    v_perm_b32 v46, v189, v185, s66
    v_perm_b32 v47, v189, v185, s67
    ds_write_b128 v0, v[40:43] offset:36864
    ds_write_b128 v0, v[44:47] offset:40960
    v_perm_b32 v48, v166, v162, s66
    v_perm_b32 v49, v166, v162, s67
    v_perm_b32 v50, v174, v170, s66
    v_perm_b32 v51, v174, v170, s67
    v_perm_b32 v52, v182, v178, s66
    v_perm_b32 v53, v182, v178, s67
    v_perm_b32 v54, v190, v186, s66
    v_perm_b32 v55, v190, v186, s67
    ds_write_b128 v1, v[48:51] offset:12288
    ds_write_b128 v1, v[52:55] offset:16384
    v_perm_b32 v56, v167, v163, s66
    v_perm_b32 v57, v167, v163, s67
    v_perm_b32 v58, v175, v171, s66
    v_perm_b32 v59, v175, v171, s67
    v_perm_b32 v60, v183, v179, s66
    v_perm_b32 v61, v183, v179, s67
    v_perm_b32 v62, v191, v187, s66
    v_perm_b32 v63, v191, v187, s67
    ds_write_b128 v1, v[56:59] offset:20480
    ds_write_b128 v1, v[60:63] offset:24576
    s_waitcnt lgkmcnt(0)
    s_waitcnt vmcnt(15)
    s_waitcnt lgkmcnt(0)
    s_barrier
    ds_read_b64_tr_b16 a[0:1], v22 offset:0
    ds_read_b64_tr_b16 a[2:3], v22 offset:256
    ds_read_b64_tr_b16 a[8:9], v23 offset:0
    ds_read_b64_tr_b16 a[10:11], v23 offset:256
    ds_read_b64_tr_b16 a[32:33], v24 offset:0
    ds_read_b64_tr_b16 a[34:35], v24 offset:256
    ds_read_b64_tr_b16 a[40:41], v25 offset:0
    ds_read_b64_tr_b16 a[42:43], v25 offset:256
    s_waitcnt vmcnt(11)
    s_waitcnt lgkmcnt(0)
    s_barrier
    s_xor_b32 s43, s36, 2
    s_lshl_b32 s43, s43, 19
    s_add_u32 s43, s43, s74
    s_xor_b32 s75, s37, 0
    s_lshl_b32 s75, s75, 21
    s_add_u32 s43, s43, s75
    s_add_u32 s75, s43, 0
    s_add_u32 m0, s68, 0
    s_nop 0
    buffer_load_dwordx4 v16, s[48:51], s75 offen nt lds
    s_add_u32 s75, s43, 65536
    s_add_u32 m0, s68, 1024
    s_nop 0
    buffer_load_dwordx4 v17, s[48:51], s75 offen nt lds
    s_add_u32 s75, s43, 131072
    s_add_u32 m0, s68, 2048
    s_nop 0
    buffer_load_dwordx4 v16, s[48:51], s75 offen nt lds
    s_add_u32 s75, s43, 196608
    s_add_u32 m0, s68, 3072
    s_nop 0
    buffer_load_dwordx4 v17, s[48:51], s75 offen nt lds
    ds_read_b64_tr_b16 a[4:5], v22 offset:16384
    ds_read_b64_tr_b16 a[6:7], v22 offset:16640
    ds_read_b64_tr_b16 a[12:13], v23 offset:16384
    ds_read_b64_tr_b16 a[14:15], v23 offset:16640
    ds_read_b64_tr_b16 a[36:37], v24 offset:16384
    ds_read_b64_tr_b16 a[38:39], v24 offset:16640
    ds_read_b64_tr_b16 a[44:45], v25 offset:16384
    ds_read_b64_tr_b16 a[46:47], v25 offset:16640
    s_waitcnt vmcnt(11)
    s_waitcnt lgkmcnt(0)
    s_barrier
    s_xor_b32 s43, s36, 2
    s_lshl_b32 s43, s43, 19
    s_add_u32 s43, s43, s74
    s_xor_b32 s75, s37, 0
    s_lshl_b32 s75, s75, 21
    s_add_u32 s43, s43, s75
    s_add_u32 s75, s43, 262144
    s_add_u32 m0, s68, 16384
    s_nop 0
    buffer_load_dwordx4 v16, s[48:51], s75 offen nt lds
    s_add_u32 s75, s43, 327680
    s_add_u32 m0, s68, 17408
    s_nop 0
    buffer_load_dwordx4 v17, s[48:51], s75 offen nt lds
    s_add_u32 s75, s43, 393216
    s_add_u32 m0, s68, 18432
    s_nop 0
    buffer_load_dwordx4 v16, s[48:51], s75 offen nt lds
    s_add_u32 s75, s43, 458752
    s_add_u32 m0, s68, 19456
    s_nop 0
    buffer_load_dwordx4 v17, s[48:51], s75 offen nt lds
    ds_read_b64_tr_b16 a[16:17], v22 offset:32768
    ds_read_b64_tr_b16 a[18:19], v22 offset:33024
    ds_read_b64_tr_b16 a[24:25], v23 offset:32768
    ds_read_b64_tr_b16 a[26:27], v23 offset:33024
    ds_read_b64_tr_b16 a[48:49], v24 offset:32768
    ds_read_b64_tr_b16 a[50:51], v24 offset:33024
    ds_read_b64_tr_b16 a[56:57], v25 offset:32768
    ds_read_b64_tr_b16 a[58:59], v25 offset:33024
    s_waitcnt vmcnt(11)
    s_waitcnt lgkmcnt(0)
    s_barrier
    s_xor_b32 s43, s36, 2
    s_lshl_b32 s43, s43, 19
    s_add_u32 s43, s43, s74
    s_xor_b32 s75, s37, 1
    s_lshl_b32 s75, s75, 21
    s_add_u32 s43, s43, s75
    s_add_u32 s75, s43, 0
    s_add_u32 m0, s68, 32768
    s_nop 0
    buffer_load_dwordx4 v16, s[48:51], s75 offen nt lds
    s_add_u32 s75, s43, 65536
    s_add_u32 m0, s68, 33792
    s_nop 0
    buffer_load_dwordx4 v17, s[48:51], s75 offen nt lds
    s_add_u32 s75, s43, 131072
    s_add_u32 m0, s68, 34816
    s_nop 0
    buffer_load_dwordx4 v16, s[48:51], s75 offen nt lds
    s_add_u32 s75, s43, 196608
    s_add_u32 m0, s68, 35840
    s_nop 0
    buffer_load_dwordx4 v17, s[48:51], s75 offen nt lds
    ds_read_b64_tr_b16 a[20:21], v22 offset:49152
    ds_read_b64_tr_b16 a[22:23], v22 offset:49408
    ds_read_b64_tr_b16 a[28:29], v23 offset:49152
    ds_read_b64_tr_b16 a[30:31], v23 offset:49408
    ds_read_b64_tr_b16 a[52:53], v24 offset:49152
    ds_read_b64_tr_b16 a[54:55], v24 offset:49408
    ds_read_b64_tr_b16 a[60:61], v25 offset:49152
    ds_read_b64_tr_b16 a[62:63], v25 offset:49408
    s_waitcnt vmcnt(8)
    s_waitcnt lgkmcnt(0)
    s_barrier
    s_cmp_eq_u32 s13, 0
    s_cbranch_scc0 L_ch_na
    s_add_u32 s38, s91, 0x1000000
    v_mov_b32 v28, s90
    v_mov_b32 v29, s38
    v_mov_b32 v26, 0
    s_mov_b64 exec, 1
    global_atomic_add_x2 v26, v[28:29], s[92:93] offset:192
    s_mov_b64 exec, -1
L_ch_na:
    s_lshl_b64 s[90:91], s[90:91], 5
    s_add_u32 s91, s91, 0x20000000
    s_xor_b32 s43, s36, 2
    s_lshl_b32 s43, s43, 19
    s_add_u32 s43, s43, s74
    s_xor_b32 s75, s37, 1
    s_lshl_b32 s75, s75, 21
    s_add_u32 s43, s43, s75
    s_add_u32 s75, s43, 262144
    s_add_u32 m0, s68, 49152
    s_nop 0
    buffer_load_dwordx4 v16, s[48:51], s75 offen nt lds
    s_add_u32 s75, s43, 327680
    s_add_u32 m0, s68, 50176
    s_nop 0
    buffer_load_dwordx4 v17, s[48:51], s75 offen nt lds
    s_add_u32 s75, s43, 393216
    s_add_u32 m0, s68, 51200
    s_nop 0
    buffer_load_dwordx4 v16, s[48:51], s75 offen nt lds
    s_add_u32 s75, s43, 458752
    s_add_u32 m0, s68, 52224
    s_nop 0
    buffer_load_dwordx4 v17, s[48:51], s75 offen nt lds
    ds_read_b64_tr_b16 a[64:65], v22 offset:0
    ds_read_b64_tr_b16 a[66:67], v22 offset:256
    ds_read_b64_tr_b16 a[72:73], v23 offset:0
    ds_read_b64_tr_b16 a[74:75], v23 offset:256
    ds_read_b64_tr_b16 a[96:97], v24 offset:0
    ds_read_b64_tr_b16 a[98:99], v24 offset:256
    ds_read_b64_tr_b16 a[104:105], v25 offset:0
    ds_read_b64_tr_b16 a[106:107], v25 offset:256
    s_waitcnt vmcnt(8)
    s_waitcnt lgkmcnt(0)
    s_barrier
    s_xor_b32 s43, s36, 0
    s_lshl_b32 s43, s43, 19
    s_add_u32 s43, s43, s74
    s_xor_b32 s75, s37, 0
    s_lshl_b32 s75, s75, 21
    s_add_u32 s43, s43, s75
    s_add_u32 s75, s43, 0
    s_add_u32 m0, s68, 0
    s_nop 0
    buffer_load_dwordx4 v16, s[52:55], s75 offen nt lds
    s_add_u32 s75, s43, 65536
    s_add_u32 m0, s68, 1024
    s_nop 0
    buffer_load_dwordx4 v17, s[52:55], s75 offen nt lds
    s_add_u32 s75, s43, 131072
    s_add_u32 m0, s68, 2048
    s_nop 0
    buffer_load_dwordx4 v16, s[52:55], s75 offen nt lds
    s_add_u32 s75, s43, 196608
    s_add_u32 m0, s68, 3072
    s_nop 0
    buffer_load_dwordx4 v17, s[52:55], s75 offen nt lds
    ds_read_b64_tr_b16 a[68:69], v22 offset:16384
    ds_read_b64_tr_b16 a[70:71], v22 offset:16640
    ds_read_b64_tr_b16 a[76:77], v23 offset:16384
    ds_read_b64_tr_b16 a[78:79], v23 offset:16640
    ds_read_b64_tr_b16 a[100:101], v24 offset:16384
    ds_read_b64_tr_b16 a[102:103], v24 offset:16640
    ds_read_b64_tr_b16 a[108:109], v25 offset:16384
    ds_read_b64_tr_b16 a[110:111], v25 offset:16640
    s_waitcnt vmcnt(8)
    s_waitcnt lgkmcnt(0)
    s_barrier
    s_xor_b32 s43, s36, 0
    s_lshl_b32 s43, s43, 19
    s_add_u32 s43, s43, s74
    s_xor_b32 s75, s37, 0
    s_lshl_b32 s75, s75, 21
    s_add_u32 s43, s43, s75
    s_add_u32 s75, s43, 262144
    s_add_u32 m0, s68, 16384
    s_nop 0
    buffer_load_dwordx4 v16, s[52:55], s75 offen nt lds
    s_add_u32 s75, s43, 327680
    s_add_u32 m0, s68, 17408
    s_nop 0
    buffer_load_dwordx4 v17, s[52:55], s75 offen nt lds
    s_add_u32 s75, s43, 393216
    s_add_u32 m0, s68, 18432
    s_nop 0
    buffer_load_dwordx4 v16, s[52:55], s75 offen nt lds
    s_add_u32 s75, s43, 458752
    s_add_u32 m0, s68, 19456
    s_nop 0
    buffer_load_dwordx4 v17, s[52:55], s75 offen nt lds
    ds_read_b64_tr_b16 a[80:81], v22 offset:32768
    ds_read_b64_tr_b16 a[82:83], v22 offset:33024
    ds_read_b64_tr_b16 a[88:89], v23 offset:32768
    ds_read_b64_tr_b16 a[90:91], v23 offset:33024
    ds_read_b64_tr_b16 a[112:113], v24 offset:32768
    ds_read_b64_tr_b16 a[114:115], v24 offset:33024
    ds_read_b64_tr_b16 a[120:121], v25 offset:32768
    ds_read_b64_tr_b16 a[122:123], v25 offset:33024
    s_waitcnt vmcnt(8)
    s_waitcnt lgkmcnt(0)
    s_barrier
    s_xor_b32 s43, s36, 0
    s_lshl_b32 s43, s43, 19
    s_add_u32 s43, s43, s74
    s_xor_b32 s75, s37, 1
    s_lshl_b32 s75, s75, 21
    s_add_u32 s43, s43, s75
    s_add_u32 s75, s43, 0
    s_add_u32 m0, s68, 32768
    s_nop 0
    buffer_load_dwordx4 v16, s[52:55], s75 offen nt lds
    s_add_u32 s75, s43, 65536
    s_add_u32 m0, s68, 33792
    s_nop 0
    buffer_load_dwordx4 v17, s[52:55], s75 offen nt lds
    s_add_u32 s75, s43, 131072
    s_add_u32 m0, s68, 34816
    s_nop 0
    buffer_load_dwordx4 v16, s[52:55], s75 offen nt lds
    s_add_u32 s75, s43, 196608
    s_add_u32 m0, s68, 35840
    s_nop 0
    buffer_load_dwordx4 v17, s[52:55], s75 offen nt lds
    ds_read_b64_tr_b16 a[84:85], v22 offset:49152
    ds_read_b64_tr_b16 a[86:87], v22 offset:49408
    ds_read_b64_tr_b16 a[92:93], v23 offset:49152
    ds_read_b64_tr_b16 a[94:95], v23 offset:49408
    ds_read_b64_tr_b16 a[116:117], v24 offset:49152
    ds_read_b64_tr_b16 a[118:119], v24 offset:49408
    ds_read_b64_tr_b16 a[124:125], v25 offset:49152
    ds_read_b64_tr_b16 a[126:127], v25 offset:49408
    s_waitcnt vmcnt(8)
    s_waitcnt lgkmcnt(0)
    s_barrier
    s_xor_b32 s43, s36, 0
    s_lshl_b32 s43, s43, 19
    s_add_u32 s43, s43, s74
    s_xor_b32 s75, s37, 1
    s_lshl_b32 s75, s75, 21
    s_add_u32 s43, s43, s75
    s_add_u32 s75, s43, 262144
    s_add_u32 m0, s68, 49152
    s_nop 0
    buffer_load_dwordx4 v16, s[52:55], s75 offen nt lds
    s_add_u32 s75, s43, 327680
    s_add_u32 m0, s68, 50176
    s_nop 0
    buffer_load_dwordx4 v17, s[52:55], s75 offen nt lds
    s_add_u32 s75, s43, 393216
    s_add_u32 m0, s68, 51200
    s_nop 0
    buffer_load_dwordx4 v16, s[52:55], s75 offen nt lds
    s_add_u32 s75, s43, 458752
    s_add_u32 m0, s68, 52224
    s_nop 0
    buffer_load_dwordx4 v17, s[52:55], s75 offen nt lds
    ds_read_b64_tr_b16 a[128:129], v22 offset:0
    ds_read_b64_tr_b16 a[130:131], v22 offset:256
    ds_read_b64_tr_b16 a[136:137], v23 offset:0
    ds_read_b64_tr_b16 a[138:139], v23 offset:256
    ds_read_b64_tr_b16 a[160:161], v24 offset:0
    ds_read_b64_tr_b16 a[162:163], v24 offset:256
    ds_read_b64_tr_b16 a[168:169], v25 offset:0
    ds_read_b64_tr_b16 a[170:171], v25 offset:256
    s_waitcnt vmcnt(8)
    s_waitcnt lgkmcnt(0)
    s_barrier
    s_xor_b32 s43, s36, 2
    s_lshl_b32 s43, s43, 19
    s_add_u32 s43, s43, s74
    s_xor_b32 s75, s37, 0
    s_lshl_b32 s75, s75, 21
    s_add_u32 s43, s43, s75
    s_add_u32 s75, s43, 0
    s_add_u32 m0, s68, 0
    s_nop 0
    buffer_load_dwordx4 v16, s[52:55], s75 offen nt lds
    s_add_u32 s75, s43, 65536
    s_add_u32 m0, s68, 1024
    s_nop 0
    buffer_load_dwordx4 v17, s[52:55], s75 offen nt lds
    s_add_u32 s75, s43, 131072
    s_add_u32 m0, s68, 2048
    s_nop 0
    buffer_load_dwordx4 v16, s[52:55], s75 offen nt lds
    s_add_u32 s75, s43, 196608
    s_add_u32 m0, s68, 3072
    s_nop 0
    buffer_load_dwordx4 v17, s[52:55], s75 offen nt lds
    ds_read_b64_tr_b16 a[132:133], v22 offset:16384
    ds_read_b64_tr_b16 a[134:135], v22 offset:16640
    ds_read_b64_tr_b16 a[140:141], v23 offset:16384
    ds_read_b64_tr_b16 a[142:143], v23 offset:16640
    ds_read_b64_tr_b16 a[164:165], v24 offset:16384
    ds_read_b64_tr_b16 a[166:167], v24 offset:16640
    ds_read_b64_tr_b16 a[172:173], v25 offset:16384
    ds_read_b64_tr_b16 a[174:175], v25 offset:16640
    s_waitcnt vmcnt(8)
    s_waitcnt lgkmcnt(0)
    s_barrier
    s_xor_b32 s43, s36, 2
    s_lshl_b32 s43, s43, 19
    s_add_u32 s43, s43, s74
    s_xor_b32 s75, s37, 0
    s_lshl_b32 s75, s75, 21
    s_add_u32 s43, s43, s75
    s_add_u32 s75, s43, 262144
    s_add_u32 m0, s68, 16384
    s_nop 0
    buffer_load_dwordx4 v16, s[52:55], s75 offen nt lds
    s_add_u32 s75, s43, 327680
    s_add_u32 m0, s68, 17408
    s_nop 0
    buffer_load_dwordx4 v17, s[52:55], s75 offen nt lds
    s_add_u32 s75, s43, 393216
    s_add_u32 m0, s68, 18432
    s_nop 0
    buffer_load_dwordx4 v16, s[52:55], s75 offen nt lds
    s_add_u32 s75, s43, 458752
    s_add_u32 m0, s68, 19456
    s_nop 0
    buffer_load_dwordx4 v17, s[52:55], s75 offen nt lds
    ds_read_b64_tr_b16 a[144:145], v22 offset:32768
    ds_read_b64_tr_b16 a[146:147], v22 offset:33024
    ds_read_b64_tr_b16 a[152:153], v23 offset:32768
    ds_read_b64_tr_b16 a[154:155], v23 offset:33024
    ds_read_b64_tr_b16 a[176:177], v24 offset:32768
    ds_read_b64_tr_b16 a[178:179], v24 offset:33024
    ds_read_b64_tr_b16 a[184:185], v25 offset:32768
    ds_read_b64_tr_b16 a[186:187], v25 offset:33024
    s_waitcnt vmcnt(8)
    s_waitcnt lgkmcnt(0)
    s_barrier
    s_xor_b32 s43, s36, 2
    s_lshl_b32 s43, s43, 19
    s_add_u32 s43, s43, s74
    s_xor_b32 s75, s37, 1
    s_lshl_b32 s75, s75, 21
    s_add_u32 s43, s43, s75
    s_add_u32 s75, s43, 0
    s_add_u32 m0, s68, 32768
    s_nop 0
    buffer_load_dwordx4 v16, s[52:55], s75 offen nt lds
    s_add_u32 s75, s43, 65536
    s_add_u32 m0, s68, 33792
    s_nop 0
    buffer_load_dwordx4 v17, s[52:55], s75 offen nt lds
    s_add_u32 s75, s43, 131072
    s_add_u32 m0, s68, 34816
    s_nop 0
    buffer_load_dwordx4 v16, s[52:55], s75 offen nt lds
    s_add_u32 s75, s43, 196608
    s_add_u32 m0, s68, 35840
    s_nop 0
    buffer_load_dwordx4 v17, s[52:55], s75 offen nt lds
    ds_read_b64_tr_b16 a[148:149], v22 offset:49152
    ds_read_b64_tr_b16 a[150:151], v22 offset:49408
    ds_read_b64_tr_b16 a[156:157], v23 offset:49152
    ds_read_b64_tr_b16 a[158:159], v23 offset:49408
    ds_read_b64_tr_b16 a[180:181], v24 offset:49152
    ds_read_b64_tr_b16 a[182:183], v24 offset:49408
    ds_read_b64_tr_b16 a[188:189], v25 offset:49152
    ds_read_b64_tr_b16 a[190:191], v25 offset:49408
    s_waitcnt vmcnt(8)
    s_waitcnt lgkmcnt(0)
    s_barrier
    s_xor_b32 s43, s36, 2
    s_lshl_b32 s43, s43, 19
    s_add_u32 s43, s43, s74
    s_xor_b32 s75, s37, 1
    s_lshl_b32 s75, s75, 21
    s_add_u32 s43, s43, s75
    s_add_u32 s75, s43, 262144
    s_add_u32 m0, s68, 49152
    s_nop 0
    buffer_load_dwordx4 v16, s[52:55], s75 offen nt lds
    s_add_u32 s75, s43, 327680
    s_add_u32 m0, s68, 50176
    s_nop 0
    buffer_load_dwordx4 v17, s[52:55], s75 offen nt lds
    s_add_u32 s75, s43, 393216
    s_add_u32 m0, s68, 51200
    s_nop 0
    buffer_load_dwordx4 v16, s[52:55], s75 offen nt lds
    s_add_u32 s75, s43, 458752
    s_add_u32 m0, s68, 52224
    s_nop 0
    buffer_load_dwordx4 v17, s[52:55], s75 offen nt lds
    ds_read_b64_tr_b16 a[192:193], v22 offset:0
    ds_read_b64_tr_b16 a[194:195], v22 offset:256
    ds_read_b64_tr_b16 a[200:201], v23 offset:0
    ds_read_b64_tr_b16 a[202:203], v23 offset:256
    ds_read_b64_tr_b16 a[224:225], v24 offset:0
    ds_read_b64_tr_b16 a[226:227], v24 offset:256
    ds_read_b64_tr_b16 a[232:233], v25 offset:0
    ds_read_b64_tr_b16 a[234:235], v25 offset:256
    s_waitcnt vmcnt(8)
    s_waitcnt lgkmcnt(0)
    s_barrier
    s_xor_b32 s43, s36, 2
    s_lshl_b32 s43, s43, 19
    s_add_u32 s43, s43, s74
    s_xor_b32 s75, s37, 0
    s_lshl_b32 s75, s75, 21
    s_add_u32 s43, s43, s75
    s_add_u32 s75, s43, 0
    s_add_u32 m0, s68, 0
    s_nop 0
    buffer_load_dwordx4 v16, s[44:47], s75 offen nt lds
    s_add_u32 s75, s43, 65536
    s_add_u32 m0, s68, 1024
    s_nop 0
    buffer_load_dwordx4 v17, s[44:47], s75 offen nt lds
    s_add_u32 s75, s43, 131072
    s_add_u32 m0, s68, 2048
    s_nop 0
    buffer_load_dwordx4 v16, s[44:47], s75 offen nt lds
    s_add_u32 s75, s43, 196608
    s_add_u32 m0, s68, 3072
    s_nop 0
    buffer_load_dwordx4 v17, s[44:47], s75 offen nt lds
    ds_read_b64_tr_b16 a[196:197], v22 offset:16384
    ds_read_b64_tr_b16 a[198:199], v22 offset:16640
    ds_read_b64_tr_b16 a[204:205], v23 offset:16384
    ds_read_b64_tr_b16 a[206:207], v23 offset:16640
    ds_read_b64_tr_b16 a[228:229], v24 offset:16384
    ds_read_b64_tr_b16 a[230:231], v24 offset:16640
    ds_read_b64_tr_b16 a[236:237], v25 offset:16384
    ds_read_b64_tr_b16 a[238:239], v25 offset:16640
    s_waitcnt vmcnt(8)
    s_waitcnt lgkmcnt(0)
    s_barrier
    s_xor_b32 s43, s36, 2
    s_lshl_b32 s43, s43, 19
    s_add_u32 s43, s43, s74
    s_xor_b32 s75, s37, 0
    s_lshl_b32 s75, s75, 21
    s_add_u32 s43, s43, s75
    s_add_u32 s75, s43, 262144
    s_add_u32 m0, s68, 16384
    s_nop 0
    buffer_load_dwordx4 v16, s[44:47], s75 offen nt lds
    s_add_u32 s75, s43, 327680
    s_add_u32 m0, s68, 17408
    s_nop 0
    buffer_load_dwordx4 v17, s[44:47], s75 offen nt lds
    s_add_u32 s75, s43, 393216
    s_add_u32 m0, s68, 18432
    s_nop 0
    buffer_load_dwordx4 v16, s[44:47], s75 offen nt lds
    s_add_u32 s75, s43, 458752
    s_add_u32 m0, s68, 19456
    s_nop 0
    buffer_load_dwordx4 v17, s[44:47], s75 offen nt lds
    ds_read_b64_tr_b16 a[208:209], v22 offset:32768
    ds_read_b64_tr_b16 a[210:211], v22 offset:33024
    ds_read_b64_tr_b16 a[216:217], v23 offset:32768
    ds_read_b64_tr_b16 a[218:219], v23 offset:33024
    ds_read_b64_tr_b16 a[240:241], v24 offset:32768
    ds_read_b64_tr_b16 a[242:243], v24 offset:33024
    ds_read_b64_tr_b16 a[248:249], v25 offset:32768
    ds_read_b64_tr_b16 a[250:251], v25 offset:33024
    s_waitcnt vmcnt(8)
    s_waitcnt lgkmcnt(0)
    s_barrier
    s_xor_b32 s43, s36, 2
    s_lshl_b32 s43, s43, 19
    s_add_u32 s43, s43, s74
    s_xor_b32 s75, s37, 1
    s_lshl_b32 s75, s75, 21
    s_add_u32 s43, s43, s75
    s_add_u32 s75, s43, 0
    s_add_u32 m0, s68, 32768
    s_nop 0
    buffer_load_dwordx4 v16, s[44:47], s75 offen nt lds
    s_add_u32 s75, s43, 65536
    s_add_u32 m0, s68, 33792
    s_nop 0
    buffer_load_dwordx4 v17, s[44:47], s75 offen nt lds
    s_add_u32 s75, s43, 131072
    s_add_u32 m0, s68, 34816
    s_nop 0
    buffer_load_dwordx4 v16, s[44:47], s75 offen nt lds
    s_add_u32 s75, s43, 196608
    s_add_u32 m0, s68, 35840
    s_nop 0
    buffer_load_dwordx4 v17, s[44:47], s75 offen nt lds
    ds_read_b64_tr_b16 a[212:213], v22 offset:49152
    ds_read_b64_tr_b16 a[214:215], v22 offset:49408
    ds_read_b64_tr_b16 a[220:221], v23 offset:49152
    ds_read_b64_tr_b16 a[222:223], v23 offset:49408
    ds_read_b64_tr_b16 a[244:245], v24 offset:49152
    ds_read_b64_tr_b16 a[246:247], v24 offset:49408
    ds_read_b64_tr_b16 a[252:253], v25 offset:49152
    ds_read_b64_tr_b16 a[254:255], v25 offset:49408
    s_waitcnt vmcnt(8)
    s_waitcnt lgkmcnt(0)
    s_barrier
    s_xor_b32 s43, s36, 2
    s_lshl_b32 s43, s43, 19
    s_add_u32 s43, s43, s74
    s_xor_b32 s75, s37, 1
    s_lshl_b32 s75, s75, 21
    s_add_u32 s43, s43, s75
    s_add_u32 s75, s43, 262144
    s_add_u32 m0, s68, 49152
    s_nop 0
    buffer_load_dwordx4 v16, s[44:47], s75 offen nt lds
    s_add_u32 s75, s43, 327680
    s_add_u32 m0, s68, 50176
    s_nop 0
    buffer_load_dwordx4 v17, s[44:47], s75 offen nt lds
    s_add_u32 s75, s43, 393216
    s_add_u32 m0, s68, 51200
    s_nop 0
    buffer_load_dwordx4 v16, s[44:47], s75 offen nt lds
    s_add_u32 s75, s43, 458752
    s_add_u32 m0, s68, 52224
    s_nop 0
    buffer_load_dwordx4 v17, s[44:47], s75 offen nt lds
    v_mov_b32 v26, 0
    global_load_dwordx2 v[28:29], v26, s[92:93] offset:192 sc1
    global_load_dword v27, v26, s[92:93] offset:132 sc1
    ds_read_b64_tr_b16 v[136:137], v22 offset:0
    ds_read_b64_tr_b16 v[138:139], v22 offset:256
    ds_read_b64_tr_b16 v[144:145], v23 offset:0
    ds_read_b64_tr_b16 v[146:147], v23 offset:256
    ds_read_b64_tr_b16 v[168:169], v24 offset:0
    ds_read_b64_tr_b16 v[170:171], v24 offset:256
    ds_read_b64_tr_b16 v[176:177], v25 offset:0
    ds_read_b64_tr_b16 v[178:179], v25 offset:256
    s_waitcnt vmcnt(10)
    s_waitcnt lgkmcnt(0)
    s_barrier
    s_xor_b32 s43, s36, 0
    s_lshl_b32 s43, s43, 19
    s_add_u32 s43, s43, s74
    s_xor_b32 s75, s37, 0
    s_lshl_b32 s75, s75, 21
    s_add_u32 s43, s43, s75
    s_add_u32 s75, s43, 0
    s_add_u32 m0, s68, 0
    s_nop 0
    buffer_load_dwordx4 v16, s[44:47], s75 offen nt lds
    s_add_u32 s75, s43, 65536
    s_add_u32 m0, s68, 1024
    s_nop 0
    buffer_load_dwordx4 v17, s[44:47], s75 offen nt lds
    s_add_u32 s75, s43, 131072
    s_add_u32 m0, s68, 2048
    s_nop 0
    buffer_load_dwordx4 v16, s[44:47], s75 offen nt lds
    s_add_u32 s75, s43, 196608
    s_add_u32 m0, s68, 3072
    s_nop 0
    buffer_load_dwordx4 v17, s[44:47], s75 offen nt lds
    ds_read_b64_tr_b16 v[140:141], v22 offset:16384
    ds_read_b64_tr_b16 v[142:143], v22 offset:16640
    ds_read_b64_tr_b16 v[148:149], v23 offset:16384
    ds_read_b64_tr_b16 v[150:151], v23 offset:16640
    ds_read_b64_tr_b16 v[172:173], v24 offset:16384
    ds_read_b64_tr_b16 v[174:175], v24 offset:16640
    ds_read_b64_tr_b16 v[180:181], v25 offset:16384
    ds_read_b64_tr_b16 v[182:183], v25 offset:16640
    s_waitcnt vmcnt(10)
    s_waitcnt lgkmcnt(0)
    s_barrier
    s_xor_b32 s43, s36, 0
    s_lshl_b32 s43, s43, 19
    s_add_u32 s43, s43, s74
    s_xor_b32 s75, s37, 0
    s_lshl_b32 s75, s75, 21
    s_add_u32 s43, s43, s75
    s_add_u32 s75, s43, 262144
    s_add_u32 m0, s68, 16384
    s_nop 0
    buffer_load_dwordx4 v16, s[44:47], s75 offen nt lds
    s_add_u32 s75, s43, 327680
    s_add_u32 m0, s68, 17408
    s_nop 0
    buffer_load_dwordx4 v17, s[44:47], s75 offen nt lds
    s_add_u32 s75, s43, 393216
    s_add_u32 m0, s68, 18432
    s_nop 0
    buffer_load_dwordx4 v16, s[44:47], s75 offen nt lds
    s_add_u32 s75, s43, 458752
    s_add_u32 m0, s68, 19456
    s_nop 0
    buffer_load_dwordx4 v17, s[44:47], s75 offen nt lds
    ds_read_b64_tr_b16 v[152:153], v22 offset:32768
    ds_read_b64_tr_b16 v[154:155], v22 offset:33024
    ds_read_b64_tr_b16 v[160:161], v23 offset:32768
    ds_read_b64_tr_b16 v[162:163], v23 offset:33024
    ds_read_b64_tr_b16 v[184:185], v24 offset:32768
    ds_read_b64_tr_b16 v[186:187], v24 offset:33024
    ds_read_b64_tr_b16 v[192:193], v25 offset:32768
    ds_read_b64_tr_b16 v[194:195], v25 offset:33024
    s_waitcnt vmcnt(10)
    s_waitcnt lgkmcnt(0)
    s_barrier
    s_xor_b32 s43, s36, 0
    s_lshl_b32 s43, s43, 19
    s_add_u32 s43, s43, s74
    s_xor_b32 s75, s37, 1
    s_lshl_b32 s75, s75, 21
    s_add_u32 s43, s43, s75
    s_add_u32 s75, s43, 0
    s_add_u32 m0, s68, 32768
    s_nop 0
    buffer_load_dwordx4 v16, s[44:47], s75 offen nt lds
    s_add_u32 s75, s43, 65536
    s_add_u32 m0, s68, 33792
    s_nop 0
    buffer_load_dwordx4 v17, s[44:47], s75 offen nt lds
    s_add_u32 s75, s43, 131072
    s_add_u32 m0, s68, 34816
    s_nop 0
    buffer_load_dwordx4 v16, s[44:47], s75 offen nt lds
    s_add_u32 s75, s43, 196608
    s_add_u32 m0, s68, 35840
    s_nop 0
    buffer_load_dwordx4 v17, s[44:47], s75 offen nt lds
    ds_read_b64_tr_b16 v[156:157], v22 offset:49152
    ds_read_b64_tr_b16 v[158:159], v22 offset:49408
    ds_read_b64_tr_b16 v[164:165], v23 offset:49152
    ds_read_b64_tr_b16 v[166:167], v23 offset:49408
    ds_read_b64_tr_b16 v[188:189], v24 offset:49152
    ds_read_b64_tr_b16 v[190:191], v24 offset:49408
    ds_read_b64_tr_b16 v[196:197], v25 offset:49152
    ds_read_b64_tr_b16 v[198:199], v25 offset:49408
    s_waitcnt vmcnt(8)
    s_waitcnt lgkmcnt(0)
    s_barrier
    v_cmp_gt_u32 vcc, 32, v27
    s_mov_b64 s[38:39], vcc
    v_cmp_gt_u32 vcc, 0x20000000, v29
    s_or_b64 s[38:39], s[38:39], vcc
    s_xor_b32 s43, s36, 0
    s_lshl_b32 s43, s43, 19
    s_add_u32 s43, s43, s74
    s_xor_b32 s75, s37, 1
    s_lshl_b32 s75, s75, 21
    s_add_u32 s43, s43, s75
    s_add_u32 s75, s43, 262144
    s_add_u32 m0, s68, 49152
    s_nop 0
    buffer_load_dwordx4 v16, s[44:47], s75 offen nt lds
    s_add_u32 s75, s43, 327680
    s_add_u32 m0, s68, 50176
    s_nop 0
    buffer_load_dwordx4 v17, s[44:47], s75 offen nt lds
    s_add_u32 s75, s43, 393216
    s_add_u32 m0, s68, 51200
    s_nop 0
    buffer_load_dwordx4 v16, s[44:47], s75 offen nt lds
    s_add_u32 s75, s43, 458752
    s_add_u32 m0, s68, 52224
    s_nop 0
    buffer_load_dwordx4 v17, s[44:47], s75 offen nt lds
    buffer_load_dword v30, off, s[4:7], s15 sc1
    buffer_load_dword v31, off, s[4:7], s15 offset:128 sc1
    ds_read_b64_tr_b16 v[64:65], v22 offset:0
    ds_read_b64_tr_b16 v[66:67], v22 offset:256
    ds_read_b64_tr_b16 v[72:73], v23 offset:0
    ds_read_b64_tr_b16 v[74:75], v23 offset:256
    ds_read_b64_tr_b16 v[96:97], v24 offset:0
    ds_read_b64_tr_b16 v[98:99], v24 offset:256
    ds_read_b64_tr_b16 v[120:121], v25 offset:0
    ds_read_b64_tr_b16 v[122:123], v25 offset:256
    s_waitcnt vmcnt(10)
    s_waitcnt lgkmcnt(0)
    s_barrier
    ds_write_b128 v1, v[64:67] offset:28672
    ds_write_b128 v1, v[72:75] offset:32768
    ds_write_b128 v1, v[96:99] offset:36864
    ds_write_b128 v1, v[120:123] offset:40960
    ds_read_b64_tr_b16 v[68:69], v22 offset:16384
    ds_read_b64_tr_b16 v[70:71], v22 offset:16640
    ds_read_b64_tr_b16 v[76:77], v23 offset:16384
    ds_read_b64_tr_b16 v[78:79], v23 offset:16640
    ds_read_b64_tr_b16 v[100:101], v24 offset:16384
    ds_read_b64_tr_b16 v[102:103], v24 offset:16640
    ds_read_b64_tr_b16 v[124:125], v25 offset:16384
    ds_read_b64_tr_b16 v[126:127], v25 offset:16640
    s_waitcnt vmcnt(6)
    s_waitcnt lgkmcnt(0)
    s_barrier
    ds_write_b128 v1, v[68:71] offset:45056
    ds_write_b128 v1, v[76:79] offset:49152
    ds_write_b128 v1, v[100:103] offset:53248
    ds_write_b128 v1, v[124:127] offset:57344
    ds_read_b64_tr_b16 v[80:81], v22 offset:32768
    ds_read_b64_tr_b16 v[82:83], v22 offset:33024
    ds_read_b64_tr_b16 v[88:89], v23 offset:32768
    ds_read_b64_tr_b16 v[90:91], v23 offset:33024
    ds_read_b64_tr_b16 v[104:105], v24 offset:32768
    ds_read_b64_tr_b16 v[106:107], v24 offset:33024
    ds_read_b64_tr_b16 v[112:113], v25 offset:32768
    ds_read_b64_tr_b16 v[114:115], v25 offset:33024
    s_waitcnt vmcnt(2)
    s_waitcnt lgkmcnt(0)
    s_barrier
    ds_write_b128 v1, v[80:83] offset:61440
    ds_write_b128 v9, v[88:91] offset:0
    ds_write_b128 v9, v[104:107] offset:4096
    ds_write_b128 v9, v[112:115] offset:8192
    ds_read_b64_tr_b16 v[84:85], v22 offset:49152
    ds_read_b64_tr_b16 v[86:87], v22 offset:49408
    ds_read_b64_tr_b16 v[92:93], v23 offset:49152
    ds_read_b64_tr_b16 v[94:95], v23 offset:49408
    ds_read_b64_tr_b16 v[108:109], v24 offset:49152
    ds_read_b64_tr_b16 v[110:111], v24 offset:49408
    ds_read_b64_tr_b16 v[116:117], v25 offset:49152
    ds_read_b64_tr_b16 v[118:119], v25 offset:49408
    s_waitcnt lgkmcnt(0)
    s_barrier
    s_add_u32 s27, s23, 524288
    s_lshl_b32 s43, s14, 8
    s_add_u32 s29, s43, 1572992
    s_and_b32 s43, s13, 1
    s_lshl_b32 s43, s43, 13
    s_add_u32 s27, s27, s43
    s_cmp_ge_u32 s13, 2
    s_cselect_b32 s27, s27, 0x80000000
    s_cselect_b32 s29, s29, 0x80000000
    s_mov_b32 s74, 2
    s_waitcnt vmcnt(0)
    v_mov_b32 v20, v28
    v_mov_b32 v21, v29
    v_cmp_gt_u32 vcc, 1, v30
    s_or_b64 s[38:39], s[38:39], vcc
    v_cmp_gt_u32 vcc, 2, v31
    s_or_b64 vcc, s[38:39], vcc
    s_cbranch_vccz L_ch_go
    v_mov_b32 v18, 0
    s_mov_b32 s38, 0x20000000
    s_mov_b32 s42, 0
L_cs_1:
    global_load_dwordx2 v[20:21], v18, s[92:93] offset:192 sc1
    s_waitcnt vmcnt(0)
    v_cmp_gt_u32 vcc, s38, v21
    s_cbranch_vccz L_cd_2
    s_add_u32 s42, s42, 1
    s_cmp_lt_u32 s42, 2097152
    s_cbranch_scc1 L_cs_1
    s_branch L_fail
L_cd_2:
    s_mov_b32 s42, 0
L_cs_3:
    global_load_dword v16, v18, s[92:93] offset:132 sc1
    s_waitcnt vmcnt(0)
    v_cmp_gt_u32 vcc, 32, v16
    s_cbranch_vccz L_cd_4
    s_add_u32 s42, s42, 1
    s_cmp_lt_u32 s42, 2097152
    s_cbranch_scc1 L_cs_3
    s_branch L_fail
L_cd_4:
    s_mov_b32 s42, 0
L_cs_5:
    buffer_load_dword v16, off, s[4:7], s15 sc1
    s_waitcnt vmcnt(0)
    v_cmp_gt_u32 vcc, 1, v16
    s_cbranch_vccz L_cd_6
    s_add_u32 s42, s42, 1
    s_cmp_lt_u32 s42, 2097152
    s_cbranch_scc1 L_cs_5
    s_branch L_fail
L_cd_6:
    s_mov_b32 s42, 0
L_cs_7:
    buffer_load_dword v16, off, s[4:7], s15 offset:128 sc1
    s_waitcnt vmcnt(0)
    v_cmp_gt_u32 vcc, 2, v16
    s_cbranch_vccz L_cd_8
    s_add_u32 s42, s42, 1
    s_cmp_lt_u32 s42, 2097152
    s_cbranch_scc1 L_cs_7
    s_branch L_fail
L_cd_8:
L_ch_go:
    v_readfirstlane_b32 s88, v20
    v_readfirstlane_b32 s89, v21
    v_lshrrev_b32 v21, 4, v11
    v_bfe_u32 v20, v21, 2, 2
    v_lshlrev_b32 v18, 11, v20
    v_and_b32 v20, 1, v21
    v_lshl_add_u32 v18, v20, 10, v18
    v_bfe_u32 v20, v21, 1, 1
    v_lshl_add_u32 v18, v20, 4, v18
    v_lshrrev_b32 v20, 4, v21
    v_lshl_add_u32 v18, v20, 5, v18
    s_lshl_b32 s43, s36, 7
    s_lshl_b32 s64, s37, 9
    s_add_u32 s43, s43, s64
    s_xor_b32 s64, s43, 512
    buffer_load_dwordx4 v[32:35], v18, s[60:63], s43 offen
    buffer_load_dwordx4 v[36:39], v18, s[60:63], s64 offen
    s_mov_b32 s43, s23
    s_add_u32 m0, s22, 0
    s_nop 0
    buffer_load_dwordx4 v0, s[4:7], s43 offen sc1 lds
    s_add_u32 s43, s43, 4096
    s_add_u32 m0, s22, 4096
    s_nop 0
    buffer_load_dwordx4 v0, s[4:7], s43 offen sc1 lds
    s_add_u32 s43, s43, 4096
    buffer_load_dwordx4 v[128:131], v0, s[4:7], s43 offen sc1
    s_add_u32 s43, s43, 4096
    buffer_load_dwordx4 v[132:135], v0, s[4:7], s43 offen sc1
L_ch_go2:
    ds_write_b128 v9, v[84:87] offset:12288
    ds_write_b128 v9, v[92:95] offset:16384
    ds_write_b128 v9, v[108:111] offset:20480
    ds_write_b128 v9, v[116:119] offset:24576
    v_mov_b32 v10, 0
    v_mov_b64 v[16:17], 0
    v_mov_b64 v[18:19], 0
    v_mov_b64 v[20:21], 0
    v_mov_b64 v[22:23], 0
    v_mov_b64 v[24:25], 0
    v_mov_b64 v[26:27], 0
    v_mov_b64 v[28:29], 0
    v_mov_b64 v[120:121], 0
    v_mov_b64 v[122:123], 0
    v_mov_b64 v[124:125], 0
    v_mov_b64 v[126:127], 0
    v_xor_b32 v40, 1024, v0
    v_xor_b32 v48, 2048, v0
    v_xor_b32 v56, 3072, v0
    v_lshlrev_b32 v61, 3, v11
    s_waitcnt vmcnt(0)
    v_mov_b64 v[30:31], 0
    s_mov_b32 s42, 0
    s_cmp_eq_u64 s[88:89], s[90:91]
    s_cbranch_scc0 L_first_s
    s_branch L_first
L_first:
    ds_write_b128 v0, v[32:35] offset:0
    v_smfmac_f32_16x16x64_bf16 v[16:19], v[32:35], v[64:71], v5
    ds_write_b128 v0, v[36:39] offset:4096
    v_smfmac_f32_16x16x64_bf16 v[20:23], v[32:35], v[72:79], v5
    v_smfmac_f32_16x16x64_bf16 v[16:19], v[36:39], v[80:87], v5
    v_smfmac_f32_16x16x64_bf16 v[20:23], v[36:39], v[88:95], v5
    s_branch L_arrok
L_arr:
    s_waitcnt vmcnt(2)
    v_bitop3_b32 v44, v35, v39, s18 bitop3:0x7e
    ds_write_b128 v0, v[32:35] offset:0
    v_smfmac_f32_16x16x64_bf16 v[16:19], v[32:35], v[64:71], v5
    ds_write_b128 v0, v[36:39] offset:4096
    v_and_b32 v44, 1, v44
    v_smfmac_f32_16x16x64_bf16 v[20:23], v[32:35], v[72:79], v5
    v_cmp_ne_u32 vcc, 0, v44
    v_smfmac_f32_16x16x64_bf16 v[16:19], v[36:39], v[80:87], v5
    v_smfmac_f32_16x16x64_bf16 v[20:23], v[36:39], v[88:95], v5
    s_cbranch_vccnz L_retry2
L_arrok:
    s_waitcnt lgkmcnt(0)
    s_barrier
    ds_read_b128 v[44:47], v40 offset:4096
    ds_read_b128 v[40:43], v40 offset:0
    ds_read_b128 v[64:67], v1 offset:40960
    v_smfmac_f32_16x16x64_bf16 v[24:27], v[32:35], a[0:7], v5
    ds_read_b128 v[68:71], v1 offset:57344
    v_smfmac_f32_16x16x64_bf16 v[28:31], v[32:35], a[8:15], v5
    ds_read_b128 v[52:55], v48 offset:4096
    s_add_u32 s23, s23, 524288
    v_smfmac_f32_16x16x64_bf16 v[24:27], v[36:39], a[16:23], v5
    ds_read_b128 v[48:51], v48 offset:0
    s_not_b32 s18, s18
    v_smfmac_f32_16x16x64_bf16 v[28:31], v[36:39], a[24:31], v5
    ds_read_b128 v[60:63], v56 offset:4096
    v_smfmac_f32_16x16x64_bf16 v[120:123], v[32:35], a[128:135], v5
    ds_read_b128 v[56:59], v56 offset:0
    v_smfmac_f32_16x16x64_bf16 v[124:127], v[32:35], a[136:143], v5
    ds_read_b128 v[72:75], v11 offset:8192
    v_smfmac_f32_16x16x64_bf16 v[120:123], v[36:39], a[144:151], v5
    ds_read_b128 v[76:79], v11 offset:12288
    v_smfmac_f32_16x16x64_bf16 v[124:127], v[36:39], a[152:159], v5
    ds_read_b128 v[80:83], v11 offset:9216
    s_waitcnt lgkmcnt(10)
    v_smfmac_f32_16x16x64_bf16 v[16:19], v[44:47], v[104:111], v5
    ds_read_b128 v[84:87], v11 offset:13312
    v_smfmac_f32_16x16x64_bf16 v[20:23], v[44:47], v[112:119], v5
    ds_read_b128 v[88:91], v11 offset:10240
    s_waitcnt lgkmcnt(11)
    v_smfmac_f32_16x16x64_bf16 v[16:19], v[40:43], v[96:103], v5
    ds_read_b128 v[92:95], v11 offset:14336
    s_waitcnt lgkmcnt(10)
    v_smfmac_f32_16x16x64_bf16 v[20:23], v[40:43], v[64:71], v5
    ds_read_b128 v[104:107], v11 offset:11264
    s_waitcnt lgkmcnt(10)
    v_smfmac_f32_16x16x64_bf16 v[16:19], v[52:55], v[152:159], v5
    ds_read_b128 v[108:111], v11 offset:15360
    v_smfmac_f32_16x16x64_bf16 v[20:23], v[52:55], v[160:167], v5
    s_waitcnt vmcnt(0)
    s_mov_b64 exec, s[34:35]
    s_waitcnt lgkmcnt(10)
    v_smfmac_f32_16x16x64_bf16 v[16:19], v[48:51], v[136:143], v5
    buffer_store_dwordx4 v[32:35], v0, s[4:7], s28 offen sc1
    s_mov_b64 exec, -1
    v_smfmac_f32_16x16x64_bf16 v[20:23], v[48:51], v[144:151], v5
    s_add_u32 s24, s23, 4096
    s_add_u32 s25, s23, 8192
    s_waitcnt lgkmcnt(9)
    v_smfmac_f32_16x16x64_bf16 v[16:19], v[60:63], v[184:191], v5
    s_add_u32 s26, s23, 12288
    v_add_u32 v112, 16384, v3
    s_waitcnt lgkmcnt(8)
    v_smfmac_f32_16x16x64_bf16 v[16:19], v[56:59], v[168:175], v5
    s_mov_b32 m0, 159744
    s_add_u32 s27, s27, 524288
    v_lshlrev_b32 v113, 3, v11
    v_smfmac_f32_16x16x64_bf16 v[20:23], v[60:63], v[192:199], v5
    buffer_load_dword v113, s[4:7], s27 offen sc1 lds
    v_smfmac_f32_16x16x64_bf16 v[20:23], v[56:59], v[176:183], v5
    s_nop 0
    v_add_f32 v16, v16, v18
    v_smfmac_f32_16x16x64_bf16 v[24:27], v[44:47], a[48:55], v5
    v_add_f32 v17, v17, v19
    v_smfmac_f32_16x16x64_bf16 v[28:31], v[44:47], a[56:63], v5
    s_nop 0
    v_add_f32 v20, v20, v22
    v_add_f32 v21, v21, v23
    v_smfmac_f32_16x16x64_bf16 v[24:27], v[40:43], a[32:39], v5
    v_cvt_pk_bf16_f32 v18, v16, v20
    v_cvt_pk_bf16_f32 v19, v17, v21
    v_smfmac_f32_16x16x64_bf16 v[28:31], v[40:43], a[40:47], v5
    ds_write2_b32 v112, v18, v19 offset0:0 offset1:72
    v_smfmac_f32_16x16x64_bf16 v[24:27], v[52:55], a[80:87], v5
    v_smfmac_f32_16x16x64_bf16 v[28:31], v[52:55], a[88:95], v5
    s_xor_b32 s29, s29, 128
    buffer_load_dword v10, off, s[4:7], s29 sc1
    v_smfmac_f32_16x16x64_bf16 v[24:27], v[48:51], a[64:71], v5
    v_smfmac_f32_16x16x64_bf16 v[28:31], v[48:51], a[72:79], v5
    v_smfmac_f32_16x16x64_bf16 v[24:27], v[60:63], a[112:119], v5
    s_waitcnt lgkmcnt(0)
    s_barrier
    v_smfmac_f32_16x16x64_bf16 v[24:27], v[56:59], a[96:103], v5
    ds_read_b128 v[64:67], v4 offset:16384
    v_smfmac_f32_16x16x64_bf16 v[28:31], v[60:63], a[120:127], v5
    ds_read_b128 v[68:71], v4 offset:16448
    v_smfmac_f32_16x16x64_bf16 v[28:31], v[56:59], a[104:111], v5
    ds_read_b128 v[96:99], v4 offset:16512
    v_add_f32 v24, v24, v26
    v_smfmac_f32_16x16x64_bf16 v[120:123], v[52:55], a[208:215], v5
    ds_read_b128 v[100:103], v4 offset:16576
    v_add_f32 v25, v25, v27
    s_waitcnt lgkmcnt(3)
    v_mfma_f32_16x16x32_bf16 v[112:115], v[72:75], v[64:67], 0
    s_nop 0
    v_add_f32 v28, v28, v30
    v_add_f32 v29, v29, v31
    v_mfma_f32_16x16x32_bf16 v[116:119], v[76:79], v[64:67], 0
    v_cvt_pk_bf16_f32 v20, v24, v28
    v_cvt_pk_bf16_f32 v21, v25, v29
    s_waitcnt lgkmcnt(2)
    v_mfma_f32_16x16x32_bf16 v[112:115], v[80:83], v[68:71], v[112:115]
    ds_write2_b32 v3, v20, v21 offset0:0 offset1:72
    v_mfma_f32_16x16x32_bf16 v[116:119], v[84:87], v[68:71], v[116:119]
    s_waitcnt lgkmcnt(2)
    v_mfma_f32_16x16x32_bf16 v[112:115], v[88:91], v[96:99], v[112:115]
    v_mfma_f32_16x16x32_bf16 v[116:119], v[92:95], v[96:99], v[116:119]
    v_mov_b64 v[88:89], s[32:33]
    v_mov_b64 v[90:91], s[32:33]
    s_waitcnt lgkmcnt(1)
    v_mfma_f32_16x16x32_bf16 v[112:115], v[104:107], v[100:103], v[112:115]
    v_mov_b32 v93, 0
    v_mov_b32 v94, 0
    v_mfma_f32_16x16x32_bf16 v[116:119], v[108:111], v[100:103], v[116:119]
    s_waitcnt lgkmcnt(0)
    s_barrier
    v_smfmac_f32_16x16x64_bf16 v[124:127], v[52:55], a[216:223], v5
    ds_read_b128 v[72:75], v4 offset:0
    v_max3_f32 v26, v112, v113, v114
    v_smfmac_f32_16x16x64_bf16 v[120:123], v[48:51], a[192:199], v5
    ds_read_b128 v[76:79], v4 offset:64
    v_max3_f32 v27, v115, v116, v117
    v_smfmac_f32_16x16x64_bf16 v[124:127], v[48:51], a[200:207], v5
    ds_read_b128 v[80:83], v4 offset:128
    v_max3_f32 v26, v118, v119, v26
    v_smfmac_f32_16x16x64_bf16 v[120:123], v[60:63], a[240:247], v5
    ds_read_b128 v[84:87], v4 offset:192
    v_max_f32 v26, v26, v27
    s_waitcnt lgkmcnt(3)
    v_mfma_f32_16x16x32_bf16 v[16:19], v[72:75], v[64:67], 0
    s_add_u32 m0, s22, 0
    s_waitcnt lgkmcnt(2)
    v_mfma_f32_16x16x32_bf16 v[16:19], v[76:79], v[68:71], v[16:19]
    ds_read_b128 v[64:67], v0 offset:36864
    s_waitcnt lgkmcnt(2)
    v_mfma_f32_16x16x32_bf16 v[16:19], v[80:83], v[96:99], v[16:19]
    ds_read_b128 v[68:71], v0 offset:40960
    s_waitcnt lgkmcnt(2)
    v_mfma_f32_16x16x32_bf16 v[16:19], v[84:87], v[100:103], v[16:19]
    ds_read_b128 v[72:75], v0 offset:20480
    v_smfmac_f32_16x16x64_bf16 v[124:127], v[60:63], a[248:255], v5
    ds_read_b128 v[76:79], v0 offset:24576
    s_nop 3
    v_max3_f32 v27, v18, v19, v26
    v_max3_f32 v26, v16, v17, v26
    v_smfmac_f32_16x16x64_bf16 v[120:123], v[56:59], a[224:231], v5
    ds_read_b128 v[80:83], v0 offset:28672
    v_permlane32_swap_b32 v26, v27
    v_max_f32 v26, v26, v27
    v_mov_b32 v27, v26
    v_smfmac_f32_16x16x64_bf16 v[124:127], v[56:59], a[232:239], v5
    ds_read_b128 v[84:87], v0 offset:32768
    v_permlane16_swap_b32 v26, v27
    v_max_f32 v26, v26, v27
    v_mul_f32 v26, s30, v26
    v_fma_f32 v112, v112, s30, -v26
    v_fma_f32 v113, v113, s30, -v26
    v_smfmac_f32_16x16x64_bf16 v[120:123], v[44:47], a[176:183], v5
    buffer_load_dwordx4 v0, s[4:7], s23 offen sc1 lds
    v_exp_f32 v112, v112
    v_exp_f32 v113, v113
    v_smfmac_f32_16x16x64_bf16 v[120:123], v[40:43], a[160:167], v5
    ds_read_b128 v[96:99], v0 offset:45056
    v_fma_f32 v114, v114, s30, -v26
    v_fma_f32 v115, v115, s30, -v26
    s_add_u32 m0, s22, 4096
    v_smfmac_f32_16x16x64_bf16 v[124:127], v[44:47], a[184:191], v5
    ds_read_b128 v[100:103], v0 offset:49152
    v_exp_f32 v114, v114
    v_exp_f32 v115, v115
    v_smfmac_f32_16x16x64_bf16 v[124:127], v[40:43], a[168:175], v5
    buffer_load_dwordx4 v0, s[4:7], s24 offen sc1 lds
    v_cvt_pk_bf16_f32 v104, v112, v113
    v_fma_f32 v116, v116, s30, -v26
    v_fma_f32 v117, v117, s30, -v26
    v_exp_f32 v116, v116
    v_exp_f32 v117, v117
    v_cvt_pk_bf16_f32 v105, v114, v115
    v_fma_f32 v118, v118, s30, -v26
    v_fma_f32 v119, v119, s30, -v26
    v_exp_f32 v118, v118
    v_exp_f32 v119, v119
    v_cvt_pk_bf16_f32 v106, v116, v117
    v_fma_f32 v16, v16, s30, -v26
    v_fma_f32 v17, v17, s30, -v26
    v_exp_f32 v16, v16
    v_exp_f32 v17, v17
    v_cvt_pk_bf16_f32 v107, v118, v119
    v_cvt_pk_bf16_f32 v92, v16, v17
    s_nop 0
    v_mfma_f32_16x16x32_bf16 v[108:111], v[88:91], v[104:107], 0
    v_cvt_pk_bf16_f32 v95, v16, v17
    v_add_f32 v120, v120, v122
    v_mfma_f32_16x16x32_bf16 v[24:27], v[128:131], v[104:107], 0
    v_add_f32 v121, v121, v123
    v_add_f32 v124, v124, v126
    v_mfma_f32_16x16x32_bf16 v[28:31], v[132:135], v[104:107], 0
    v_add_f32 v125, v125, v127
    v_cvt_pk_bf16_f32 v22, v120, v121
    v_mfma_f32_16x16x16_bf16 v[108:111], v[88:89], v[92:93], v[108:111]
    v_cvt_pk_bf16_f32 v23, v124, v125
    v_mov_b64 v[48:49], 0
    v_mov_b64 v[50:51], 0
    v_mfma_f32_16x16x16_bf16 v[24:27], v[22:23], v[92:93], v[24:27]
    s_cmp_eq_u32 s12, 63
    s_cbranch_scc1 L_last
    v_mov_b64 v[52:53], 0
    v_mov_b64 v[54:55], 0
    v_mfma_f32_16x16x16_bf16 v[28:31], v[22:23], v[94:95], v[28:31]
    v_rcp_f32 v108, v108
    v_mov_b64 v[56:57], 0
    v_mov_b64 v[58:59], 0
    v_mov_b64 v[60:61], 0
    v_mov_b64 v[62:63], 0
    v_pk_mul_f32 v[24:25], v[24:25], v[108:109] op_sel_hi:[1,0]
    v_pk_mul_f32 v[26:27], v[26:27], v[108:109] op_sel_hi:[1,0]
    s_nop 0
    v_pk_mul_f32 v[28:29], v[28:29], v[108:109] op_sel_hi:[1,0]
    v_pk_mul_f32 v[30:31], v[30:31], v[108:109] op_sel_hi:[1,0]
    v_cvt_pk_bf16_f32 v32, v24, v25
    v_cvt_pk_bf16_f32 v33, v26, v27
    v_cvt_pk_bf16_f32 v34, v28, v29
    v_cvt_pk_bf16_f32 v35, v30, v31
    ds_write_b128 v0, v[32:35] offset:16384
    s_add_u32 s28, s28, 8192
    s_add_u32 s12, s12, 1
    v_smfmac_f32_16x16x64_bf16 v[48:51], v[32:35], v[200:207], v5
    buffer_load_dwordx4 v[128:131], v0, s[4:7], s25 offen sc1
    v_xor_b32 v24, 1024, v0
    v_smfmac_f32_16x16x64_bf16 v[52:55], v[32:35], v[208:215], v5
    ds_read_b128 v[112:115], v0 offset:53248
    v_xor_b32 v25, 2048, v0
    v_smfmac_f32_16x16x64_bf16 v[56:59], v[32:35], v[216:223], v5
    ds_read_b128 v[116:119], v0 offset:57344
    v_xor_b32 v26, 3072, v0
    v_smfmac_f32_16x16x64_bf16 v[60:63], v[32:35], v[224:231], v5
    ds_read_b128 v[120:123], v0 offset:61440
    s_waitcnt lgkmcnt(3)
    s_barrier
    ds_read_b128 v[36:39], v24 offset:16384
    ds_read_b128 v[40:43], v25 offset:16384
    ds_read_b128 v[44:47], v26 offset:16384
    ds_read_b128 v[124:127], v1 offset:0
    buffer_load_dwordx4 v[132:135], v0, s[4:7], s26 offen sc1
    s_waitcnt lgkmcnt(3)
    v_smfmac_f32_16x16x64_bf16 v[48:51], v[36:39], v[232:239], v5
    ds_read_b128 v[88:91], v1 offset:4096
    v_smfmac_f32_16x16x64_bf16 v[52:55], v[36:39], v[240:247], v5
    ds_read_b128 v[92:95], v1 offset:8192
    s_waitcnt lgkmcnt(4)
    v_smfmac_f32_16x16x64_bf16 v[48:51], v[40:43], v[248:255], v5
    ds_read_b128 v[104:107], v1 offset:12288
    v_smfmac_f32_16x16x64_bf16 v[52:55], v[40:43], v[72:79], v5
    ds_read_b128 v[108:111], v1 offset:16384
    s_waitcnt lgkmcnt(5)
    v_smfmac_f32_16x16x64_bf16 v[48:51], v[44:47], v[80:87], v5
    ds_read_b128 v[16:19], v1 offset:20480
    v_smfmac_f32_16x16x64_bf16 v[52:55], v[44:47], v[64:71], v5
    ds_read_b128 v[20:23], v1 offset:24576
    v_smfmac_f32_16x16x64_bf16 v[56:59], v[36:39], v[96:103], v5
    s_nop 0
    v_cvt_pk_bf16_f32 v32, v48, v50
    v_smfmac_f32_16x16x64_bf16 v[60:63], v[36:39], v[112:119], v5
    v_cvt_pk_bf16_f32 v33, v49, v51
    s_waitcnt lgkmcnt(6)
    v_smfmac_f32_16x16x64_bf16 v[56:59], v[40:43], v[120:127], v5
    v_cvt_pk_bf16_f32 v34, v52, v54
    s_waitcnt lgkmcnt(4)
    v_smfmac_f32_16x16x64_bf16 v[60:63], v[40:43], v[88:95], v5
    v_cvt_pk_bf16_f32 v35, v53, v55
    v_bfi_b32 v32, 1, s18, v32
    s_waitcnt lgkmcnt(2)
    v_smfmac_f32_16x16x64_bf16 v[56:59], v[44:47], v[104:111], v5
    buffer_store_dwordx4 v[32:35], v6, s[4:7], s16 offen offset:0
    s_waitcnt lgkmcnt(0)
    v_smfmac_f32_16x16x64_bf16 v[60:63], v[44:47], v[16:23], v5
    s_nop 4
    v_cvt_pk_bf16_f32 v36, v56, v58
    v_cvt_pk_bf16_f32 v37, v57, v59
    v_bfi_b32 v36, 1, s18, v36
    v_cvt_pk_bf16_f32 v38, v60, v62
    v_cvt_pk_bf16_f32 v39, v61, v63
    buffer_store_dwordx4 v[36:39], v6, s[4:7], s16 offen offset:64
    s_mov_b32 s42, 0
    ds_read_b128 v[64:67], v1 offset:28672
    ds_read_b128 v[68:71], v1 offset:45056
    ds_read_b128 v[72:75], v1 offset:32768
    ds_read_b128 v[76:79], v1 offset:49152
    ds_read_b128 v[80:83], v1 offset:61440
    ds_read_b128 v[84:87], v9 offset:12288
    ds_read_b128 v[88:91], v9 offset:0
    ds_read_b128 v[92:95], v9 offset:16384
    ds_read_b128 v[112:115], v9 offset:8192
    ds_read_b128 v[116:119], v9 offset:24576
    ds_read_b128 v[104:107], v9 offset:4096
    ds_read_b128 v[108:111], v9 offset:20480
    ds_read_b128 v[96:99], v1 offset:36864
    ds_read_b128 v[100:103], v1 offset:53248
    s_waitcnt lgkmcnt(0)
    s_cmp_ge_u32 s13, 2
    s_cbranch_scc1 L_idle
    s_nop 7
    s_nop 7
    s_nop 7
    s_nop 7
    s_nop 5
L_poll1:
    buffer_load_dwordx4 v[40:43], v7, s[4:7], s8 offen sc1
    buffer_load_dwordx4 v[44:47], v7, s[4:7], s9 offen sc1
    buffer_load_dwordx4 v[48:51], v7, s[4:7], s10 offen sc1
    buffer_load_dwordx4 v[52:55], v7, s[4:7], s11 offen sc1
    s_waitcnt vmcnt(3)
    v_mfma_f32_16x16x32_bf16 v[60:63], v[12:15], v[40:43], 0
    s_waitcnt vmcnt(2)
    v_mfma_f32_16x16x32_bf16 v[60:63], v[12:15], v[44:47], v[60:63]
    v_bitop3_b32 v58, v40, v44, s18 bitop3:0x7e
    s_waitcnt vmcnt(1)
    v_mfma_f32_16x16x32_bf16 v[60:63], v[12:15], v[48:51], v[60:63]
    s_waitcnt vmcnt(0)
    v_mfma_f32_16x16x32_bf16 v[60:63], v[12:15], v[52:55], v[60:63]
    v_bitop3_b32 v59, v48, v52, s18 bitop3:0x7e
    v_bitop3_b32 v58, v58, v59, 1 bitop3:0xa8
    v_cmp_ne_u32 vcc, 0, v58
    s_cbranch_vccnz L_retry1
    s_nop 3
    v_add_f32_dpp v60, v60, v60 row_ror:8 row_mask:0xf bank_mask:0xf
    v_add_f32_dpp v61, v61, v61 row_ror:8 row_mask:0xf bank_mask:0xf
    v_cvt_pk_bf16_f32 v58, v60, v61
    v_bfi_b32 v58, v2, s18, v58
    buffer_store_dword v58, v8, s[4:7], s19 offen
L_skip1:
    s_barrier
    v_mov_b64 v[16:17], 0
    v_mov_b64 v[18:19], 0
    v_mov_b64 v[20:21], 0
    v_mov_b64 v[22:23], 0
    v_mov_b64 v[24:25], 0
    v_mov_b64 v[26:27], 0
    v_mov_b64 v[28:29], 0
    v_mov_b64 v[30:31], 0
    v_mov_b64 v[120:121], 0
    v_mov_b64 v[122:123], 0
    v_mov_b64 v[124:125], 0
    v_mov_b64 v[126:127], 0
    s_mov_b32 s42, 0
    buffer_load_dwordx4 v[32:35], v0, s[4:7], s20 offen sc1
    buffer_load_dwordx4 v[36:39], v0, s[4:7], s21 offen sc1
    v_xor_b32 v40, 1024, v0
    v_xor_b32 v48, 2048, v0
    v_xor_b32 v56, 3072, v0
    v_lshlrev_b32 v61, 3, v11
    s_nop 7
    s_nop 7
    s_nop 7
    s_nop 7
    s_nop 7
    buffer_load_dwordx4 v[32:35], v0, s[4:7], s20 offen sc1
    buffer_load_dwordx4 v[36:39], v0, s[4:7], s21 offen sc1
    s_waitcnt lgkmcnt(0)
    s_branch L_arr
L_last:
    buffer_store_dwordx4 v[20:23], v0, s[4:7], s40 offen sc1
    s_branch L_ch_exit
L_idle:
    s_waitcnt vmcnt(6)
    v_cmp_gt_u32 vcc, s74, v10
    s_cbranch_vccnz L_kvwait
L_kvok:
    s_add_u32 s74, s74, 1
    s_min_u32 s74, s74, 63
    s_branch L_skip1
L_retry1:
    s_add_u32 s42, s42, 1
    s_cmp_lt_u32 s42, 2097152
    s_cbranch_scc1 L_poll1
    s_branch L_fail
L_retry2:
    buffer_load_dwordx4 v[32:35], v0, s[4:7], s20 offen sc1
    buffer_load_dwordx4 v[36:39], v0, s[4:7], s21 offen sc1
    s_add_u32 s42, s42, 1
    s_waitcnt lgkmcnt(0)
    v_mov_b64 v[16:17], 0
    v_mov_b64 v[18:19], 0
    s_nop 0
    v_mov_b64 v[20:21], 0
    v_mov_b64 v[22:23], 0
    s_cmp_lt_u32 s42, 2097152
    s_cbranch_scc1 L_arr
    s_branch L_fail
L_kvwait:
    s_mov_b32 s42, 0
L_kvw2:
    buffer_load_dword v10, off, s[4:7], s29 sc1
    s_waitcnt vmcnt(0)
    v_cmp_gt_u32 vcc, s74, v10
    s_cbranch_vccz L_kvok
    s_add_u32 s42, s42, 1
    s_cmp_lt_u32 s42, 2097152
    s_cbranch_scc1 L_kvw2
    s_branch L_fail
L_first_s:
    ds_write_b128 v0, v[32:35] offset:0
    v_smfmac_f32_16x16x64_bf16 v[16:19], v[32:35], v[64:71], v5
    ds_write_b128 v0, v[36:39] offset:4096
    v_smfmac_f32_16x16x64_bf16 v[20:23], v[32:35], v[72:79], v5
    v_smfmac_f32_16x16x64_bf16 v[16:19], v[36:39], v[80:87], v5
    v_smfmac_f32_16x16x64_bf16 v[20:23], v[36:39], v[88:95], v5
    s_branch L_arrok_s
L_arr_s:
    s_waitcnt vmcnt(2)
    v_bitop3_b32 v44, v35, v39, s18 bitop3:0x7e
    ds_write_b128 v0, v[32:35] offset:0
    v_smfmac_f32_16x16x64_bf16 v[16:19], v[32:35], v[64:71], v5
    ds_write_b128 v0, v[36:39] offset:4096
    v_and_b32 v44, 1, v44
    v_smfmac_f32_16x16x64_bf16 v[20:23], v[32:35], v[72:79], v5
    v_cmp_ne_u32 vcc, 0, v44
    v_smfmac_f32_16x16x64_bf16 v[16:19], v[36:39], v[80:87], v5
    v_smfmac_f32_16x16x64_bf16 v[20:23], v[36:39], v[88:95], v5
    s_cbranch_vccnz L_retry2_s
L_arrok_s:
    s_waitcnt lgkmcnt(0)
    s_barrier
    ds_read_b128 v[44:47], v40 offset:4096
    ds_read_b128 v[40:43], v40 offset:0
    ds_read_b128 v[64:67], v1 offset:40960
    v_smfmac_f32_16x16x64_bf16 v[24:27], v[32:35], a[0:7], v5
    ds_read_b128 v[68:71], v1 offset:57344
    v_smfmac_f32_16x16x64_bf16 v[28:31], v[32:35], a[8:15], v5
    ds_read_b128 v[52:55], v48 offset:4096
    s_add_u32 s23, s23, 524288
    v_smfmac_f32_16x16x64_bf16 v[24:27], v[36:39], a[16:23], v5
    ds_read_b128 v[48:51], v48 offset:0
    s_not_b32 s18, s18
    v_smfmac_f32_16x16x64_bf16 v[28:31], v[36:39], a[24:31], v5
    ds_read_b128 v[60:63], v56 offset:4096
    v_smfmac_f32_16x16x64_bf16 v[120:123], v[32:35], a[128:135], v5
    ds_read_b128 v[56:59], v56 offset:0
    v_smfmac_f32_16x16x64_bf16 v[124:127], v[32:35], a[136:143], v5
    ds_read_b128 v[72:75], v11 offset:8192
    v_smfmac_f32_16x16x64_bf16 v[120:123], v[36:39], a[144:151], v5
    ds_read_b128 v[76:79], v11 offset:12288
    v_smfmac_f32_16x16x64_bf16 v[124:127], v[36:39], a[152:159], v5
    ds_read_b128 v[80:83], v11 offset:9216
    s_waitcnt lgkmcnt(10)
    v_smfmac_f32_16x16x64_bf16 v[16:19], v[44:47], v[104:111], v5
    ds_read_b128 v[84:87], v11 offset:13312
    v_smfmac_f32_16x16x64_bf16 v[20:23], v[44:47], v[112:119], v5
    ds_read_b128 v[88:91], v11 offset:10240
    s_waitcnt lgkmcnt(11)
    v_smfmac_f32_16x16x64_bf16 v[16:19], v[40:43], v[96:103], v5
    ds_read_b128 v[92:95], v11 offset:14336
    s_waitcnt lgkmcnt(10)
    v_smfmac_f32_16x16x64_bf16 v[20:23], v[40:43], v[64:71], v5
    ds_read_b128 v[104:107], v11 offset:11264
    s_waitcnt lgkmcnt(10)
    v_smfmac_f32_16x16x64_bf16 v[16:19], v[52:55], v[152:159], v5
    ds_read_b128 v[108:111], v11 offset:15360
    v_smfmac_f32_16x16x64_bf16 v[20:23], v[52:55], v[160:167], v5
    s_waitcnt vmcnt(0)
    s_mov_b64 exec, s[34:35]
    s_waitcnt lgkmcnt(10)
    v_smfmac_f32_16x16x64_bf16 v[16:19], v[48:51], v[136:143], v5
    buffer_store_dwordx4 v[32:35], v0, s[4:7], s28 offen sc1
    s_mov_b64 exec, -1
    v_smfmac_f32_16x16x64_bf16 v[20:23], v[48:51], v[144:151], v5
    s_add_u32 s24, s23, 4096
    s_add_u32 s25, s23, 8192
    s_waitcnt lgkmcnt(9)
    v_smfmac_f32_16x16x64_bf16 v[16:19], v[60:63], v[184:191], v5
    s_add_u32 s26, s23, 12288
    v_add_u32 v112, 16384, v3
    s_waitcnt lgkmcnt(8)
    v_smfmac_f32_16x16x64_bf16 v[16:19], v[56:59], v[168:175], v5
    s_mov_b32 m0, 159744
    s_add_u32 s27, s27, 524288
    v_lshlrev_b32 v113, 3, v11
    v_smfmac_f32_16x16x64_bf16 v[20:23], v[60:63], v[192:199], v5
    buffer_load_dword v113, s[4:7], s27 offen sc1 lds
    v_smfmac_f32_16x16x64_bf16 v[20:23], v[56:59], v[176:183], v5
    s_nop 0
    v_add_f32 v16, v16, v18
    v_smfmac_f32_16x16x64_bf16 v[24:27], v[44:47], a[48:55], v5
    v_add_f32 v17, v17, v19
    v_smfmac_f32_16x16x64_bf16 v[28:31], v[44:47], a[56:63], v5
    s_nop 0
    v_add_f32 v20, v20, v22
    v_add_f32 v21, v21, v23
    v_smfmac_f32_16x16x64_bf16 v[24:27], v[40:43], a[32:39], v5
    v_cvt_pk_bf16_f32 v18, v16, v20
    v_cvt_pk_bf16_f32 v19, v17, v21
    v_smfmac_f32_16x16x64_bf16 v[28:31], v[40:43], a[40:47], v5
    ds_write2_b32 v112, v18, v19 offset0:0 offset1:72
    v_smfmac_f32_16x16x64_bf16 v[24:27], v[52:55], a[80:87], v5
    v_smfmac_f32_16x16x64_bf16 v[28:31], v[52:55], a[88:95], v5
    s_xor_b32 s29, s29, 128
    buffer_load_dword v10, off, s[4:7], s29 sc1
    v_smfmac_f32_16x16x64_bf16 v[24:27], v[48:51], a[64:71], v5
    v_smfmac_f32_16x16x64_bf16 v[28:31], v[48:51], a[72:79], v5
    v_smfmac_f32_16x16x64_bf16 v[24:27], v[60:63], a[112:119], v5
    s_waitcnt lgkmcnt(0)
    s_barrier
    v_smfmac_f32_16x16x64_bf16 v[24:27], v[56:59], a[96:103], v5
    ds_read_b128 v[64:67], v4 offset:16384
    v_smfmac_f32_16x16x64_bf16 v[28:31], v[60:63], a[120:127], v5
    ds_read_b128 v[68:71], v4 offset:16448
    v_smfmac_f32_16x16x64_bf16 v[28:31], v[56:59], a[104:111], v5
    ds_read_b128 v[96:99], v4 offset:16512
    v_add_f32 v24, v24, v26
    v_smfmac_f32_16x16x64_bf16 v[120:123], v[52:55], a[208:215], v5
    ds_read_b128 v[100:103], v4 offset:16576
    v_add_f32 v25, v25, v27
    s_waitcnt lgkmcnt(3)
    v_mfma_f32_16x16x32_bf16 v[112:115], v[72:75], v[64:67], 0
    s_nop 0
    v_add_f32 v28, v28, v30
    v_add_f32 v29, v29, v31
    v_mfma_f32_16x16x32_bf16 v[116:119], v[76:79], v[64:67], 0
    v_cvt_pk_bf16_f32 v20, v24, v28
    v_cvt_pk_bf16_f32 v21, v25, v29
    s_waitcnt lgkmcnt(2)
    v_mfma_f32_16x16x32_bf16 v[112:115], v[80:83], v[68:71], v[112:115]
    ds_write2_b32 v3, v20, v21 offset0:0 offset1:72
    v_mfma_f32_16x16x32_bf16 v[116:119], v[84:87], v[68:71], v[116:119]
    s_waitcnt lgkmcnt(2)
    v_mfma_f32_16x16x32_bf16 v[112:115], v[88:91], v[96:99], v[112:115]
    v_mfma_f32_16x16x32_bf16 v[116:119], v[92:95], v[96:99], v[116:119]
    v_mov_b64 v[88:89], s[32:33]
    v_mov_b64 v[90:91], s[32:33]
    s_waitcnt lgkmcnt(1)
    v_mfma_f32_16x16x32_bf16 v[112:115], v[104:107], v[100:103], v[112:115]
    v_mov_b32 v93, 0
    v_mov_b32 v94, 0
    v_mfma_f32_16x16x32_bf16 v[116:119], v[108:111], v[100:103], v[116:119]
    s_waitcnt lgkmcnt(0)
    s_barrier
    v_smfmac_f32_16x16x64_bf16 v[124:127], v[52:55], a[216:223], v5
    ds_read_b128 v[72:75], v4 offset:0
    v_max3_f32 v26, v112, v113, v114
    v_smfmac_f32_16x16x64_bf16 v[120:123], v[48:51], a[192:199], v5
    ds_read_b128 v[76:79], v4 offset:64
    v_max3_f32 v27, v115, v116, v117
    v_smfmac_f32_16x16x64_bf16 v[124:127], v[48:51], a[200:207], v5
    ds_read_b128 v[80:83], v4 offset:128
    v_max3_f32 v26, v118, v119, v26
    v_smfmac_f32_16x16x64_bf16 v[120:123], v[60:63], a[240:247], v5
    ds_read_b128 v[84:87], v4 offset:192
    v_max_f32 v26, v26, v27
    s_waitcnt lgkmcnt(3)
    v_mfma_f32_16x16x32_bf16 v[16:19], v[72:75], v[64:67], 0
    s_add_u32 m0, s22, 0
    s_waitcnt lgkmcnt(2)
    v_mfma_f32_16x16x32_bf16 v[16:19], v[76:79], v[68:71], v[16:19]
    ds_read_b128 v[64:67], v0 offset:36864
    s_waitcnt lgkmcnt(2)
    v_mfma_f32_16x16x32_bf16 v[16:19], v[80:83], v[96:99], v[16:19]
    ds_read_b128 v[68:71], v0 offset:40960
    s_waitcnt lgkmcnt(2)
    v_mfma_f32_16x16x32_bf16 v[16:19], v[84:87], v[100:103], v[16:19]
    ds_read_b128 v[72:75], v0 offset:20480
    v_smfmac_f32_16x16x64_bf16 v[124:127], v[60:63], a[248:255], v5
    ds_read_b128 v[76:79], v0 offset:24576
    s_nop 3
    v_max3_f32 v27, v18, v19, v26
    v_max3_f32 v26, v16, v17, v26
    v_smfmac_f32_16x16x64_bf16 v[120:123], v[56:59], a[224:231], v5
    ds_read_b128 v[80:83], v0 offset:28672
    v_permlane32_swap_b32 v26, v27
    v_max_f32 v26, v26, v27
    v_mov_b32 v27, v26
    v_smfmac_f32_16x16x64_bf16 v[124:127], v[56:59], a[232:239], v5
    ds_read_b128 v[84:87], v0 offset:32768
    v_permlane16_swap_b32 v26, v27
    v_max_f32 v26, v26, v27
    v_mul_f32 v26, s30, v26
    v_fma_f32 v112, v112, s30, -v26
    v_fma_f32 v113, v113, s30, -v26
    v_smfmac_f32_16x16x64_bf16 v[120:123], v[44:47], a[176:183], v5
    buffer_load_dwordx4 v0, s[4:7], s23 offen sc1 lds
    v_exp_f32 v112, v112
    v_exp_f32 v113, v113
    v_smfmac_f32_16x16x64_bf16 v[120:123], v[40:43], a[160:167], v5
    ds_read_b128 v[96:99], v0 offset:45056
    v_fma_f32 v114, v114, s30, -v26
    v_fma_f32 v115, v115, s30, -v26
    s_add_u32 m0, s22, 4096
    v_smfmac_f32_16x16x64_bf16 v[124:127], v[44:47], a[184:191], v5
    ds_read_b128 v[100:103], v0 offset:49152
    v_exp_f32 v114, v114
    v_exp_f32 v115, v115
    v_smfmac_f32_16x16x64_bf16 v[124:127], v[40:43], a[168:175], v5
    buffer_load_dwordx4 v0, s[4:7], s24 offen sc1 lds
    v_cvt_pk_bf16_f32 v104, v112, v113
    v_fma_f32 v116, v116, s30, -v26
    v_fma_f32 v117, v117, s30, -v26
    v_exp_f32 v116, v116
    v_exp_f32 v117, v117
    v_cvt_pk_bf16_f32 v105, v114, v115
    v_fma_f32 v118, v118, s30, -v26
    v_fma_f32 v119, v119, s30, -v26
    v_exp_f32 v118, v118
    v_exp_f32 v119, v119
    v_cvt_pk_bf16_f32 v106, v116, v117
    v_fma_f32 v16, v16, s30, -v26
    v_fma_f32 v17, v17, s30, -v26
    v_exp_f32 v16, v16
    v_exp_f32 v17, v17
    v_cvt_pk_bf16_f32 v107, v118, v119
    v_cvt_pk_bf16_f32 v92, v16, v17
    s_nop 0
    v_mfma_f32_16x16x32_bf16 v[108:111], v[88:91], v[104:107], 0
    v_cvt_pk_bf16_f32 v95, v16, v17
    v_add_f32 v120, v120, v122
    v_mfma_f32_16x16x32_bf16 v[24:27], v[128:131], v[104:107], 0
    v_add_f32 v121, v121, v123
    v_add_f32 v124, v124, v126
    v_mfma_f32_16x16x32_bf16 v[28:31], v[132:135], v[104:107], 0
    v_add_f32 v125, v125, v127
    v_cvt_pk_bf16_f32 v22, v120, v121
    v_mfma_f32_16x16x16_bf16 v[108:111], v[88:89], v[92:93], v[108:111]
    v_cvt_pk_bf16_f32 v23, v124, v125
    v_mov_b64 v[48:49], 0
    v_mov_b64 v[50:51], 0
    v_mfma_f32_16x16x16_bf16 v[24:27], v[22:23], v[92:93], v[24:27]
    s_cmp_eq_u32 s12, 63
    s_cbranch_scc1 L_last_s
    v_mov_b64 v[52:53], 0
    v_mov_b64 v[54:55], 0
    v_mfma_f32_16x16x16_bf16 v[28:31], v[22:23], v[94:95], v[28:31]
    v_rcp_f32 v108, v108
    v_mov_b64 v[56:57], 0
    v_mov_b64 v[58:59], 0
    v_mov_b64 v[60:61], 0
    v_mov_b64 v[62:63], 0
    v_pk_mul_f32 v[24:25], v[24:25], v[108:109] op_sel_hi:[1,0]
    v_pk_mul_f32 v[26:27], v[26:27], v[108:109] op_sel_hi:[1,0]
    s_nop 0
    v_pk_mul_f32 v[28:29], v[28:29], v[108:109] op_sel_hi:[1,0]
    v_pk_mul_f32 v[30:31], v[30:31], v[108:109] op_sel_hi:[1,0]
    v_cvt_pk_bf16_f32 v32, v24, v25
    v_cvt_pk_bf16_f32 v33, v26, v27
    v_cvt_pk_bf16_f32 v34, v28, v29
    v_cvt_pk_bf16_f32 v35, v30, v31
    ds_write_b128 v0, v[32:35] offset:16384
    s_add_u32 s28, s28, 8192
    s_add_u32 s12, s12, 1
    v_smfmac_f32_16x16x64_bf16 v[48:51], v[32:35], v[200:207], v5
    buffer_load_dwordx4 v[128:131], v0, s[4:7], s25 offen sc1
    v_xor_b32 v24, 1024, v0
    v_smfmac_f32_16x16x64_bf16 v[52:55], v[32:35], v[208:215], v5
    ds_read_b128 v[112:115], v0 offset:53248
    v_xor_b32 v25, 2048, v0
    v_smfmac_f32_16x16x64_bf16 v[56:59], v[32:35], v[216:223], v5
    ds_read_b128 v[116:119], v0 offset:57344
    v_xor_b32 v26, 3072, v0
    v_smfmac_f32_16x16x64_bf16 v[60:63], v[32:35], v[224:231], v5
    ds_read_b128 v[120:123], v0 offset:61440
    s_waitcnt lgkmcnt(3)
    s_barrier
    ds_read_b128 v[36:39], v24 offset:16384
    ds_read_b128 v[40:43], v25 offset:16384
    ds_read_b128 v[44:47], v26 offset:16384
    ds_read_b128 v[124:127], v1 offset:0
    buffer_load_dwordx4 v[132:135], v0, s[4:7], s26 offen sc1
    s_waitcnt lgkmcnt(3)
    v_smfmac_f32_16x16x64_bf16 v[48:51], v[36:39], v[232:239], v5
    ds_read_b128 v[88:91], v1 offset:4096
    v_smfmac_f32_16x16x64_bf16 v[52:55], v[36:39], v[240:247], v5
    ds_read_b128 v[92:95], v1 offset:8192
    s_waitcnt lgkmcnt(4)
    v_smfmac_f32_16x16x64_bf16 v[48:51], v[40:43], v[248:255], v5
    ds_read_b128 v[104:107], v1 offset:12288
    v_smfmac_f32_16x16x64_bf16 v[52:55], v[40:43], v[72:79], v5
    ds_read_b128 v[108:111], v1 offset:16384
    s_waitcnt lgkmcnt(5)
    v_smfmac_f32_16x16x64_bf16 v[48:51], v[44:47], v[80:87], v5
    ds_read_b128 v[16:19], v1 offset:20480
    v_smfmac_f32_16x16x64_bf16 v[52:55], v[44:47], v[64:71], v5
    ds_read_b128 v[20:23], v1 offset:24576
    v_smfmac_f32_16x16x64_bf16 v[56:59], v[36:39], v[96:103], v5
    s_nop 0
    v_cvt_pk_bf16_f32 v32, v48, v50
    v_smfmac_f32_16x16x64_bf16 v[60:63], v[36:39], v[112:119], v5
    v_cvt_pk_bf16_f32 v33, v49, v51
    s_waitcnt lgkmcnt(6)
    v_smfmac_f32_16x16x64_bf16 v[56:59], v[40:43], v[120:127], v5
    v_cvt_pk_bf16_f32 v34, v52, v54
    s_waitcnt lgkmcnt(4)
    v_smfmac_f32_16x16x64_bf16 v[60:63], v[40:43], v[88:95], v5
    v_cvt_pk_bf16_f32 v35, v53, v55
    v_bfi_b32 v32, 1, s18, v32
    s_waitcnt lgkmcnt(2)
    v_smfmac_f32_16x16x64_bf16 v[56:59], v[44:47], v[104:111], v5
    buffer_store_dwordx4 v[32:35], v6, s[4:7], s16 offen offset:0 sc1
    s_waitcnt lgkmcnt(0)
    v_smfmac_f32_16x16x64_bf16 v[60:63], v[44:47], v[16:23], v5
    s_nop 4
    v_cvt_pk_bf16_f32 v36, v56, v58
    v_cvt_pk_bf16_f32 v37, v57, v59
    v_bfi_b32 v36, 1, s18, v36
    v_cvt_pk_bf16_f32 v38, v60, v62
    v_cvt_pk_bf16_f32 v39, v61, v63
    buffer_store_dwordx4 v[36:39], v6, s[4:7], s16 offen offset:64 sc1
    s_mov_b32 s42, 0
    ds_read_b128 v[64:67], v1 offset:28672
    ds_read_b128 v[68:71], v1 offset:45056
    ds_read_b128 v[72:75], v1 offset:32768
    ds_read_b128 v[76:79], v1 offset:49152
    ds_read_b128 v[80:83], v1 offset:61440
    ds_read_b128 v[84:87], v9 offset:12288
    ds_read_b128 v[88:91], v9 offset:0
    ds_read_b128 v[92:95], v9 offset:16384
    ds_read_b128 v[112:115], v9 offset:8192
    ds_read_b128 v[116:119], v9 offset:24576
    ds_read_b128 v[104:107], v9 offset:4096
    ds_read_b128 v[108:111], v9 offset:20480
    ds_read_b128 v[96:99], v1 offset:36864
    ds_read_b128 v[100:103], v1 offset:53248
    s_waitcnt lgkmcnt(0)
    s_cmp_ge_u32 s13, 2
    s_cbranch_scc1 L_idle_s
    s_nop 7
    s_nop 7
    s_nop 7
    s_nop 7
    s_nop 5
L_poll1_s:
    buffer_load_dwordx4 v[40:43], v7, s[4:7], s8 offen sc1
    buffer_load_dwordx4 v[44:47], v7, s[4:7], s9 offen sc1
    buffer_load_dwordx4 v[48:51], v7, s[4:7], s10 offen sc1
    buffer_load_dwordx4 v[52:55], v7, s[4:7], s11 offen sc1
    s_waitcnt vmcnt(3)
    v_mfma_f32_16x16x32_bf16 v[60:63], v[12:15], v[40:43], 0
    s_waitcnt vmcnt(2)
    v_mfma_f32_16x16x32_bf16 v[60:63], v[12:15], v[44:47], v[60:63]
    v_bitop3_b32 v58, v40, v44, s18 bitop3:0x7e
    s_waitcnt vmcnt(1)
    v_mfma_f32_16x16x32_bf16 v[60:63], v[12:15], v[48:51], v[60:63]
    s_waitcnt vmcnt(0)
    v_mfma_f32_16x16x32_bf16 v[60:63], v[12:15], v[52:55], v[60:63]
    v_bitop3_b32 v59, v48, v52, s18 bitop3:0x7e
    v_bitop3_b32 v58, v58, v59, 1 bitop3:0xa8
    v_cmp_ne_u32 vcc, 0, v58
    s_cbranch_vccnz L_retry1_s
    s_nop 3
    v_add_f32_dpp v60, v60, v60 row_ror:8 row_mask:0xf bank_mask:0xf
    v_add_f32_dpp v61, v61, v61 row_ror:8 row_mask:0xf bank_mask:0xf
    v_cvt_pk_bf16_f32 v58, v60, v61
    v_bfi_b32 v58, v2, s18, v58
    buffer_store_dword v58, v8, s[4:7], s19 offen sc1
L_skip1_s:
    s_barrier
    v_mov_b64 v[16:17], 0
    v_mov_b64 v[18:19], 0
    v_mov_b64 v[20:21], 0
    v_mov_b64 v[22:23], 0
    v_mov_b64 v[24:25], 0
    v_mov_b64 v[26:27], 0
    v_mov_b64 v[28:29], 0
    v_mov_b64 v[30:31], 0
    v_mov_b64 v[120:121], 0
    v_mov_b64 v[122:123], 0
    v_mov_b64 v[124:125], 0
    v_mov_b64 v[126:127], 0
    s_mov_b32 s42, 0
    buffer_load_dwordx4 v[32:35], v0, s[4:7], s20 offen sc1
    buffer_load_dwordx4 v[36:39], v0, s[4:7], s21 offen sc1
    v_xor_b32 v40, 1024, v0
    v_xor_b32 v48, 2048, v0
    v_xor_b32 v56, 3072, v0
    v_lshlrev_b32 v61, 3, v11
    s_nop 7
    s_nop 7
    s_nop 7
    s_nop 7
    s_nop 7
    buffer_load_dwordx4 v[32:35], v0, s[4:7], s20 offen sc1
    buffer_load_dwordx4 v[36:39], v0, s[4:7], s21 offen sc1
    s_waitcnt lgkmcnt(0)
    s_branch L_arr_s
L_last_s:
    buffer_store_dwordx4 v[20:23], v0, s[4:7], s40 offen sc1
    s_branch L_ch_exit
L_idle_s:
    s_waitcnt vmcnt(6)
    v_cmp_gt_u32 vcc, s74, v10
    s_cbranch_vccnz L_kvwait_s
L_kvok_s:
    s_add_u32 s74, s74, 1
    s_min_u32 s74, s74, 63
    s_branch L_skip1_s
L_retry1_s:
    s_add_u32 s42, s42, 1
    s_cmp_lt_u32 s42, 2097152
    s_cbranch_scc1 L_poll1_s
    s_branch L_fail
L_retry2_s:
    buffer_load_dwordx4 v[32:35], v0, s[4:7], s20 offen sc1
    buffer_load_dwordx4 v[36:39], v0, s[4:7], s21 offen sc1
    s_add_u32 s42, s42, 1
    s_waitcnt lgkmcnt(0)
    v_mov_b64 v[16:17], 0
    v_mov_b64 v[18:19], 0
    s_nop 0
    v_mov_b64 v[20:21], 0
    v_mov_b64 v[22:23], 0
    s_cmp_lt_u32 s42, 2097152
    s_cbranch_scc1 L_arr_s
    s_branch L_fail
L_kvwait_s:
    s_mov_b32 s42, 0
L_kvw2_s:
    buffer_load_dword v10, off, s[4:7], s29 sc1
    s_waitcnt vmcnt(0)
    v_cmp_gt_u32 vcc, s74, v10
    s_cbranch_vccz L_kvok_s
    s_add_u32 s42, s42, 1
    s_cmp_lt_u32 s42, 2097152
    s_cbranch_scc1 L_kvw2_s
    s_branch L_fail
L_ch_exit:
    s_waitcnt lgkmcnt(0)
    s_branch L_done
L_roles:
    s_and_b32 s15, s14, 1
    s_lshr_b32 s14, s14, 1
    s_sub_u32 s9, s3, 1
    s_mul_i32 s8, s14, 6
    s_add_u32 s8, s8, s9
    s_cmp_lt_u32 s8, 96
    s_cselect_b32 s8, s8, 102
    s_add_u32 s14, s14, 96
    s_cmp_eq_u32 s3, 7
    s_cselect_b32 s14, s14, s8
    s_cmp_lt_u32 s14, 32
    s_cbranch_scc1 L_role_kv
    s_sub_u32 s14, s14, 32
    s_cmp_lt_u32 s14, 32
    s_cbranch_scc1 L_role_att
    s_sub_u32 s14, s14, 32
    s_cmp_lt_u32 s14, 22
    s_cbranch_scc1 L_role_ffn
    s_sub_u32 s14, s14, 22
    s_cmp_lt_u32 s14, 16
    s_cbranch_scc0 L_end
    s_lshl_b32 s14, s14, 1
    s_add_u32 s14, s14, s15
    s_mov_b32 s44, s84
    s_mov_b32 s45, s85
    s_mov_b32 s46, 0x300000
    s_mov_b32 s47, 0x00020000
    s_mov_b32 s48, s60
    s_mov_b32 s49, s61
    s_mov_b32 s50, 0x200000
    s_mov_b32 s51, 0x00020000
    s_mov_b32 s52, s82
    s_mov_b32 s53, s83
    s_mov_b32 s54, 0x400
    s_mov_b32 s55, 0x00020000
    s_mov_b32 s60, s86
    s_mov_b32 s61, s87
    s_mov_b32 s62, 0x200000
    s_mov_b32 s63, 0x00020000
    v_and_b32 v1, 63, v0
    v_lshlrev_b32 v2, 4, v1
    s_lshl_b32 s43, s13, 10
    v_add_u32 v3, s43, v2
    s_mov_b32 s66, 0x05040100
    s_mov_b32 s67, 0x07060302
    s_mov_b32 s19, 0x3b000000
    s_mov_b32 s20, 0x3727c5ac
    s_mov_b32 s30, 0xbfb8aa3b
    s_lshl_b32 s18, s14, 16
    s_lshl_b32 s43, s13, 14
    s_add_u32 s18, s18, s43
    s_cmp_eq_u32 s13, 0
    s_cbranch_scc0 L_r_w3
    buffer_load_dwordx4 v[16:19], v2, s[52:55], 0 offen
    v_bfe_u32 v4, v1, 2, 4
    v_mul_u32_u24 v8, 6144, v4
    v_bfe_u32 v4, v1, 0, 2
    v_lshl_add_u32 v8, v4, 4, v8
    v_bfe_u32 v4, v1, 5, 1
    v_lshlrev_b32 v9, 10, v4
    v_bfe_u32 v4, v1, 4, 1
    v_lshl_add_u32 v9, v4, 9, v9
    v_bfe_u32 v4, v1, 2, 2
    v_lshl_add_u32 v9, v4, 6, v9
    v_bfe_u32 v4, v1, 0, 2
    v_lshl_add_u32 v9, v4, 3, v9
    s_mul_i32 s17, s13, 32768
    v_add_u32 v9, s17, v9
    s_lshl_b32 s16, s13, 11
    s_lshl_b32 s43, s14, 6
    s_add_u32 s16, s16, s43
    s_add_u32 s43, s16, 0x0
    s_add_u32 m0, s17, 0
    s_nop 0
    buffer_load_dwordx4 v8, s[44:47], s43 offen lds
    s_add_u32 s43, s16, 0x18000
    s_add_u32 m0, s17, 1024
    s_nop 0
    buffer_load_dwordx4 v8, s[44:47], s43 offen lds
    s_add_u32 s43, s16, 0x30000
    s_add_u32 m0, s17, 2048
    s_nop 0
    buffer_load_dwordx4 v8, s[44:47], s43 offen lds
    s_add_u32 s43, s16, 0x48000
    s_add_u32 m0, s17, 3072
    s_nop 0
    buffer_load_dwordx4 v8, s[44:47], s43 offen lds
    s_add_u32 s43, s16, 0x60000
    s_add_u32 m0, s17, 4096
    s_nop 0
    buffer_load_dwordx4 v8, s[44:47], s43 offen lds
    s_add_u32 s43, s16, 0x78000
    s_add_u32 m0, s17, 5120
    s_nop 0
    buffer_load_dwordx4 v8, s[44:47], s43 offen lds
    s_add_u32 s43, s16, 0x90000
    s_add_u32 m0, s17, 6144
    s_nop 0
    buffer_load_dwordx4 v8, s[44:47], s43 offen lds
    s_add_u32 s43, s16, 0xa8000
    s_add_u32 m0, s17, 7168
    s_nop 0
    buffer_load_dwordx4 v8, s[44:47], s43 offen lds
    s_add_u32 s43, s16, 0xc0000
    s_add_u32 m0, s17, 8192
    s_nop 0
    buffer_load_dwordx4 v8, s[44:47], s43 offen lds
    s_add_u32 s43, s16, 0xd8000
    s_add_u32 m0, s17, 9216
    s_nop 0
    buffer_load_dwordx4 v8, s[44:47], s43 offen lds
    s_add_u32 s43, s16, 0xf0000
    s_add_u32 m0, s17, 10240
    s_nop 0
    buffer_load_dwordx4 v8, s[44:47], s43 offen lds
    s_add_u32 s43, s16, 0x108000
    s_add_u32 m0, s17, 11264
    s_nop 0
    buffer_load_dwordx4 v8, s[44:47], s43 offen lds
    s_add_u32 s43, s16, 0x120000
    s_add_u32 m0, s17, 12288
    s_nop 0
    buffer_load_dwordx4 v8, s[44:47], s43 offen lds
    s_add_u32 s43, s16, 0x138000
    s_add_u32 m0, s17, 13312
    s_nop 0
    buffer_load_dwordx4 v8, s[44:47], s43 offen lds
    s_add_u32 s43, s16, 0x150000
    s_add_u32 m0, s17, 14336
    s_nop 0
    buffer_load_dwordx4 v8, s[44:47], s43 offen lds
    s_add_u32 s43, s16, 0x168000
    s_add_u32 m0, s17, 15360
    s_nop 0
    buffer_load_dwordx4 v8, s[44:47], s43 offen lds
    s_add_u32 s43, s16, 0x180000
    s_add_u32 m0, s17, 16384
    s_nop 0
    buffer_load_dwordx4 v8, s[44:47], s43 offen lds
    s_add_u32 s43, s16, 0x198000
    s_add_u32 m0, s17, 17408
    s_nop 0
    buffer_load_dwordx4 v8, s[44:47], s43 offen lds
    s_add_u32 s43, s16, 0x1b0000
    s_add_u32 m0, s17, 18432
    s_nop 0
    buffer_load_dwordx4 v8, s[44:47], s43 offen lds
    s_add_u32 s43, s16, 0x1c8000
    s_add_u32 m0, s17, 19456
    s_nop 0
    buffer_load_dwordx4 v8, s[44:47], s43 offen lds
    s_add_u32 s43, s16, 0x1e0000
    s_add_u32 m0, s17, 20480
    s_nop 0
    buffer_load_dwordx4 v8, s[44:47], s43 offen lds
    s_add_u32 s43, s16, 0x1f8000
    s_add_u32 m0, s17, 21504
    s_nop 0
    buffer_load_dwordx4 v8, s[44:47], s43 offen lds
    s_add_u32 s43, s16, 0x210000
    s_add_u32 m0, s17, 22528
    s_nop 0
    buffer_load_dwordx4 v8, s[44:47], s43 offen lds
    s_add_u32 s43, s16, 0x228000
    s_add_u32 m0, s17, 23552
    s_nop 0
    buffer_load_dwordx4 v8, s[44:47], s43 offen lds
    s_add_u32 s43, s16, 0x240000
    s_add_u32 m0, s17, 24576
    s_nop 0
    buffer_load_dwordx4 v8, s[44:47], s43 offen lds
    s_add_u32 s43, s16, 0x258000
    s_add_u32 m0, s17, 25600
    s_nop 0
    buffer_load_dwordx4 v8, s[44:47], s43 offen lds
    s_add_u32 s43, s16, 0x270000
    s_add_u32 m0, s17, 26624
    s_nop 0
    buffer_load_dwordx4 v8, s[44:47], s43 offen lds
    s_add_u32 s43, s16, 0x288000
    s_add_u32 m0, s17, 27648
    s_nop 0
    buffer_load_dwordx4 v8, s[44:47], s43 offen lds
    s_add_u32 s43, s16, 0x2a0000
    s_add_u32 m0, s17, 28672
    s_nop 0
    buffer_load_dwordx4 v8, s[44:47], s43 offen lds
    s_add_u32 s43, s16, 0x2b8000
    s_add_u32 m0, s17, 29696
    s_nop 0
    buffer_load_dwordx4 v8, s[44:47], s43 offen lds
    s_add_u32 s43, s16, 0x2d0000
    s_add_u32 m0, s17, 30720
    s_nop 0
    buffer_load_dwordx4 v8, s[44:47], s43 offen lds
    s_add_u32 s43, s16, 0x2e8000
    s_add_u32 m0, s17, 31744
    s_nop 0
    buffer_load_dwordx4 v8, s[44:47], s43 offen lds
    s_add_u32 s43, s18, 0
    buffer_load_dwordx4 v[192:195], v2, s[48:51], s43 offen offset:0
    buffer_load_dwordx4 v[196:199], v2, s[48:51], s43 offen offset:1024
    buffer_load_dwordx4 v[200:203], v2, s[48:51], s43 offen offset:2048
    buffer_load_dwordx4 v[204:207], v2, s[48:51], s43 offen offset:3072
    s_add_u32 s43, s18, 4096
    buffer_load_dwordx4 v[208:211], v2, s[48:51], s43 offen offset:0
    buffer_load_dwordx4 v[212:215], v2, s[48:51], s43 offen offset:1024
    buffer_load_dwordx4 v[216:219], v2, s[48:51], s43 offen offset:2048
    buffer_load_dwordx4 v[220:223], v2, s[48:51], s43 offen offset:3072
    s_add_u32 s43, s18, 8192
    buffer_load_dwordx4 v[224:227], v2, s[48:51], s43 offen offset:0
    buffer_load_dwordx4 v[228:231], v2, s[48:51], s43 offen offset:1024
    buffer_load_dwordx4 v[232:235], v2, s[48:51], s43 offen offset:2048
    buffer_load_dwordx4 v[236:239], v2, s[48:51], s43 offen offset:3072
    s_add_u32 s43, s18, 12288
    buffer_load_dwordx4 v[240:243], v2, s[48:51], s43 offen offset:0
    buffer_load_dwordx4 v[244:247], v2, s[48:51], s43 offen offset:1024
    buffer_load_dwordx4 v[248:251], v2, s[48:51], s43 offen offset:2048
    buffer_load_dwordx4 v[252:255], v2, s[48:51], s43 offen offset:3072
    s_waitcnt vmcnt(48)
    v_lshlrev_b32 v24, 16, v16
    v_and_b32 v25, 0xffff0000, v16
    v_lshlrev_b32 v26, 16, v17
    v_and_b32 v27, 0xffff0000, v17
    v_lshlrev_b32 v28, 16, v18
    v_and_b32 v29, 0xffff0000, v18
    v_lshlrev_b32 v30, 16, v19
    v_and_b32 v31, 0xffff0000, v19
    v_mul_f32 v32, s30, v24
    v_mul_f32 v33, s30, v25
    v_mul_f32 v34, s30, v26
    v_mul_f32 v35, s30, v27
    v_mul_f32 v36, s30, v28
    v_mul_f32 v37, s30, v29
    v_mul_f32 v38, s30, v30
    v_mul_f32 v39, s30, v31
    v_exp_f32 v32, v32
    v_exp_f32 v33, v33
    v_exp_f32 v34, v34
    v_exp_f32 v35, v35
    v_exp_f32 v36, v36
    v_exp_f32 v37, v37
    v_exp_f32 v38, v38
    v_exp_f32 v39, v39
    v_add_f32 v32, 1.0, v32
    v_add_f32 v33, 1.0, v33
    v_add_f32 v34, 1.0, v34
    v_add_f32 v35, 1.0, v35
    v_add_f32 v36, 1.0, v36
    v_add_f32 v37, 1.0, v37
    v_add_f32 v38, 1.0, v38
    v_add_f32 v39, 1.0, v39
    v_rcp_f32 v32, v32
    v_rcp_f32 v33, v33
    v_rcp_f32 v34, v34
    v_rcp_f32 v35, v35
    v_rcp_f32 v36, v36
    v_rcp_f32 v37, v37
    v_rcp_f32 v38, v38
    v_rcp_f32 v39, v39
    v_mul_f32 v32, v32, v24
    v_mul_f32 v33, v33, v25
    v_mul_f32 v34, v34, v26
    v_mul_f32 v35, v35, v27
    v_mul_f32 v36, v36, v28
    v_mul_f32 v37, v37, v29
    v_mul_f32 v38, v38, v30
    v_mul_f32 v39, v39, v31
    v_cvt_pk_bf16_f32 v16, v32, v33
    v_cvt_pk_bf16_f32 v17, v34, v35
    v_cvt_pk_bf16_f32 v18, v36, v37
    v_cvt_pk_bf16_f32 v19, v38, v39
    v_add_u32 v14, 0x20000, v3
    ds_write_b128 v14, v[16:19]
    v_bfe_u32 v4, v1, 4, 2
    v_lshlrev_b32 v14, 4, v4
    s_lshl_b32 s43, s13, 10
    s_add_u32 s43, s43, 0x20000
    v_add_u32 v14, s43, v14
    s_waitcnt lgkmcnt(0)
    ds_read_b128 v[64:67], v14 offset:0
    ds_read_b128 v[68:71], v14 offset:64
    ds_read_b128 v[72:75], v14 offset:128
    ds_read_b128 v[76:79], v14 offset:192
    ds_read_b128 v[80:83], v14 offset:256
    ds_read_b128 v[84:87], v14 offset:320
    ds_read_b128 v[88:91], v14 offset:384
    ds_read_b128 v[92:95], v14 offset:448
    ds_read_b128 v[96:99], v14 offset:512
    ds_read_b128 v[100:103], v14 offset:576
    ds_read_b128 v[104:107], v14 offset:640
    ds_read_b128 v[108:111], v14 offset:704
    ds_read_b128 v[112:115], v14 offset:768
    ds_read_b128 v[116:119], v14 offset:832
    ds_read_b128 v[120:123], v14 offset:896
    ds_read_b128 v[124:127], v14 offset:960
    s_waitcnt lgkmcnt(0)
    s_waitcnt vmcnt(46)
    ds_read_b64_tr_b16 a[0:1], v9 offset:0
    ds_read_b64_tr_b16 a[2:3], v9 offset:256
    ds_read_b64_tr_b16 a[4:5], v9 offset:32
    ds_read_b64_tr_b16 a[6:7], v9 offset:288
    s_waitcnt vmcnt(44)
    ds_read_b64_tr_b16 a[8:9], v9 offset:2048
    ds_read_b64_tr_b16 a[10:11], v9 offset:2304
    ds_read_b64_tr_b16 a[12:13], v9 offset:2080
    ds_read_b64_tr_b16 a[14:15], v9 offset:2336
    s_waitcnt vmcnt(42)
    ds_read_b64_tr_b16 a[16:17], v9 offset:4096
    ds_read_b64_tr_b16 a[18:19], v9 offset:4352
    ds_read_b64_tr_b16 a[20:21], v9 offset:4128
    ds_read_b64_tr_b16 a[22:23], v9 offset:4384
    s_waitcnt vmcnt(40)
    ds_read_b64_tr_b16 a[24:25], v9 offset:6144
    ds_read_b64_tr_b16 a[26:27], v9 offset:6400
    ds_read_b64_tr_b16 a[28:29], v9 offset:6176
    ds_read_b64_tr_b16 a[30:31], v9 offset:6432
    s_waitcnt vmcnt(38)
    ds_read_b64_tr_b16 a[32:33], v9 offset:8192
    ds_read_b64_tr_b16 a[34:35], v9 offset:8448
    ds_read_b64_tr_b16 a[36:37], v9 offset:8224
    ds_read_b64_tr_b16 a[38:39], v9 offset:8480
    s_waitcnt vmcnt(36)
    ds_read_b64_tr_b16 a[40:41], v9 offset:10240
    ds_read_b64_tr_b16 a[42:43], v9 offset:10496
    ds_read_b64_tr_b16 a[44:45], v9 offset:10272
    ds_read_b64_tr_b16 a[46:47], v9 offset:10528
    s_waitcnt vmcnt(34)
    ds_read_b64_tr_b16 a[48:49], v9 offset:12288
    ds_read_b64_tr_b16 a[50:51], v9 offset:12544
    ds_read_b64_tr_b16 a[52:53], v9 offset:12320
    ds_read_b64_tr_b16 a[54:55], v9 offset:12576
    s_waitcnt vmcnt(32)
    ds_read_b64_tr_b16 a[56:57], v9 offset:14336
    ds_read_b64_tr_b16 a[58:59], v9 offset:14592
    ds_read_b64_tr_b16 a[60:61], v9 offset:14368
    ds_read_b64_tr_b16 a[62:63], v9 offset:14624
    s_waitcnt vmcnt(30)
    ds_read_b64_tr_b16 a[64:65], v9 offset:16384
    ds_read_b64_tr_b16 a[66:67], v9 offset:16640
    ds_read_b64_tr_b16 a[68:69], v9 offset:16416
    ds_read_b64_tr_b16 a[70:71], v9 offset:16672
    s_waitcnt vmcnt(28)
    ds_read_b64_tr_b16 a[72:73], v9 offset:18432
    ds_read_b64_tr_b16 a[74:75], v9 offset:18688
    ds_read_b64_tr_b16 a[76:77], v9 offset:18464
    ds_read_b64_tr_b16 a[78:79], v9 offset:18720
    s_waitcnt vmcnt(26)
    ds_read_b64_tr_b16 a[80:81], v9 offset:20480
    ds_read_b64_tr_b16 a[82:83], v9 offset:20736
    ds_read_b64_tr_b16 a[84:85], v9 offset:20512
    ds_read_b64_tr_b16 a[86:87], v9 offset:20768
    s_waitcnt vmcnt(24)
    ds_read_b64_tr_b16 a[88:89], v9 offset:22528
    ds_read_b64_tr_b16 a[90:91], v9 offset:22784
    ds_read_b64_tr_b16 a[92:93], v9 offset:22560
    ds_read_b64_tr_b16 a[94:95], v9 offset:22816
    s_waitcnt vmcnt(22)
    ds_read_b64_tr_b16 a[96:97], v9 offset:24576
    ds_read_b64_tr_b16 a[98:99], v9 offset:24832
    ds_read_b64_tr_b16 a[100:101], v9 offset:24608
    ds_read_b64_tr_b16 a[102:103], v9 offset:24864
    s_waitcnt vmcnt(20)
    ds_read_b64_tr_b16 a[104:105], v9 offset:26624
    ds_read_b64_tr_b16 a[106:107], v9 offset:26880
    ds_read_b64_tr_b16 a[108:109], v9 offset:26656
    ds_read_b64_tr_b16 a[110:111], v9 offset:26912
    s_waitcnt vmcnt(18)
    ds_read_b64_tr_b16 a[112:113], v9 offset:28672
    ds_read_b64_tr_b16 a[114:115], v9 offset:28928
    ds_read_b64_tr_b16 a[116:117], v9 offset:28704
    ds_read_b64_tr_b16 a[118:119], v9 offset:28960
    s_waitcnt vmcnt(16)
    ds_read_b64_tr_b16 a[120:121], v9 offset:30720
    ds_read_b64_tr_b16 a[122:123], v9 offset:30976
    ds_read_b64_tr_b16 a[124:125], v9 offset:30752
    ds_read_b64_tr_b16 a[126:127], v9 offset:31008
    s_waitcnt lgkmcnt(0)
    v_mfma_f32_16x16x32_bf16 v[16:19], a[0:3], v[64:67], 0
    v_mfma_f32_16x16x32_bf16 v[20:23], a[4:7], v[64:67], 0
    v_mfma_f32_16x16x32_bf16 v[16:19], a[8:11], v[68:71], v[16:19]
    v_mfma_f32_16x16x32_bf16 v[20:23], a[12:15], v[68:71], v[20:23]
    v_mfma_f32_16x16x32_bf16 v[16:19], a[16:19], v[72:75], v[16:19]
    v_mfma_f32_16x16x32_bf16 v[20:23], a[20:23], v[72:75], v[20:23]
    v_mfma_f32_16x16x32_bf16 v[16:19], a[24:27], v[76:79], v[16:19]
    v_mfma_f32_16x16x32_bf16 v[20:23], a[28:31], v[76:79], v[20:23]
    v_mfma_f32_16x16x32_bf16 v[16:19], a[32:35], v[80:83], v[16:19]
    v_mfma_f32_16x16x32_bf16 v[20:23], a[36:39], v[80:83], v[20:23]
    v_mfma_f32_16x16x32_bf16 v[16:19], a[40:43], v[84:87], v[16:19]
    v_mfma_f32_16x16x32_bf16 v[20:23], a[44:47], v[84:87], v[20:23]
    v_mfma_f32_16x16x32_bf16 v[16:19], a[48:51], v[88:91], v[16:19]
    v_mfma_f32_16x16x32_bf16 v[20:23], a[52:55], v[88:91], v[20:23]
    v_mfma_f32_16x16x32_bf16 v[16:19], a[56:59], v[92:95], v[16:19]
    v_mfma_f32_16x16x32_bf16 v[20:23], a[60:63], v[92:95], v[20:23]
    v_mfma_f32_16x16x32_bf16 v[16:19], a[64:67], v[96:99], v[16:19]
    v_mfma_f32_16x16x32_bf16 v[20:23], a[68:71], v[96:99], v[20:23]
    v_mfma_f32_16x16x32_bf16 v[16:19], a[72:75], v[100:103], v[16:19]
    v_mfma_f32_16x16x32_bf16 v[20:23], a[76:79], v[100:103], v[20:23]
    v_mfma_f32_16x16x32_bf16 v[16:19], a[80:83], v[104:107], v[16:19]
    v_mfma_f32_16x16x32_bf16 v[20:23], a[84:87], v[104:107], v[20:23]
    v_mfma_f32_16x16x32_bf16 v[16:19], a[88:91], v[108:111], v[16:19]
    v_mfma_f32_16x16x32_bf16 v[20:23], a[92:95], v[108:111], v[20:23]
    v_mfma_f32_16x16x32_bf16 v[16:19], a[96:99], v[112:115], v[16:19]
    v_mfma_f32_16x16x32_bf16 v[20:23], a[100:103], v[112:115], v[20:23]
    v_mfma_f32_16x16x32_bf16 v[16:19], a[104:107], v[116:119], v[16:19]
    v_mfma_f32_16x16x32_bf16 v[20:23], a[108:111], v[116:119], v[20:23]
    v_mfma_f32_16x16x32_bf16 v[16:19], a[112:115], v[120:123], v[16:19]
    v_mfma_f32_16x16x32_bf16 v[20:23], a[116:119], v[120:123], v[20:23]
    v_mfma_f32_16x16x32_bf16 v[16:19], a[120:123], v[124:127], v[16:19]
    v_mfma_f32_16x16x32_bf16 v[20:23], a[124:127], v[124:127], v[20:23]
    v_bfe_u32 v4, v1, 0, 1
    v_lshlrev_b32 v14, 5, v4
    v_bfe_u32 v4, v1, 4, 2
    v_lshl_add_u32 v14, v4, 3, v14
    v_and_b32 v4, 15, v1
    v_cmp_gt_u32 vcc, 2, v4
    v_mov_b32 v5, 0x7fff0000
    s_nop 0
    v_cndmask_b32 v14, v5, v14, vcc
    v_cmp_eq_u32 vcc, 1, v4
    v_cvt_pk_bf16_f32 v24, v16, v17
    v_cvt_pk_bf16_f32 v25, v18, v19
    v_cvt_pk_bf16_f32 v26, v20, v21
    v_cvt_pk_bf16_f32 v27, v22, v23
    v_cndmask_b32 v24, v24, v26, vcc
    v_cndmask_b32 v25, v25, v27, vcc
    s_add_u32 s29, s16, 0x3e00000
    buffer_store_dwordx2 v[24:25], v14, s[4:7], s29 offen sc1
    s_waitcnt vmcnt(0)
    s_min_u32 s64, s13, 1
    s_lshl_b32 s64, s64, 6
    v_mov_b32 v5, s64
    v_mov_b32 v4, 1
    s_mov_b64 exec, 1
    global_atomic_add v5, v4, s[92:93] offset:0
    s_mov_b64 exec, -1
    s_branch L_r_w12
L_r_w3:
    s_add_u32 s43, s18, 0
    buffer_load_dwordx4 v[192:195], v2, s[48:51], s43 offen offset:0
    buffer_load_dwordx4 v[196:199], v2, s[48:51], s43 offen offset:1024
    buffer_load_dwordx4 v[200:203], v2, s[48:51], s43 offen offset:2048
    buffer_load_dwordx4 v[204:207], v2, s[48:51], s43 offen offset:3072
    s_add_u32 s43, s18, 4096
    buffer_load_dwordx4 v[208:211], v2, s[48:51], s43 offen offset:0
    buffer_load_dwordx4 v[212:215], v2, s[48:51], s43 offen offset:1024
    buffer_load_dwordx4 v[216:219], v2, s[48:51], s43 offen offset:2048
    buffer_load_dwordx4 v[220:223], v2, s[48:51], s43 offen offset:3072
    s_add_u32 s43, s18, 8192
    buffer_load_dwordx4 v[224:227], v2, s[48:51], s43 offen offset:0
    buffer_load_dwordx4 v[228:231], v2, s[48:51], s43 offen offset:1024
    buffer_load_dwordx4 v[232:235], v2, s[48:51], s43 offen offset:2048
    buffer_load_dwordx4 v[236:239], v2, s[48:51], s43 offen offset:3072
    s_add_u32 s43, s18, 12288
    buffer_load_dwordx4 v[240:243], v2, s[48:51], s43 offen offset:0
    buffer_load_dwordx4 v[244:247], v2, s[48:51], s43 offen offset:1024
    buffer_load_dwordx4 v[248:251], v2, s[48:51], s43 offen offset:2048
    buffer_load_dwordx4 v[252:255], v2, s[48:51], s43 offen offset:3072
    s_cmp_eq_u32 s13, 3
    s_cbranch_scc0 L_r_w12
    v_mov_b32 v16, 0
    v_mov_b32 v17, 0
    v_mov_b32 v18, 0
    v_mov_b32 v19, 0
    s_lshl_b32 s16, s14, 10
    s_add_u32 s16, s16, 0x180000
    buffer_store_dwordx4 v[16:19], v2, s[4:7], s16 offen sc1
    s_add_u32 s16, s16, 32768
    buffer_store_dwordx4 v[16:19], v2, s[4:7], s16 offen sc1
    s_add_u32 s16, s16, 32768
    buffer_store_dwordx4 v[16:19], v2, s[4:7], s16 offen sc1
    s_add_u32 s16, s16, 32768
    buffer_store_dwordx4 v[16:19], v2, s[4:7], s16 offen sc1
    s_add_u32 s16, s16, 32768
    v_mov_b32 v20, -1
    v_mov_b32 v21, -1
    v_mov_b32 v22, -1
    v_mov_b32 v23, -1
    s_lshl_b32 s16, s14, 14
    s_add_u32 s16, s16, 0x3840000
    buffer_store_dwordx4 v[16:19], v2, s[4:7], s16 offen offset:0 sc1
    buffer_store_dwordx4 v[16:19], v2, s[4:7], s16 offen offset:1024 sc1
    buffer_store_dwordx4 v[16:19], v2, s[4:7], s16 offen offset:2048 sc1
    buffer_store_dwordx4 v[16:19], v2, s[4:7], s16 offen offset:3072 sc1
    s_add_u32 s16, s16, 4096
    buffer_store_dwordx4 v[16:19], v2, s[4:7], s16 offen offset:0 sc1
    buffer_store_dwordx4 v[16:19], v2, s[4:7], s16 offen offset:1024 sc1
    buffer_store_dwordx4 v[16:19], v2, s[4:7], s16 offen offset:2048 sc1
    buffer_store_dwordx4 v[16:19], v2, s[4:7], s16 offen offset:3072 sc1
    s_add_u32 s16, s16, 4096
    buffer_store_dwordx4 v[20:23], v2, s[4:7], s16 offen offset:0 sc1
    buffer_store_dwordx4 v[20:23], v2, s[4:7], s16 offen offset:1024 sc1
    buffer_store_dwordx4 v[20:23], v2, s[4:7], s16 offen offset:2048 sc1
    buffer_store_dwordx4 v[20:23], v2, s[4:7], s16 offen offset:3072 sc1
    s_add_u32 s16, s16, 4096
    buffer_store_dwordx4 v[20:23], v2, s[4:7], s16 offen offset:0 sc1
    buffer_store_dwordx4 v[20:23], v2, s[4:7], s16 offen offset:1024 sc1
    buffer_store_dwordx4 v[20:23], v2, s[4:7], s16 offen offset:2048 sc1
    buffer_store_dwordx4 v[20:23], v2, s[4:7], s16 offen offset:3072 sc1
    s_waitcnt vmcnt(0)
    v_mov_b32 v5, 0
    v_mov_b32 v4, 1
    s_mov_b64 exec, 1
    global_atomic_add v5, v4, s[92:93] offset:132
    s_mov_b64 exec, -1
L_r_w12:
    s_waitcnt vmcnt(0)
    v_lshlrev_b32 v64, 16, v192
    v_and_b32 v65, 0xffff0000, v192
    v_lshlrev_b32 v66, 16, v193
    v_and_b32 v67, 0xffff0000, v193
    v_lshlrev_b32 v68, 16, v194
    v_and_b32 v69, 0xffff0000, v194
    v_lshlrev_b32 v70, 16, v195
    v_and_b32 v71, 0xffff0000, v195
    v_lshlrev_b32 v72, 16, v196
    v_and_b32 v73, 0xffff0000, v196
    v_lshlrev_b32 v74, 16, v197
    v_and_b32 v75, 0xffff0000, v197
    v_lshlrev_b32 v76, 16, v198
    v_and_b32 v77, 0xffff0000, v198
    v_lshlrev_b32 v78, 16, v199
    v_and_b32 v79, 0xffff0000, v199
    v_lshlrev_b32 v80, 16, v200
    v_and_b32 v81, 0xffff0000, v200
    v_lshlrev_b32 v82, 16, v201
    v_and_b32 v83, 0xffff0000, v201
    v_lshlrev_b32 v84, 16, v202
    v_and_b32 v85, 0xffff0000, v202
    v_lshlrev_b32 v86, 16, v203
    v_and_b32 v87, 0xffff0000, v203
    v_lshlrev_b32 v88, 16, v204
    v_and_b32 v89, 0xffff0000, v204
    v_lshlrev_b32 v90, 16, v205
    v_and_b32 v91, 0xffff0000, v205
    v_lshlrev_b32 v92, 16, v206
    v_and_b32 v93, 0xffff0000, v206
    v_lshlrev_b32 v94, 16, v207
    v_and_b32 v95, 0xffff0000, v207
    v_lshlrev_b32 v96, 16, v208
    v_and_b32 v97, 0xffff0000, v208
    v_lshlrev_b32 v98, 16, v209
    v_and_b32 v99, 0xffff0000, v209
    v_lshlrev_b32 v100, 16, v210
    v_and_b32 v101, 0xffff0000, v210
    v_lshlrev_b32 v102, 16, v211
    v_and_b32 v103, 0xffff0000, v211
    v_lshlrev_b32 v104, 16, v212
    v_and_b32 v105, 0xffff0000, v212
    v_lshlrev_b32 v106, 16, v213
    v_and_b32 v107, 0xffff0000, v213
    v_lshlrev_b32 v108, 16, v214
    v_and_b32 v109, 0xffff0000, v214
    v_lshlrev_b32 v110, 16, v215
    v_and_b32 v111, 0xffff0000, v215
    v_lshlrev_b32 v112, 16, v216
    v_and_b32 v113, 0xffff0000, v216
    v_lshlrev_b32 v114, 16, v217
    v_and_b32 v115, 0xffff0000, v217
    v_lshlrev_b32 v116, 16, v218
    v_and_b32 v117, 0xffff0000, v218
    v_lshlrev_b32 v118, 16, v219
    v_and_b32 v119, 0xffff0000, v219
    v_lshlrev_b32 v120, 16, v220
    v_and_b32 v121, 0xffff0000, v220
    v_lshlrev_b32 v122, 16, v221
    v_and_b32 v123, 0xffff0000, v221
    v_lshlrev_b32 v124, 16, v222
    v_and_b32 v125, 0xffff0000, v222
    v_lshlrev_b32 v126, 16, v223
    v_and_b32 v127, 0xffff0000, v223
    v_add_f32 v16, v64, v65
    v_add_f32 v24, v66, v67
    v_add_f32 v17, v72, v73
    v_add_f32 v25, v74, v75
    v_add_f32 v18, v80, v81
    v_add_f32 v26, v82, v83
    v_add_f32 v19, v88, v89
    v_add_f32 v27, v90, v91
    v_add_f32 v20, v96, v97
    v_add_f32 v28, v98, v99
    v_add_f32 v21, v104, v105
    v_add_f32 v29, v106, v107
    v_add_f32 v22, v112, v113
    v_add_f32 v30, v114, v115
    v_add_f32 v23, v120, v121
    v_add_f32 v31, v122, v123
    v_add_f32 v16, v16, v68
    v_add_f32 v24, v24, v69
    v_add_f32 v17, v17, v76
    v_add_f32 v25, v25, v77
    v_add_f32 v18, v18, v84
    v_add_f32 v26, v26, v85
    v_add_f32 v19, v19, v92
    v_add_f32 v27, v27, v93
    v_add_f32 v20, v20, v100
    v_add_f32 v28, v28, v101
    v_add_f32 v21, v21, v108
    v_add_f32 v29, v29, v109
    v_add_f32 v22, v22, v116
    v_add_f32 v30, v30, v117
    v_add_f32 v23, v23, v124
    v_add_f32 v31, v31, v125
    v_add_f32 v16, v16, v70
    v_add_f32 v24, v24, v71
    v_add_f32 v17, v17, v78
    v_add_f32 v25, v25, v79
    v_add_f32 v18, v18, v86
    v_add_f32 v26, v26, v87
    v_add_f32 v19, v19, v94
    v_add_f32 v27, v27, v95
    v_add_f32 v20, v20, v102
    v_add_f32 v28, v28, v103
    v_add_f32 v21, v21, v110
    v_add_f32 v29, v29, v111
    v_add_f32 v22, v22, v118
    v_add_f32 v30, v30, v119
    v_add_f32 v23, v23, v126
    v_add_f32 v31, v31, v127
    v_add_f32 v16, v16, v24
    v_add_f32 v17, v17, v25
    v_add_f32 v18, v18, v26
    v_add_f32 v19, v19, v27
    v_add_f32 v20, v20, v28
    v_add_f32 v21, v21, v29
    v_add_f32 v22, v22, v30
    v_add_f32 v23, v23, v31
    v_add_f32_dpp v16, v16, v16 row_ror:8 row_mask:0xf bank_mask:0xf
    v_add_f32_dpp v17, v17, v17 row_ror:8 row_mask:0xf bank_mask:0xf
    v_add_f32_dpp v18, v18, v18 row_ror:8 row_mask:0xf bank_mask:0xf
    v_add_f32_dpp v19, v19, v19 row_ror:8 row_mask:0xf bank_mask:0xf
    v_add_f32_dpp v20, v20, v20 row_ror:8 row_mask:0xf bank_mask:0xf
    v_add_f32_dpp v21, v21, v21 row_ror:8 row_mask:0xf bank_mask:0xf
    v_add_f32_dpp v22, v22, v22 row_ror:8 row_mask:0xf bank_mask:0xf
    v_add_f32_dpp v23, v23, v23 row_ror:8 row_mask:0xf bank_mask:0xf
    v_add_f32_dpp v16, v16, v16 row_ror:4 row_mask:0xf bank_mask:0xf
    v_add_f32_dpp v17, v17, v17 row_ror:4 row_mask:0xf bank_mask:0xf
    v_add_f32_dpp v18, v18, v18 row_ror:4 row_mask:0xf bank_mask:0xf
    v_add_f32_dpp v19, v19, v19 row_ror:4 row_mask:0xf bank_mask:0xf
    v_add_f32_dpp v20, v20, v20 row_ror:4 row_mask:0xf bank_mask:0xf
    v_add_f32_dpp v21, v21, v21 row_ror:4 row_mask:0xf bank_mask:0xf
    v_add_f32_dpp v22, v22, v22 row_ror:4 row_mask:0xf bank_mask:0xf
    v_add_f32_dpp v23, v23, v23 row_ror:4 row_mask:0xf bank_mask:0xf
    v_add_f32_dpp v16, v16, v16 row_ror:2 row_mask:0xf bank_mask:0xf
    v_add_f32_dpp v17, v17, v17 row_ror:2 row_mask:0xf bank_mask:0xf
    v_add_f32_dpp v18, v18, v18 row_ror:2 row_mask:0xf bank_mask:0xf
    v_add_f32_dpp v19, v19, v19 row_ror:2 row_mask:0xf bank_mask:0xf
    v_add_f32_dpp v20, v20, v20 row_ror:2 row_mask:0xf bank_mask:0xf
    v_add_f32_dpp v21, v21, v21 row_ror:2 row_mask:0xf bank_mask:0xf
    v_add_f32_dpp v22, v22, v22 row_ror:2 row_mask:0xf bank_mask:0xf
    v_add_f32_dpp v23, v23, v23 row_ror:2 row_mask:0xf bank_mask:0xf
    v_add_f32_dpp v16, v16, v16 row_ror:1 row_mask:0xf bank_mask:0xf
    v_add_f32_dpp v17, v17, v17 row_ror:1 row_mask:0xf bank_mask:0xf
    v_add_f32_dpp v18, v18, v18 row_ror:1 row_mask:0xf bank_mask:0xf
    v_add_f32_dpp v19, v19, v19 row_ror:1 row_mask:0xf bank_mask:0xf
    v_add_f32_dpp v20, v20, v20 row_ror:1 row_mask:0xf bank_mask:0xf
    v_add_f32_dpp v21, v21, v21 row_ror:1 row_mask:0xf bank_mask:0xf
    v_add_f32_dpp v22, v22, v22 row_ror:1 row_mask:0xf bank_mask:0xf
    v_add_f32_dpp v23, v23, v23 row_ror:1 row_mask:0xf bank_mask:0xf
    v_mov_b32 v24, v16
    v_mov_b32 v25, v17
    v_mov_b32 v26, v18
    v_mov_b32 v27, v19
    v_mov_b32 v28, v20
    v_mov_b32 v29, v21
    v_mov_b32 v30, v22
    v_mov_b32 v31, v23
    v_permlane16_swap_b32 v16, v24
    v_permlane16_swap_b32 v17, v25
    v_permlane16_swap_b32 v18, v26
    v_permlane16_swap_b32 v19, v27
    v_permlane16_swap_b32 v20, v28
    v_permlane16_swap_b32 v21, v29
    v_permlane16_swap_b32 v22, v30
    v_permlane16_swap_b32 v23, v31
    v_add_f32 v16, v16, v24
    v_add_f32 v17, v17, v25
    v_add_f32 v18, v18, v26
    v_add_f32 v19, v19, v27
    v_add_f32 v20, v20, v28
    v_add_f32 v21, v21, v29
    v_add_f32 v22, v22, v30
    v_add_f32 v23, v23, v31
    v_mov_b32 v24, v16
    v_mov_b32 v25, v17
    v_mov_b32 v26, v18
    v_mov_b32 v27, v19
    v_mov_b32 v28, v20
    v_mov_b32 v29, v21
    v_mov_b32 v30, v22
    v_mov_b32 v31, v23
    v_permlane32_swap_b32 v16, v24
    v_permlane32_swap_b32 v17, v25
    v_permlane32_swap_b32 v18, v26
    v_permlane32_swap_b32 v19, v27
    v_permlane32_swap_b32 v20, v28
    v_permlane32_swap_b32 v21, v29
    v_permlane32_swap_b32 v22, v30
    v_permlane32_swap_b32 v23, v31
    v_add_f32 v16, v16, v24
    v_add_f32 v17, v17, v25
    v_add_f32 v18, v18, v26
    v_add_f32 v19, v19, v27
    v_add_f32 v20, v20, v28
    v_add_f32 v21, v21, v29
    v_add_f32 v22, v22, v30
    v_add_f32 v23, v23, v31
    v_mul_f32 v16, s19, v16
    v_mul_f32 v17, s19, v17
    v_mul_f32 v18, s19, v18
    v_mul_f32 v19, s19, v19
    v_mul_f32 v20, s19, v20
    v_mul_f32 v21, s19, v21
    v_mul_f32 v22, s19, v22
    v_mul_f32 v23, s19, v23
    v_sub_f32 v64, v64, v16
    v_sub_f32 v65, v65, v16
    v_sub_f32 v66, v66, v16
    v_sub_f32 v67, v67, v16
    v_sub_f32 v68, v68, v16
    v_sub_f32 v69, v69, v16
    v_sub_f32 v70, v70, v16
    v_sub_f32 v71, v71, v16
    v_sub_f32 v72, v72, v17
    v_sub_f32 v73, v73, v17
    v_sub_f32 v74, v74, v17
    v_sub_f32 v75, v75, v17
    v_sub_f32 v76, v76, v17
    v_sub_f32 v77, v77, v17
    v_sub_f32 v78, v78, v17
    v_sub_f32 v79, v79, v17
    v_sub_f32 v80, v80, v18
    v_sub_f32 v81, v81, v18
    v_sub_f32 v82, v82, v18
    v_sub_f32 v83, v83, v18
    v_sub_f32 v84, v84, v18
    v_sub_f32 v85, v85, v18
    v_sub_f32 v86, v86, v18
    v_sub_f32 v87, v87, v18
    v_sub_f32 v88, v88, v19
    v_sub_f32 v89, v89, v19
    v_sub_f32 v90, v90, v19
    v_sub_f32 v91, v91, v19
    v_sub_f32 v92, v92, v19
    v_sub_f32 v93, v93, v19
    v_sub_f32 v94, v94, v19
    v_sub_f32 v95, v95, v19
    v_sub_f32 v96, v96, v20
    v_sub_f32 v97, v97, v20
    v_sub_f32 v98, v98, v20
    v_sub_f32 v99, v99, v20
    v_sub_f32 v100, v100, v20
    v_sub_f32 v101, v101, v20
    v_sub_f32 v102, v102, v20
    v_sub_f32 v103, v103, v20
    v_sub_f32 v104, v104, v21
    v_sub_f32 v105, v105, v21
    v_sub_f32 v106, v106, v21
    v_sub_f32 v107, v107, v21
    v_sub_f32 v108, v108, v21
    v_sub_f32 v109, v109, v21
    v_sub_f32 v110, v110, v21
    v_sub_f32 v111, v111, v21
    v_sub_f32 v112, v112, v22
    v_sub_f32 v113, v113, v22
    v_sub_f32 v114, v114, v22
    v_sub_f32 v115, v115, v22
    v_sub_f32 v116, v116, v22
    v_sub_f32 v117, v117, v22
    v_sub_f32 v118, v118, v22
    v_sub_f32 v119, v119, v22
    v_sub_f32 v120, v120, v23
    v_sub_f32 v121, v121, v23
    v_sub_f32 v122, v122, v23
    v_sub_f32 v123, v123, v23
    v_sub_f32 v124, v124, v23
    v_sub_f32 v125, v125, v23
    v_sub_f32 v126, v126, v23
    v_sub_f32 v127, v127, v23
    v_mul_f32 v16, v64, v64
    v_mul_f32 v24, v65, v65
    v_mul_f32 v17, v72, v72
    v_mul_f32 v25, v73, v73
    v_mul_f32 v18, v80, v80
    v_mul_f32 v26, v81, v81
    v_mul_f32 v19, v88, v88
    v_mul_f32 v27, v89, v89
    v_mul_f32 v20, v96, v96
    v_mul_f32 v28, v97, v97
    v_mul_f32 v21, v104, v104
    v_mul_f32 v29, v105, v105
    v_mul_f32 v22, v112, v112
    v_mul_f32 v30, v113, v113
    v_mul_f32 v23, v120, v120
    v_mul_f32 v31, v121, v121
    v_fmac_f32 v16, v66, v66
    v_fmac_f32 v24, v67, v67
    v_fmac_f32 v17, v74, v74
    v_fmac_f32 v25, v75, v75
    v_fmac_f32 v18, v82, v82
    v_fmac_f32 v26, v83, v83
    v_fmac_f32 v19, v90, v90
    v_fmac_f32 v27, v91, v91
    v_fmac_f32 v20, v98, v98
    v_fmac_f32 v28, v99, v99
    v_fmac_f32 v21, v106, v106
    v_fmac_f32 v29, v107, v107
    v_fmac_f32 v22, v114, v114
    v_fmac_f32 v30, v115, v115
    v_fmac_f32 v23, v122, v122
    v_fmac_f32 v31, v123, v123
    v_fmac_f32 v16, v68, v68
    v_fmac_f32 v24, v69, v69
    v_fmac_f32 v17, v76, v76
    v_fmac_f32 v25, v77, v77
    v_fmac_f32 v18, v84, v84
    v_fmac_f32 v26, v85, v85
    v_fmac_f32 v19, v92, v92
    v_fmac_f32 v27, v93, v93
    v_fmac_f32 v20, v100, v100
    v_fmac_f32 v28, v101, v101
    v_fmac_f32 v21, v108, v108
    v_fmac_f32 v29, v109, v109
    v_fmac_f32 v22, v116, v116
    v_fmac_f32 v30, v117, v117
    v_fmac_f32 v23, v124, v124
    v_fmac_f32 v31, v125, v125
    v_fmac_f32 v16, v70, v70
    v_fmac_f32 v24, v71, v71
    v_fmac_f32 v17, v78, v78
    v_fmac_f32 v25, v79, v79
    v_fmac_f32 v18, v86, v86
    v_fmac_f32 v26, v87, v87
    v_fmac_f32 v19, v94, v94
    v_fmac_f32 v27, v95, v95
    v_fmac_f32 v20, v102, v102
    v_fmac_f32 v28, v103, v103
    v_fmac_f32 v21, v110, v110
    v_fmac_f32 v29, v111, v111
    v_fmac_f32 v22, v118, v118
    v_fmac_f32 v30, v119, v119
    v_fmac_f32 v23, v126, v126
    v_fmac_f32 v31, v127, v127
    v_add_f32 v16, v16, v24
    v_add_f32 v17, v17, v25
    v_add_f32 v18, v18, v26
    v_add_f32 v19, v19, v27
    v_add_f32 v20, v20, v28
    v_add_f32 v21, v21, v29
    v_add_f32 v22, v22, v30
    v_add_f32 v23, v23, v31
    v_add_f32_dpp v16, v16, v16 row_ror:8 row_mask:0xf bank_mask:0xf
    v_add_f32_dpp v17, v17, v17 row_ror:8 row_mask:0xf bank_mask:0xf
    v_add_f32_dpp v18, v18, v18 row_ror:8 row_mask:0xf bank_mask:0xf
    v_add_f32_dpp v19, v19, v19 row_ror:8 row_mask:0xf bank_mask:0xf
    v_add_f32_dpp v20, v20, v20 row_ror:8 row_mask:0xf bank_mask:0xf
    v_add_f32_dpp v21, v21, v21 row_ror:8 row_mask:0xf bank_mask:0xf
    v_add_f32_dpp v22, v22, v22 row_ror:8 row_mask:0xf bank_mask:0xf
    v_add_f32_dpp v23, v23, v23 row_ror:8 row_mask:0xf bank_mask:0xf
    v_add_f32_dpp v16, v16, v16 row_ror:4 row_mask:0xf bank_mask:0xf
    v_add_f32_dpp v17, v17, v17 row_ror:4 row_mask:0xf bank_mask:0xf
    v_add_f32_dpp v18, v18, v18 row_ror:4 row_mask:0xf bank_mask:0xf
    v_add_f32_dpp v19, v19, v19 row_ror:4 row_mask:0xf bank_mask:0xf
    v_add_f32_dpp v20, v20, v20 row_ror:4 row_mask:0xf bank_mask:0xf
    v_add_f32_dpp v21, v21, v21 row_ror:4 row_mask:0xf bank_mask:0xf
    v_add_f32_dpp v22, v22, v22 row_ror:4 row_mask:0xf bank_mask:0xf
    v_add_f32_dpp v23, v23, v23 row_ror:4 row_mask:0xf bank_mask:0xf
    v_add_f32_dpp v16, v16, v16 row_ror:2 row_mask:0xf bank_mask:0xf
    v_add_f32_dpp v17, v17, v17 row_ror:2 row_mask:0xf bank_mask:0xf
    v_add_f32_dpp v18, v18, v18 row_ror:2 row_mask:0xf bank_mask:0xf
    v_add_f32_dpp v19, v19, v19 row_ror:2 row_mask:0xf bank_mask:0xf
    v_add_f32_dpp v20, v20, v20 row_ror:2 row_mask:0xf bank_mask:0xf
    v_add_f32_dpp v21, v21, v21 row_ror:2 row_mask:0xf bank_mask:0xf
    v_add_f32_dpp v22, v22, v22 row_ror:2 row_mask:0xf bank_mask:0xf
    v_add_f32_dpp v23, v23, v23 row_ror:2 row_mask:0xf bank_mask:0xf
    v_add_f32_dpp v16, v16, v16 row_ror:1 row_mask:0xf bank_mask:0xf
    v_add_f32_dpp v17, v17, v17 row_ror:1 row_mask:0xf bank_mask:0xf
    v_add_f32_dpp v18, v18, v18 row_ror:1 row_mask:0xf bank_mask:0xf
    v_add_f32_dpp v19, v19, v19 row_ror:1 row_mask:0xf bank_mask:0xf
    v_add_f32_dpp v20, v20, v20 row_ror:1 row_mask:0xf bank_mask:0xf
    v_add_f32_dpp v21, v21, v21 row_ror:1 row_mask:0xf bank_mask:0xf
    v_add_f32_dpp v22, v22, v22 row_ror:1 row_mask:0xf bank_mask:0xf
    v_add_f32_dpp v23, v23, v23 row_ror:1 row_mask:0xf bank_mask:0xf
    v_mov_b32 v24, v16
    v_mov_b32 v25, v17
    v_mov_b32 v26, v18
    v_mov_b32 v27, v19
    v_mov_b32 v28, v20
    v_mov_b32 v29, v21
    v_mov_b32 v30, v22
    v_mov_b32 v31, v23
    v_permlane16_swap_b32 v16, v24
    v_permlane16_swap_b32 v17, v25
    v_permlane16_swap_b32 v18, v26
    v_permlane16_swap_b32 v19, v27
    v_permlane16_swap_b32 v20, v28
    v_permlane16_swap_b32 v21, v29
    v_permlane16_swap_b32 v22, v30
    v_permlane16_swap_b32 v23, v31
    v_add_f32 v16, v16, v24
    v_add_f32 v17, v17, v25
    v_add_f32 v18, v18, v26
    v_add_f32 v19, v19, v27
    v_add_f32 v20, v20, v28
    v_add_f32 v21, v21, v29
    v_add_f32 v22, v22, v30
    v_add_f32 v23, v23, v31
    v_mov_b32 v24, v16
    v_mov_b32 v25, v17
    v_mov_b32 v26, v18
    v_mov_b32 v27, v19
    v_mov_b32 v28, v20
    v_mov_b32 v29, v21
    v_mov_b32 v30, v22
    v_mov_b32 v31, v23
    v_permlane32_swap_b32 v16, v24
    v_permlane32_swap_b32 v17, v25
    v_permlane32_swap_b32 v18, v26
    v_permlane32_swap_b32 v19, v27
    v_permlane32_swap_b32 v20, v28
    v_permlane32_swap_b32 v21, v29
    v_permlane32_swap_b32 v22, v30
    v_permlane32_swap_b32 v23, v31
    v_add_f32 v16, v16, v24
    v_add_f32 v17, v17, v25
    v_add_f32 v18, v18, v26
    v_add_f32 v19, v19, v27
    v_add_f32 v20, v20, v28
    v_add_f32 v21, v21, v29
    v_add_f32 v22, v22, v30
    v_add_f32 v23, v23, v31
    v_mov_b32 v24, s20
    v_mov_b32 v25, s20
    v_mov_b32 v26, s20
    v_mov_b32 v27, s20
    v_mov_b32 v28, s20
    v_mov_b32 v29, s20
    v_mov_b32 v30, s20
    v_mov_b32 v31, s20
    v_fma_f32 v16, v16, s19, v24
    v_fma_f32 v17, v17, s19, v25
    v_fma_f32 v18, v18, s19, v26
    v_fma_f32 v19, v19, s19, v27
    v_fma_f32 v20, v20, s19, v28
    v_fma_f32 v21, v21, s19, v29
    v_fma_f32 v22, v22, s19, v30
    v_fma_f32 v23, v23, s19, v31
    v_rsq_f32 v16, v16
    v_rsq_f32 v17, v17
    v_rsq_f32 v18, v18
    v_rsq_f32 v19, v19
    v_rsq_f32 v20, v20
    v_rsq_f32 v21, v21
    v_rsq_f32 v22, v22
    v_rsq_f32 v23, v23
    v_mul_f32 v64, v64, v16
    v_mul_f32 v65, v65, v16
    v_mul_f32 v66, v66, v16
    v_mul_f32 v67, v67, v16
    v_mul_f32 v68, v68, v16
    v_mul_f32 v69, v69, v16
    v_mul_f32 v70, v70, v16
    v_mul_f32 v71, v71, v16
    v_mul_f32 v72, v72, v17
    v_mul_f32 v73, v73, v17
    v_mul_f32 v74, v74, v17
    v_mul_f32 v75, v75, v17
    v_mul_f32 v76, v76, v17
    v_mul_f32 v77, v77, v17
    v_mul_f32 v78, v78, v17
    v_mul_f32 v79, v79, v17
    v_mul_f32 v80, v80, v18
    v_mul_f32 v81, v81, v18
    v_mul_f32 v82, v82, v18
    v_mul_f32 v83, v83, v18
    v_mul_f32 v84, v84, v18
    v_mul_f32 v85, v85, v18
    v_mul_f32 v86, v86, v18
    v_mul_f32 v87, v87, v18
    v_mul_f32 v88, v88, v19
    v_mul_f32 v89, v89, v19
    v_mul_f32 v90, v90, v19
    v_mul_f32 v91, v91, v19
    v_mul_f32 v92, v92, v19
    v_mul_f32 v93, v93, v19
    v_mul_f32 v94, v94, v19
    v_mul_f32 v95, v95, v19
    v_mul_f32 v96, v96, v20
    v_mul_f32 v97, v97, v20
    v_mul_f32 v98, v98, v20
    v_mul_f32 v99, v99, v20
    v_mul_f32 v100, v100, v20
    v_mul_f32 v101, v101, v20
    v_mul_f32 v102, v102, v20
    v_mul_f32 v103, v103, v20
    v_mul_f32 v104, v104, v21
    v_mul_f32 v105, v105, v21
    v_mul_f32 v106, v106, v21
    v_mul_f32 v107, v107, v21
    v_mul_f32 v108, v108, v21
    v_mul_f32 v109, v109, v21
    v_mul_f32 v110, v110, v21
    v_mul_f32 v111, v111, v21
    v_mul_f32 v112, v112, v22
    v_mul_f32 v113, v113, v22
    v_mul_f32 v114, v114, v22
    v_mul_f32 v115, v115, v22
    v_mul_f32 v116, v116, v22
    v_mul_f32 v117, v117, v22
    v_mul_f32 v118, v118, v22
    v_mul_f32 v119, v119, v22
    v_mul_f32 v120, v120, v23
    v_mul_f32 v121, v121, v23
    v_mul_f32 v122, v122, v23
    v_mul_f32 v123, v123, v23
    v_mul_f32 v124, v124, v23
    v_mul_f32 v125, v125, v23
    v_mul_f32 v126, v126, v23
    v_mul_f32 v127, v127, v23
    v_lshlrev_b32 v128, 16, v224
    v_and_b32 v129, 0xffff0000, v224
    v_lshlrev_b32 v130, 16, v225
    v_and_b32 v131, 0xffff0000, v225
    v_lshlrev_b32 v132, 16, v226
    v_and_b32 v133, 0xffff0000, v226
    v_lshlrev_b32 v134, 16, v227
    v_and_b32 v135, 0xffff0000, v227
    v_lshlrev_b32 v136, 16, v228
    v_and_b32 v137, 0xffff0000, v228
    v_lshlrev_b32 v138, 16, v229
    v_and_b32 v139, 0xffff0000, v229
    v_lshlrev_b32 v140, 16, v230
    v_and_b32 v141, 0xffff0000, v230
    v_lshlrev_b32 v142, 16, v231
    v_and_b32 v143, 0xffff0000, v231
    v_lshlrev_b32 v144, 16, v232
    v_and_b32 v145, 0xffff0000, v232
    v_lshlrev_b32 v146, 16, v233
    v_and_b32 v147, 0xffff0000, v233
    v_lshlrev_b32 v148, 16, v234
    v_and_b32 v149, 0xffff0000, v234
    v_lshlrev_b32 v150, 16, v235
    v_and_b32 v151, 0xffff0000, v235
    v_lshlrev_b32 v152, 16, v236
    v_and_b32 v153, 0xffff0000, v236
    v_lshlrev_b32 v154, 16, v237
    v_and_b32 v155, 0xffff0000, v237
    v_lshlrev_b32 v156, 16, v238
    v_and_b32 v157, 0xffff0000, v238
    v_lshlrev_b32 v158, 16, v239
    v_and_b32 v159, 0xffff0000, v239
    v_lshlrev_b32 v160, 16, v240
    v_and_b32 v161, 0xffff0000, v240
    v_lshlrev_b32 v162, 16, v241
    v_and_b32 v163, 0xffff0000, v241
    v_lshlrev_b32 v164, 16, v242
    v_and_b32 v165, 0xffff0000, v242
    v_lshlrev_b32 v166, 16, v243
    v_and_b32 v167, 0xffff0000, v243
    v_lshlrev_b32 v168, 16, v244
    v_and_b32 v169, 0xffff0000, v244
    v_lshlrev_b32 v170, 16, v245
    v_and_b32 v171, 0xffff0000, v245
    v_lshlrev_b32 v172, 16, v246
    v_and_b32 v173, 0xffff0000, v246
    v_lshlrev_b32 v174, 16, v247
    v_and_b32 v175, 0xffff0000, v247
    v_lshlrev_b32 v176, 16, v248
    v_and_b32 v177, 0xffff0000, v248
    v_lshlrev_b32 v178, 16, v249
    v_and_b32 v179, 0xffff0000, v249
    v_lshlrev_b32 v180, 16, v250
    v_and_b32 v181, 0xffff0000, v250
    v_lshlrev_b32 v182, 16, v251
    v_and_b32 v183, 0xffff0000, v251
    v_lshlrev_b32 v184, 16, v252
    v_and_b32 v185, 0xffff0000, v252
    v_lshlrev_b32 v186, 16, v253
    v_and_b32 v187, 0xffff0000, v253
    v_lshlrev_b32 v188, 16, v254
    v_and_b32 v189, 0xffff0000, v254
    v_lshlrev_b32 v190, 16, v255
    v_and_b32 v191, 0xffff0000, v255
    v_add_f32 v16, v128, v129
    v_add_f32 v24, v130, v131
    v_add_f32 v17, v136, v137
    v_add_f32 v25, v138, v139
    v_add_f32 v18, v144, v145
    v_add_f32 v26, v146, v147
    v_add_f32 v19, v152, v153
    v_add_f32 v27, v154, v155
    v_add_f32 v20, v160, v161
    v_add_f32 v28, v162, v163
    v_add_f32 v21, v168, v169
    v_add_f32 v29, v170, v171
    v_add_f32 v22, v176, v177
    v_add_f32 v30, v178, v179
    v_add_f32 v23, v184, v185
    v_add_f32 v31, v186, v187
    v_add_f32 v16, v16, v132
    v_add_f32 v24, v24, v133
    v_add_f32 v17, v17, v140
    v_add_f32 v25, v25, v141
    v_add_f32 v18, v18, v148
    v_add_f32 v26, v26, v149
    v_add_f32 v19, v19, v156
    v_add_f32 v27, v27, v157
    v_add_f32 v20, v20, v164
    v_add_f32 v28, v28, v165
    v_add_f32 v21, v21, v172
    v_add_f32 v29, v29, v173
    v_add_f32 v22, v22, v180
    v_add_f32 v30, v30, v181
    v_add_f32 v23, v23, v188
    v_add_f32 v31, v31, v189
    v_add_f32 v16, v16, v134
    v_add_f32 v24, v24, v135
    v_add_f32 v17, v17, v142
    v_add_f32 v25, v25, v143
    v_add_f32 v18, v18, v150
    v_add_f32 v26, v26, v151
    v_add_f32 v19, v19, v158
    v_add_f32 v27, v27, v159
    v_add_f32 v20, v20, v166
    v_add_f32 v28, v28, v167
    v_add_f32 v21, v21, v174
    v_add_f32 v29, v29, v175
    v_add_f32 v22, v22, v182
    v_add_f32 v30, v30, v183
    v_add_f32 v23, v23, v190
    v_add_f32 v31, v31, v191
    v_add_f32 v16, v16, v24
    v_add_f32 v17, v17, v25
    v_add_f32 v18, v18, v26
    v_add_f32 v19, v19, v27
    v_add_f32 v20, v20, v28
    v_add_f32 v21, v21, v29
    v_add_f32 v22, v22, v30
    v_add_f32 v23, v23, v31
    v_add_f32_dpp v16, v16, v16 row_ror:8 row_mask:0xf bank_mask:0xf
    v_add_f32_dpp v17, v17, v17 row_ror:8 row_mask:0xf bank_mask:0xf
    v_add_f32_dpp v18, v18, v18 row_ror:8 row_mask:0xf bank_mask:0xf
    v_add_f32_dpp v19, v19, v19 row_ror:8 row_mask:0xf bank_mask:0xf
    v_add_f32_dpp v20, v20, v20 row_ror:8 row_mask:0xf bank_mask:0xf
    v_add_f32_dpp v21, v21, v21 row_ror:8 row_mask:0xf bank_mask:0xf
    v_add_f32_dpp v22, v22, v22 row_ror:8 row_mask:0xf bank_mask:0xf
    v_add_f32_dpp v23, v23, v23 row_ror:8 row_mask:0xf bank_mask:0xf
    v_add_f32_dpp v16, v16, v16 row_ror:4 row_mask:0xf bank_mask:0xf
    v_add_f32_dpp v17, v17, v17 row_ror:4 row_mask:0xf bank_mask:0xf
    v_add_f32_dpp v18, v18, v18 row_ror:4 row_mask:0xf bank_mask:0xf
    v_add_f32_dpp v19, v19, v19 row_ror:4 row_mask:0xf bank_mask:0xf
    v_add_f32_dpp v20, v20, v20 row_ror:4 row_mask:0xf bank_mask:0xf
    v_add_f32_dpp v21, v21, v21 row_ror:4 row_mask:0xf bank_mask:0xf
    v_add_f32_dpp v22, v22, v22 row_ror:4 row_mask:0xf bank_mask:0xf
    v_add_f32_dpp v23, v23, v23 row_ror:4 row_mask:0xf bank_mask:0xf
    v_add_f32_dpp v16, v16, v16 row_ror:2 row_mask:0xf bank_mask:0xf
    v_add_f32_dpp v17, v17, v17 row_ror:2 row_mask:0xf bank_mask:0xf
    v_add_f32_dpp v18, v18, v18 row_ror:2 row_mask:0xf bank_mask:0xf
    v_add_f32_dpp v19, v19, v19 row_ror:2 row_mask:0xf bank_mask:0xf
    v_add_f32_dpp v20, v20, v20 row_ror:2 row_mask:0xf bank_mask:0xf
    v_add_f32_dpp v21, v21, v21 row_ror:2 row_mask:0xf bank_mask:0xf
    v_add_f32_dpp v22, v22, v22 row_ror:2 row_mask:0xf bank_mask:0xf
    v_add_f32_dpp v23, v23, v23 row_ror:2 row_mask:0xf bank_mask:0xf
    v_add_f32_dpp v16, v16, v16 row_ror:1 row_mask:0xf bank_mask:0xf
    v_add_f32_dpp v17, v17, v17 row_ror:1 row_mask:0xf bank_mask:0xf
    v_add_f32_dpp v18, v18, v18 row_ror:1 row_mask:0xf bank_mask:0xf
    v_add_f32_dpp v19, v19, v19 row_ror:1 row_mask:0xf bank_mask:0xf
    v_add_f32_dpp v20, v20, v20 row_ror:1 row_mask:0xf bank_mask:0xf
    v_add_f32_dpp v21, v21, v21 row_ror:1 row_mask:0xf bank_mask:0xf
    v_add_f32_dpp v22, v22, v22 row_ror:1 row_mask:0xf bank_mask:0xf
    v_add_f32_dpp v23, v23, v23 row_ror:1 row_mask:0xf bank_mask:0xf
    v_mov_b32 v24, v16
    v_mov_b32 v25, v17
    v_mov_b32 v26, v18
    v_mov_b32 v27, v19
    v_mov_b32 v28, v20
    v_mov_b32 v29, v21
    v_mov_b32 v30, v22
    v_mov_b32 v31, v23
    v_permlane16_swap_b32 v16, v24
    v_permlane16_swap_b32 v17, v25
    v_permlane16_swap_b32 v18, v26
    v_permlane16_swap_b32 v19, v27
    v_permlane16_swap_b32 v20, v28
    v_permlane16_swap_b32 v21, v29
    v_permlane16_swap_b32 v22, v30
    v_permlane16_swap_b32 v23, v31
    v_add_f32 v16, v16, v24
    v_add_f32 v17, v17, v25
    v_add_f32 v18, v18, v26
    v_add_f32 v19, v19, v27
    v_add_f32 v20, v20, v28
    v_add_f32 v21, v21, v29
    v_add_f32 v22, v22, v30
    v_add_f32 v23, v23, v31
    v_mov_b32 v24, v16
    v_mov_b32 v25, v17
    v_mov_b32 v26, v18
    v_mov_b32 v27, v19
    v_mov_b32 v28, v20
    v_mov_b32 v29, v21
    v_mov_b32 v30, v22
    v_mov_b32 v31, v23
    v_permlane32_swap_b32 v16, v24
    v_permlane32_swap_b32 v17, v25
    v_permlane32_swap_b32 v18, v26
    v_permlane32_swap_b32 v19, v27
    v_permlane32_swap_b32 v20, v28
    v_permlane32_swap_b32 v21, v29
    v_permlane32_swap_b32 v22, v30
    v_permlane32_swap_b32 v23, v31
    v_add_f32 v16, v16, v24
    v_add_f32 v17, v17, v25
    v_add_f32 v18, v18, v26
    v_add_f32 v19, v19, v27
    v_add_f32 v20, v20, v28
    v_add_f32 v21, v21, v29
    v_add_f32 v22, v22, v30
    v_add_f32 v23, v23, v31
    v_mul_f32 v16, s19, v16
    v_mul_f32 v17, s19, v17
    v_mul_f32 v18, s19, v18
    v_mul_f32 v19, s19, v19
    v_mul_f32 v20, s19, v20
    v_mul_f32 v21, s19, v21
    v_mul_f32 v22, s19, v22
    v_mul_f32 v23, s19, v23
    v_sub_f32 v128, v128, v16
    v_sub_f32 v129, v129, v16
    v_sub_f32 v130, v130, v16
    v_sub_f32 v131, v131, v16
    v_sub_f32 v132, v132, v16
    v_sub_f32 v133, v133, v16
    v_sub_f32 v134, v134, v16
    v_sub_f32 v135, v135, v16
    v_sub_f32 v136, v136, v17
    v_sub_f32 v137, v137, v17
    v_sub_f32 v138, v138, v17
    v_sub_f32 v139, v139, v17
    v_sub_f32 v140, v140, v17
    v_sub_f32 v141, v141, v17
    v_sub_f32 v142, v142, v17
    v_sub_f32 v143, v143, v17
    v_sub_f32 v144, v144, v18
    v_sub_f32 v145, v145, v18
    v_sub_f32 v146, v146, v18
    v_sub_f32 v147, v147, v18
    v_sub_f32 v148, v148, v18
    v_sub_f32 v149, v149, v18
    v_sub_f32 v150, v150, v18
    v_sub_f32 v151, v151, v18
    v_sub_f32 v152, v152, v19
    v_sub_f32 v153, v153, v19
    v_sub_f32 v154, v154, v19
    v_sub_f32 v155, v155, v19
    v_sub_f32 v156, v156, v19
    v_sub_f32 v157, v157, v19
    v_sub_f32 v158, v158, v19
    v_sub_f32 v159, v159, v19
    v_sub_f32 v160, v160, v20
    v_sub_f32 v161, v161, v20
    v_sub_f32 v162, v162, v20
    v_sub_f32 v163, v163, v20
    v_sub_f32 v164, v164, v20
    v_sub_f32 v165, v165, v20
    v_sub_f32 v166, v166, v20
    v_sub_f32 v167, v167, v20
    v_sub_f32 v168, v168, v21
    v_sub_f32 v169, v169, v21
    v_sub_f32 v170, v170, v21
    v_sub_f32 v171, v171, v21
    v_sub_f32 v172, v172, v21
    v_sub_f32 v173, v173, v21
    v_sub_f32 v174, v174, v21
    v_sub_f32 v175, v175, v21
    v_sub_f32 v176, v176, v22
    v_sub_f32 v177, v177, v22
    v_sub_f32 v178, v178, v22
    v_sub_f32 v179, v179, v22
    v_sub_f32 v180, v180, v22
    v_sub_f32 v181, v181, v22
    v_sub_f32 v182, v182, v22
    v_sub_f32 v183, v183, v22
    v_sub_f32 v184, v184, v23
    v_sub_f32 v185, v185, v23
    v_sub_f32 v186, v186, v23
    v_sub_f32 v187, v187, v23
    v_sub_f32 v188, v188, v23
    v_sub_f32 v189, v189, v23
    v_sub_f32 v190, v190, v23
    v_sub_f32 v191, v191, v23
    v_mul_f32 v16, v128, v128
    v_mul_f32 v24, v129, v129
    v_mul_f32 v17, v136, v136
    v_mul_f32 v25, v137, v137
    v_mul_f32 v18, v144, v144
    v_mul_f32 v26, v145, v145
    v_mul_f32 v19, v152, v152
    v_mul_f32 v27, v153, v153
    v_mul_f32 v20, v160, v160
    v_mul_f32 v28, v161, v161
    v_mul_f32 v21, v168, v168
    v_mul_f32 v29, v169, v169
    v_mul_f32 v22, v176, v176
    v_mul_f32 v30, v177, v177
    v_mul_f32 v23, v184, v184
    v_mul_f32 v31, v185, v185
    v_fmac_f32 v16, v130, v130
    v_fmac_f32 v24, v131, v131
    v_fmac_f32 v17, v138, v138
    v_fmac_f32 v25, v139, v139
    v_fmac_f32 v18, v146, v146
    v_fmac_f32 v26, v147, v147
    v_fmac_f32 v19, v154, v154
    v_fmac_f32 v27, v155, v155
    v_fmac_f32 v20, v162, v162
    v_fmac_f32 v28, v163, v163
    v_fmac_f32 v21, v170, v170
    v_fmac_f32 v29, v171, v171
    v_fmac_f32 v22, v178, v178
    v_fmac_f32 v30, v179, v179
    v_fmac_f32 v23, v186, v186
    v_fmac_f32 v31, v187, v187
    v_fmac_f32 v16, v132, v132
    v_fmac_f32 v24, v133, v133
    v_fmac_f32 v17, v140, v140
    v_fmac_f32 v25, v141, v141
    v_fmac_f32 v18, v148, v148
    v_fmac_f32 v26, v149, v149
    v_fmac_f32 v19, v156, v156
    v_fmac_f32 v27, v157, v157
    v_fmac_f32 v20, v164, v164
    v_fmac_f32 v28, v165, v165
    v_fmac_f32 v21, v172, v172
    v_fmac_f32 v29, v173, v173
    v_fmac_f32 v22, v180, v180
    v_fmac_f32 v30, v181, v181
    v_fmac_f32 v23, v188, v188
    v_fmac_f32 v31, v189, v189
    v_fmac_f32 v16, v134, v134
    v_fmac_f32 v24, v135, v135
    v_fmac_f32 v17, v142, v142
    v_fmac_f32 v25, v143, v143
    v_fmac_f32 v18, v150, v150
    v_fmac_f32 v26, v151, v151
    v_fmac_f32 v19, v158, v158
    v_fmac_f32 v27, v159, v159
    v_fmac_f32 v20, v166, v166
    v_fmac_f32 v28, v167, v167
    v_fmac_f32 v21, v174, v174
    v_fmac_f32 v29, v175, v175
    v_fmac_f32 v22, v182, v182
    v_fmac_f32 v30, v183, v183
    v_fmac_f32 v23, v190, v190
    v_fmac_f32 v31, v191, v191
    v_add_f32 v16, v16, v24
    v_add_f32 v17, v17, v25
    v_add_f32 v18, v18, v26
    v_add_f32 v19, v19, v27
    v_add_f32 v20, v20, v28
    v_add_f32 v21, v21, v29
    v_add_f32 v22, v22, v30
    v_add_f32 v23, v23, v31
    v_add_f32_dpp v16, v16, v16 row_ror:8 row_mask:0xf bank_mask:0xf
    v_add_f32_dpp v17, v17, v17 row_ror:8 row_mask:0xf bank_mask:0xf
    v_add_f32_dpp v18, v18, v18 row_ror:8 row_mask:0xf bank_mask:0xf
    v_add_f32_dpp v19, v19, v19 row_ror:8 row_mask:0xf bank_mask:0xf
    v_add_f32_dpp v20, v20, v20 row_ror:8 row_mask:0xf bank_mask:0xf
    v_add_f32_dpp v21, v21, v21 row_ror:8 row_mask:0xf bank_mask:0xf
    v_add_f32_dpp v22, v22, v22 row_ror:8 row_mask:0xf bank_mask:0xf
    v_add_f32_dpp v23, v23, v23 row_ror:8 row_mask:0xf bank_mask:0xf
    v_add_f32_dpp v16, v16, v16 row_ror:4 row_mask:0xf bank_mask:0xf
    v_add_f32_dpp v17, v17, v17 row_ror:4 row_mask:0xf bank_mask:0xf
    v_add_f32_dpp v18, v18, v18 row_ror:4 row_mask:0xf bank_mask:0xf
    v_add_f32_dpp v19, v19, v19 row_ror:4 row_mask:0xf bank_mask:0xf
    v_add_f32_dpp v20, v20, v20 row_ror:4 row_mask:0xf bank_mask:0xf
    v_add_f32_dpp v21, v21, v21 row_ror:4 row_mask:0xf bank_mask:0xf
    v_add_f32_dpp v22, v22, v22 row_ror:4 row_mask:0xf bank_mask:0xf
    v_add_f32_dpp v23, v23, v23 row_ror:4 row_mask:0xf bank_mask:0xf
    v_add_f32_dpp v16, v16, v16 row_ror:2 row_mask:0xf bank_mask:0xf
    v_add_f32_dpp v17, v17, v17 row_ror:2 row_mask:0xf bank_mask:0xf
    v_add_f32_dpp v18, v18, v18 row_ror:2 row_mask:0xf bank_mask:0xf
    v_add_f32_dpp v19, v19, v19 row_ror:2 row_mask:0xf bank_mask:0xf
    v_add_f32_dpp v20, v20, v20 row_ror:2 row_mask:0xf bank_mask:0xf
    v_add_f32_dpp v21, v21, v21 row_ror:2 row_mask:0xf bank_mask:0xf
    v_add_f32_dpp v22, v22, v22 row_ror:2 row_mask:0xf bank_mask:0xf
    v_add_f32_dpp v23, v23, v23 row_ror:2 row_mask:0xf bank_mask:0xf
    v_add_f32_dpp v16, v16, v16 row_ror:1 row_mask:0xf bank_mask:0xf
    v_add_f32_dpp v17, v17, v17 row_ror:1 row_mask:0xf bank_mask:0xf
    v_add_f32_dpp v18, v18, v18 row_ror:1 row_mask:0xf bank_mask:0xf
    v_add_f32_dpp v19, v19, v19 row_ror:1 row_mask:0xf bank_mask:0xf
    v_add_f32_dpp v20, v20, v20 row_ror:1 row_mask:0xf bank_mask:0xf
    v_add_f32_dpp v21, v21, v21 row_ror:1 row_mask:0xf bank_mask:0xf
    v_add_f32_dpp v22, v22, v22 row_ror:1 row_mask:0xf bank_mask:0xf
    v_add_f32_dpp v23, v23, v23 row_ror:1 row_mask:0xf bank_mask:0xf
    v_mov_b32 v24, v16
    v_mov_b32 v25, v17
    v_mov_b32 v26, v18
    v_mov_b32 v27, v19
    v_mov_b32 v28, v20
    v_mov_b32 v29, v21
    v_mov_b32 v30, v22
    v_mov_b32 v31, v23
    v_permlane16_swap_b32 v16, v24
    v_permlane16_swap_b32 v17, v25
    v_permlane16_swap_b32 v18, v26
    v_permlane16_swap_b32 v19, v27
    v_permlane16_swap_b32 v20, v28
    v_permlane16_swap_b32 v21, v29
    v_permlane16_swap_b32 v22, v30
    v_permlane16_swap_b32 v23, v31
    v_add_f32 v16, v16, v24
    v_add_f32 v17, v17, v25
    v_add_f32 v18, v18, v26
    v_add_f32 v19, v19, v27
    v_add_f32 v20, v20, v28
    v_add_f32 v21, v21, v29
    v_add_f32 v22, v22, v30
    v_add_f32 v23, v23, v31
    v_mov_b32 v24, v16
    v_mov_b32 v25, v17
    v_mov_b32 v26, v18
    v_mov_b32 v27, v19
    v_mov_b32 v28, v20
    v_mov_b32 v29, v21
    v_mov_b32 v30, v22
    v_mov_b32 v31, v23
    v_permlane32_swap_b32 v16, v24
    v_permlane32_swap_b32 v17, v25
    v_permlane32_swap_b32 v18, v26
    v_permlane32_swap_b32 v19, v27
    v_permlane32_swap_b32 v20, v28
    v_permlane32_swap_b32 v21, v29
    v_permlane32_swap_b32 v22, v30
    v_permlane32_swap_b32 v23, v31
    v_add_f32 v16, v16, v24
    v_add_f32 v17, v17, v25
    v_add_f32 v18, v18, v26
    v_add_f32 v19, v19, v27
    v_add_f32 v20, v20, v28
    v_add_f32 v21, v21, v29
    v_add_f32 v22, v22, v30
    v_add_f32 v23, v23, v31
    v_mov_b32 v24, s20
    v_mov_b32 v25, s20
    v_mov_b32 v26, s20
    v_mov_b32 v27, s20
    v_mov_b32 v28, s20
    v_mov_b32 v29, s20
    v_mov_b32 v30, s20
    v_mov_b32 v31, s20
    v_fma_f32 v16, v16, s19, v24
    v_fma_f32 v17, v17, s19, v25
    v_fma_f32 v18, v18, s19, v26
    v_fma_f32 v19, v19, s19, v27
    v_fma_f32 v20, v20, s19, v28
    v_fma_f32 v21, v21, s19, v29
    v_fma_f32 v22, v22, s19, v30
    v_fma_f32 v23, v23, s19, v31
    v_rsq_f32 v16, v16
    v_rsq_f32 v17, v17
    v_rsq_f32 v18, v18
    v_rsq_f32 v19, v19
    v_rsq_f32 v20, v20
    v_rsq_f32 v21, v21
    v_rsq_f32 v22, v22
    v_rsq_f32 v23, v23
    v_mul_f32 v128, v128, v16
    v_mul_f32 v129, v129, v16
    v_mul_f32 v130, v130, v16
    v_mul_f32 v131, v131, v16
    v_mul_f32 v132, v132, v16
    v_mul_f32 v133, v133, v16
    v_mul_f32 v134, v134, v16
    v_mul_f32 v135, v135, v16
    v_mul_f32 v136, v136, v17
    v_mul_f32 v137, v137, v17
    v_mul_f32 v138, v138, v17
    v_mul_f32 v139, v139, v17
    v_mul_f32 v140, v140, v17
    v_mul_f32 v141, v141, v17
    v_mul_f32 v142, v142, v17
    v_mul_f32 v143, v143, v17
    v_mul_f32 v144, v144, v18
    v_mul_f32 v145, v145, v18
    v_mul_f32 v146, v146, v18
    v_mul_f32 v147, v147, v18
    v_mul_f32 v148, v148, v18
    v_mul_f32 v149, v149, v18
    v_mul_f32 v150, v150, v18
    v_mul_f32 v151, v151, v18
    v_mul_f32 v152, v152, v19
    v_mul_f32 v153, v153, v19
    v_mul_f32 v154, v154, v19
    v_mul_f32 v155, v155, v19
    v_mul_f32 v156, v156, v19
    v_mul_f32 v157, v157, v19
    v_mul_f32 v158, v158, v19
    v_mul_f32 v159, v159, v19
    v_mul_f32 v160, v160, v20
    v_mul_f32 v161, v161, v20
    v_mul_f32 v162, v162, v20
    v_mul_f32 v163, v163, v20
    v_mul_f32 v164, v164, v20
    v_mul_f32 v165, v165, v20
    v_mul_f32 v166, v166, v20
    v_mul_f32 v167, v167, v20
    v_mul_f32 v168, v168, v21
    v_mul_f32 v169, v169, v21
    v_mul_f32 v170, v170, v21
    v_mul_f32 v171, v171, v21
    v_mul_f32 v172, v172, v21
    v_mul_f32 v173, v173, v21
    v_mul_f32 v174, v174, v21
    v_mul_f32 v175, v175, v21
    v_mul_f32 v176, v176, v22
    v_mul_f32 v177, v177, v22
    v_mul_f32 v178, v178, v22
    v_mul_f32 v179, v179, v22
    v_mul_f32 v180, v180, v22
    v_mul_f32 v181, v181, v22
    v_mul_f32 v182, v182, v22
    v_mul_f32 v183, v183, v22
    v_mul_f32 v184, v184, v23
    v_mul_f32 v185, v185, v23
    v_mul_f32 v186, v186, v23
    v_mul_f32 v187, v187, v23
    v_mul_f32 v188, v188, v23
    v_mul_f32 v189, v189, v23
    v_mul_f32 v190, v190, v23
    v_mul_f32 v191, v191, v23
L_r_ln:
    s_cmp_eq_u32 s13, 3
    s_cbranch_scc0 L_s1_9
    v_mov_b32 v5, 0
    s_mov_b32 s42, 0
L_sp_10:
    global_load_dword v4, v5, s[92:93] offset:0 sc1
    s_waitcnt vmcnt(0)
    v_cmp_gt_u32 vcc, 32, v4
    s_cbranch_vccz L_sd_11
    s_add_u32 s42, s42, 1
    s_cmp_lt_u32 s42, 2097152
    s_cbranch_scc1 L_sp_10
    s_branch L_fail
L_sd_11:
L_s1_9:
    s_barrier
    s_mov_b32 s29, 0x3e00000
    buffer_load_dwordx4 v[16:19], v2, s[4:7], s29 offen offset:0 sc1
    buffer_load_dwordx4 v[20:23], v2, s[4:7], s29 offen offset:1024 sc1
    s_waitcnt vmcnt(0)
    v_lshlrev_b32 v32, 16, v16
    v_and_b32 v33, 0xffff0000, v16
    v_lshlrev_b32 v34, 16, v17
    v_and_b32 v35, 0xffff0000, v17
    v_lshlrev_b32 v36, 16, v18
    v_and_b32 v37, 0xffff0000, v18
    v_lshlrev_b32 v38, 16, v19
    v_and_b32 v39, 0xffff0000, v19
    v_lshlrev_b32 v40, 16, v20
    v_and_b32 v41, 0xffff0000, v20
    v_lshlrev_b32 v42, 16, v21
    v_and_b32 v43, 0xffff0000, v21
    v_lshlrev_b32 v44, 16, v22
    v_and_b32 v45, 0xffff0000, v22
    v_lshlrev_b32 v46, 16, v23
    v_and_b32 v47, 0xffff0000, v23
    v_add_f32 v40, 1.0, v40
    v_add_f32 v41, 1.0, v41
    v_add_f32 v42, 1.0, v42
    v_add_f32 v43, 1.0, v43
    v_add_f32 v44, 1.0, v44
    v_add_f32 v45, 1.0, v45
    v_add_f32 v46, 1.0, v46
    v_add_f32 v47, 1.0, v47
    v_cvt_pk_bf16_f32 v16, v40, v41
    v_cvt_pk_bf16_f32 v17, v42, v43
    v_cvt_pk_bf16_f32 v18, v44, v45
    v_cvt_pk_bf16_f32 v19, v46, v47
    v_lshlrev_b32 v40, 16, v16
    v_and_b32 v41, 0xffff0000, v16
    v_lshlrev_b32 v42, 16, v17
    v_and_b32 v43, 0xffff0000, v17
    v_lshlrev_b32 v44, 16, v18
    v_and_b32 v45, 0xffff0000, v18
    v_lshlrev_b32 v46, 16, v19
    v_and_b32 v47, 0xffff0000, v19
    s_add_u32 s18, s18, 0x3900000
    v_pk_fma_f32 v[64:65], v[64:65], v[40:41], v[32:33]
    v_pk_fma_f32 v[66:67], v[66:67], v[42:43], v[34:35]
    v_pk_fma_f32 v[68:69], v[68:69], v[44:45], v[36:37]
    v_pk_fma_f32 v[70:71], v[70:71], v[46:47], v[38:39]
    v_cvt_pk_bf16_f32 v192, v64, v65
    v_cvt_pk_bf16_f32 v193, v66, v67
    v_cvt_pk_bf16_f32 v194, v68, v69
    v_cvt_pk_bf16_f32 v195, v70, v71
    s_add_u32 s43, s18, 0
    buffer_store_dwordx4 v[192:195], v2, s[4:7], s43 offen offset:0 sc1
    v_pk_fma_f32 v[72:73], v[72:73], v[40:41], v[32:33]
    v_pk_fma_f32 v[74:75], v[74:75], v[42:43], v[34:35]
    v_pk_fma_f32 v[76:77], v[76:77], v[44:45], v[36:37]
    v_pk_fma_f32 v[78:79], v[78:79], v[46:47], v[38:39]
    v_cvt_pk_bf16_f32 v196, v72, v73
    v_cvt_pk_bf16_f32 v197, v74, v75
    v_cvt_pk_bf16_f32 v198, v76, v77
    v_cvt_pk_bf16_f32 v199, v78, v79
    buffer_store_dwordx4 v[196:199], v2, s[4:7], s43 offen offset:1024 sc1
    v_pk_fma_f32 v[80:81], v[80:81], v[40:41], v[32:33]
    v_pk_fma_f32 v[82:83], v[82:83], v[42:43], v[34:35]
    v_pk_fma_f32 v[84:85], v[84:85], v[44:45], v[36:37]
    v_pk_fma_f32 v[86:87], v[86:87], v[46:47], v[38:39]
    v_cvt_pk_bf16_f32 v200, v80, v81
    v_cvt_pk_bf16_f32 v201, v82, v83
    v_cvt_pk_bf16_f32 v202, v84, v85
    v_cvt_pk_bf16_f32 v203, v86, v87
    buffer_store_dwordx4 v[200:203], v2, s[4:7], s43 offen offset:2048 sc1
    v_pk_fma_f32 v[88:89], v[88:89], v[40:41], v[32:33]
    v_pk_fma_f32 v[90:91], v[90:91], v[42:43], v[34:35]
    v_pk_fma_f32 v[92:93], v[92:93], v[44:45], v[36:37]
    v_pk_fma_f32 v[94:95], v[94:95], v[46:47], v[38:39]
    v_cvt_pk_bf16_f32 v204, v88, v89
    v_cvt_pk_bf16_f32 v205, v90, v91
    v_cvt_pk_bf16_f32 v206, v92, v93
    v_cvt_pk_bf16_f32 v207, v94, v95
    buffer_store_dwordx4 v[204:207], v2, s[4:7], s43 offen offset:3072 sc1
    v_pk_fma_f32 v[96:97], v[96:97], v[40:41], v[32:33]
    v_pk_fma_f32 v[98:99], v[98:99], v[42:43], v[34:35]
    v_pk_fma_f32 v[100:101], v[100:101], v[44:45], v[36:37]
    v_pk_fma_f32 v[102:103], v[102:103], v[46:47], v[38:39]
    v_cvt_pk_bf16_f32 v208, v96, v97
    v_cvt_pk_bf16_f32 v209, v98, v99
    v_cvt_pk_bf16_f32 v210, v100, v101
    v_cvt_pk_bf16_f32 v211, v102, v103
    s_add_u32 s43, s18, 4096
    buffer_store_dwordx4 v[208:211], v2, s[4:7], s43 offen offset:0 sc1
    v_pk_fma_f32 v[104:105], v[104:105], v[40:41], v[32:33]
    v_pk_fma_f32 v[106:107], v[106:107], v[42:43], v[34:35]
    v_pk_fma_f32 v[108:109], v[108:109], v[44:45], v[36:37]
    v_pk_fma_f32 v[110:111], v[110:111], v[46:47], v[38:39]
    v_cvt_pk_bf16_f32 v212, v104, v105
    v_cvt_pk_bf16_f32 v213, v106, v107
    v_cvt_pk_bf16_f32 v214, v108, v109
    v_cvt_pk_bf16_f32 v215, v110, v111
    buffer_store_dwordx4 v[212:215], v2, s[4:7], s43 offen offset:1024 sc1
    v_pk_fma_f32 v[112:113], v[112:113], v[40:41], v[32:33]
    v_pk_fma_f32 v[114:115], v[114:115], v[42:43], v[34:35]
    v_pk_fma_f32 v[116:117], v[116:117], v[44:45], v[36:37]
    v_pk_fma_f32 v[118:119], v[118:119], v[46:47], v[38:39]
    v_cvt_pk_bf16_f32 v216, v112, v113
    v_cvt_pk_bf16_f32 v217, v114, v115
    v_cvt_pk_bf16_f32 v218, v116, v117
    v_cvt_pk_bf16_f32 v219, v118, v119
    buffer_store_dwordx4 v[216:219], v2, s[4:7], s43 offen offset:2048 sc1
    v_pk_fma_f32 v[120:121], v[120:121], v[40:41], v[32:33]
    v_pk_fma_f32 v[122:123], v[122:123], v[42:43], v[34:35]
    v_pk_fma_f32 v[124:125], v[124:125], v[44:45], v[36:37]
    v_pk_fma_f32 v[126:127], v[126:127], v[46:47], v[38:39]
    v_cvt_pk_bf16_f32 v220, v120, v121
    v_cvt_pk_bf16_f32 v221, v122, v123
    v_cvt_pk_bf16_f32 v222, v124, v125
    v_cvt_pk_bf16_f32 v223, v126, v127
    buffer_store_dwordx4 v[220:223], v2, s[4:7], s43 offen offset:3072 sc1
    v_pk_fma_f32 v[128:129], v[128:129], v[40:41], v[32:33]
    v_pk_fma_f32 v[130:131], v[130:131], v[42:43], v[34:35]
    v_pk_fma_f32 v[132:133], v[132:133], v[44:45], v[36:37]
    v_pk_fma_f32 v[134:135], v[134:135], v[46:47], v[38:39]
    v_cvt_pk_bf16_f32 v224, v128, v129
    v_cvt_pk_bf16_f32 v225, v130, v131
    v_cvt_pk_bf16_f32 v226, v132, v133
    v_cvt_pk_bf16_f32 v227, v134, v135
    s_add_u32 s43, s18, 8192
    buffer_store_dwordx4 v[224:227], v2, s[4:7], s43 offen offset:0 sc1
    v_pk_fma_f32 v[136:137], v[136:137], v[40:41], v[32:33]
    v_pk_fma_f32 v[138:139], v[138:139], v[42:43], v[34:35]
    v_pk_fma_f32 v[140:141], v[140:141], v[44:45], v[36:37]
    v_pk_fma_f32 v[142:143], v[142:143], v[46:47], v[38:39]
    v_cvt_pk_bf16_f32 v228, v136, v137
    v_cvt_pk_bf16_f32 v229, v138, v139
    v_cvt_pk_bf16_f32 v230, v140, v141
    v_cvt_pk_bf16_f32 v231, v142, v143
    buffer_store_dwordx4 v[228:231], v2, s[4:7], s43 offen offset:1024 sc1
    v_pk_fma_f32 v[144:145], v[144:145], v[40:41], v[32:33]
    v_pk_fma_f32 v[146:147], v[146:147], v[42:43], v[34:35]
    v_pk_fma_f32 v[148:149], v[148:149], v[44:45], v[36:37]
    v_pk_fma_f32 v[150:151], v[150:151], v[46:47], v[38:39]
    v_cvt_pk_bf16_f32 v232, v144, v145
    v_cvt_pk_bf16_f32 v233, v146, v147
    v_cvt_pk_bf16_f32 v234, v148, v149
    v_cvt_pk_bf16_f32 v235, v150, v151
    buffer_store_dwordx4 v[232:235], v2, s[4:7], s43 offen offset:2048 sc1
    v_pk_fma_f32 v[152:153], v[152:153], v[40:41], v[32:33]
    v_pk_fma_f32 v[154:155], v[154:155], v[42:43], v[34:35]
    v_pk_fma_f32 v[156:157], v[156:157], v[44:45], v[36:37]
    v_pk_fma_f32 v[158:159], v[158:159], v[46:47], v[38:39]
    v_cvt_pk_bf16_f32 v236, v152, v153
    v_cvt_pk_bf16_f32 v237, v154, v155
    v_cvt_pk_bf16_f32 v238, v156, v157
    v_cvt_pk_bf16_f32 v239, v158, v159
    buffer_store_dwordx4 v[236:239], v2, s[4:7], s43 offen offset:3072 sc1
    v_pk_fma_f32 v[160:161], v[160:161], v[40:41], v[32:33]
    v_pk_fma_f32 v[162:163], v[162:163], v[42:43], v[34:35]
    v_pk_fma_f32 v[164:165], v[164:165], v[44:45], v[36:37]
    v_pk_fma_f32 v[166:167], v[166:167], v[46:47], v[38:39]
    v_cvt_pk_bf16_f32 v240, v160, v161
    v_cvt_pk_bf16_f32 v241, v162, v163
    v_cvt_pk_bf16_f32 v242, v164, v165
    v_cvt_pk_bf16_f32 v243, v166, v167
    s_add_u32 s43, s18, 12288
    buffer_store_dwordx4 v[240:243], v2, s[4:7], s43 offen offset:0 sc1
    v_pk_fma_f32 v[168:169], v[168:169], v[40:41], v[32:33]
    v_pk_fma_f32 v[170:171], v[170:171], v[42:43], v[34:35]
    v_pk_fma_f32 v[172:173], v[172:173], v[44:45], v[36:37]
    v_pk_fma_f32 v[174:175], v[174:175], v[46:47], v[38:39]
    v_cvt_pk_bf16_f32 v244, v168, v169
    v_cvt_pk_bf16_f32 v245, v170, v171
    v_cvt_pk_bf16_f32 v246, v172, v173
    v_cvt_pk_bf16_f32 v247, v174, v175
    buffer_store_dwordx4 v[244:247], v2, s[4:7], s43 offen offset:1024 sc1
    v_pk_fma_f32 v[176:177], v[176:177], v[40:41], v[32:33]
    v_pk_fma_f32 v[178:179], v[178:179], v[42:43], v[34:35]
    v_pk_fma_f32 v[180:181], v[180:181], v[44:45], v[36:37]
    v_pk_fma_f32 v[182:183], v[182:183], v[46:47], v[38:39]
    v_cvt_pk_bf16_f32 v248, v176, v177
    v_cvt_pk_bf16_f32 v249, v178, v179
    v_cvt_pk_bf16_f32 v250, v180, v181
    v_cvt_pk_bf16_f32 v251, v182, v183
    buffer_store_dwordx4 v[248:251], v2, s[4:7], s43 offen offset:2048 sc1
    v_pk_fma_f32 v[184:185], v[184:185], v[40:41], v[32:33]
    v_pk_fma_f32 v[186:187], v[186:187], v[42:43], v[34:35]
    v_pk_fma_f32 v[188:189], v[188:189], v[44:45], v[36:37]
    v_pk_fma_f32 v[190:191], v[190:191], v[46:47], v[38:39]
    v_cvt_pk_bf16_f32 v252, v184, v185
    v_cvt_pk_bf16_f32 v253, v186, v187
    v_cvt_pk_bf16_f32 v254, v188, v189
    v_cvt_pk_bf16_f32 v255, v190, v191
    buffer_store_dwordx4 v[252:255], v2, s[4:7], s43 offen offset:3072 sc1
    s_waitcnt vmcnt(0)
    s_barrier
    s_cmp_eq_u32 s13, 0
    s_cbranch_scc0 L_r_nd
    s_lshl_b32 s43, 1, s14
    v_mov_b32 v5, 0
    v_mov_b32 v4, s43
    s_mov_b64 exec, 1
    global_atomic_or v5, v4, s[92:93] offset:128
    s_mov_b64 exec, -1
    s_waitcnt vmcnt(0)
L_r_nd:
    s_barrier
    s_add_u32 s43, s13, 1
    s_bitcmp1_b32 s43, 1
    s_cbranch_scc0 L_r_ng
    buffer_load_dwordx4 v[16:19], v2, s[52:55], 0 offen
    v_bfe_u32 v4, v1, 2, 4
    v_mul_u32_u24 v8, 6144, v4
    v_bfe_u32 v4, v1, 0, 2
    v_lshl_add_u32 v8, v4, 4, v8
    v_bfe_u32 v4, v1, 5, 1
    v_lshlrev_b32 v9, 10, v4
    v_bfe_u32 v4, v1, 4, 1
    v_lshl_add_u32 v9, v4, 9, v9
    v_bfe_u32 v4, v1, 2, 2
    v_lshl_add_u32 v9, v4, 6, v9
    v_bfe_u32 v4, v1, 0, 2
    v_lshl_add_u32 v9, v4, 3, v9
    s_mul_i32 s17, s13, 32768
    v_add_u32 v9, s17, v9
    s_lshl_b32 s16, s13, 11
    s_lshl_b32 s43, s14, 6
    s_add_u32 s16, s16, s43
    s_add_u32 s43, s16, 0x0
    s_add_u32 m0, s17, 0
    s_nop 0
    buffer_load_dwordx4 v8, s[44:47], s43 offen lds
    s_add_u32 s43, s16, 0x18000
    s_add_u32 m0, s17, 1024
    s_nop 0
    buffer_load_dwordx4 v8, s[44:47], s43 offen lds
    s_add_u32 s43, s16, 0x30000
    s_add_u32 m0, s17, 2048
    s_nop 0
    buffer_load_dwordx4 v8, s[44:47], s43 offen lds
    s_add_u32 s43, s16, 0x48000
    s_add_u32 m0, s17, 3072
    s_nop 0
    buffer_load_dwordx4 v8, s[44:47], s43 offen lds
    s_add_u32 s43, s16, 0x60000
    s_add_u32 m0, s17, 4096
    s_nop 0
    buffer_load_dwordx4 v8, s[44:47], s43 offen lds
    s_add_u32 s43, s16, 0x78000
    s_add_u32 m0, s17, 5120
    s_nop 0
    buffer_load_dwordx4 v8, s[44:47], s43 offen lds
    s_add_u32 s43, s16, 0x90000
    s_add_u32 m0, s17, 6144
    s_nop 0
    buffer_load_dwordx4 v8, s[44:47], s43 offen lds
    s_add_u32 s43, s16, 0xa8000
    s_add_u32 m0, s17, 7168
    s_nop 0
    buffer_load_dwordx4 v8, s[44:47], s43 offen lds
    s_add_u32 s43, s16, 0xc0000
    s_add_u32 m0, s17, 8192
    s_nop 0
    buffer_load_dwordx4 v8, s[44:47], s43 offen lds
    s_add_u32 s43, s16, 0xd8000
    s_add_u32 m0, s17, 9216
    s_nop 0
    buffer_load_dwordx4 v8, s[44:47], s43 offen lds
    s_add_u32 s43, s16, 0xf0000
    s_add_u32 m0, s17, 10240
    s_nop 0
    buffer_load_dwordx4 v8, s[44:47], s43 offen lds
    s_add_u32 s43, s16, 0x108000
    s_add_u32 m0, s17, 11264
    s_nop 0
    buffer_load_dwordx4 v8, s[44:47], s43 offen lds
    s_add_u32 s43, s16, 0x120000
    s_add_u32 m0, s17, 12288
    s_nop 0
    buffer_load_dwordx4 v8, s[44:47], s43 offen lds
    s_add_u32 s43, s16, 0x138000
    s_add_u32 m0, s17, 13312
    s_nop 0
    buffer_load_dwordx4 v8, s[44:47], s43 offen lds
    s_add_u32 s43, s16, 0x150000
    s_add_u32 m0, s17, 14336
    s_nop 0
    buffer_load_dwordx4 v8, s[44:47], s43 offen lds
    s_add_u32 s43, s16, 0x168000
    s_add_u32 m0, s17, 15360
    s_nop 0
    buffer_load_dwordx4 v8, s[44:47], s43 offen lds
    s_add_u32 s43, s16, 0x180000
    s_add_u32 m0, s17, 16384
    s_nop 0
    buffer_load_dwordx4 v8, s[44:47], s43 offen lds
    s_add_u32 s43, s16, 0x198000
    s_add_u32 m0, s17, 17408
    s_nop 0
    buffer_load_dwordx4 v8, s[44:47], s43 offen lds
    s_add_u32 s43, s16, 0x1b0000
    s_add_u32 m0, s17, 18432
    s_nop 0
    buffer_load_dwordx4 v8, s[44:47], s43 offen lds
    s_add_u32 s43, s16, 0x1c8000
    s_add_u32 m0, s17, 19456
    s_nop 0
    buffer_load_dwordx4 v8, s[44:47], s43 offen lds
    s_add_u32 s43, s16, 0x1e0000
    s_add_u32 m0, s17, 20480
    s_nop 0
    buffer_load_dwordx4 v8, s[44:47], s43 offen lds
    s_add_u32 s43, s16, 0x1f8000
    s_add_u32 m0, s17, 21504
    s_nop 0
    buffer_load_dwordx4 v8, s[44:47], s43 offen lds
    s_add_u32 s43, s16, 0x210000
    s_add_u32 m0, s17, 22528
    s_nop 0
    buffer_load_dwordx4 v8, s[44:47], s43 offen lds
    s_add_u32 s43, s16, 0x228000
    s_add_u32 m0, s17, 23552
    s_nop 0
    buffer_load_dwordx4 v8, s[44:47], s43 offen lds
    s_add_u32 s43, s16, 0x240000
    s_add_u32 m0, s17, 24576
    s_nop 0
    buffer_load_dwordx4 v8, s[44:47], s43 offen lds
    s_add_u32 s43, s16, 0x258000
    s_add_u32 m0, s17, 25600
    s_nop 0
    buffer_load_dwordx4 v8, s[44:47], s43 offen lds
    s_add_u32 s43, s16, 0x270000
    s_add_u32 m0, s17, 26624
    s_nop 0
    buffer_load_dwordx4 v8, s[44:47], s43 offen lds
    s_add_u32 s43, s16, 0x288000
    s_add_u32 m0, s17, 27648
    s_nop 0
    buffer_load_dwordx4 v8, s[44:47], s43 offen lds
    s_add_u32 s43, s16, 0x2a0000
    s_add_u32 m0, s17, 28672
    s_nop 0
    buffer_load_dwordx4 v8, s[44:47], s43 offen lds
    s_add_u32 s43, s16, 0x2b8000
    s_add_u32 m0, s17, 29696
    s_nop 0
    buffer_load_dwordx4 v8, s[44:47], s43 offen lds
    s_add_u32 s43, s16, 0x2d0000
    s_add_u32 m0, s17, 30720
    s_nop 0
    buffer_load_dwordx4 v8, s[44:47], s43 offen lds
    s_add_u32 s43, s16, 0x2e8000
    s_add_u32 m0, s17, 31744
    s_nop 0
    buffer_load_dwordx4 v8, s[44:47], s43 offen lds
    s_waitcnt vmcnt(32)
    v_lshlrev_b32 v24, 16, v16
    v_and_b32 v25, 0xffff0000, v16
    v_lshlrev_b32 v26, 16, v17
    v_and_b32 v27, 0xffff0000, v17
    v_lshlrev_b32 v28, 16, v18
    v_and_b32 v29, 0xffff0000, v18
    v_lshlrev_b32 v30, 16, v19
    v_and_b32 v31, 0xffff0000, v19
    v_mul_f32 v32, s30, v24
    v_mul_f32 v33, s30, v25
    v_mul_f32 v34, s30, v26
    v_mul_f32 v35, s30, v27
    v_mul_f32 v36, s30, v28
    v_mul_f32 v37, s30, v29
    v_mul_f32 v38, s30, v30
    v_mul_f32 v39, s30, v31
    v_exp_f32 v32, v32
    v_exp_f32 v33, v33
    v_exp_f32 v34, v34
    v_exp_f32 v35, v35
    v_exp_f32 v36, v36
    v_exp_f32 v37, v37
    v_exp_f32 v38, v38
    v_exp_f32 v39, v39
    v_add_f32 v32, 1.0, v32
    v_add_f32 v33, 1.0, v33
    v_add_f32 v34, 1.0, v34
    v_add_f32 v35, 1.0, v35
    v_add_f32 v36, 1.0, v36
    v_add_f32 v37, 1.0, v37
    v_add_f32 v38, 1.0, v38
    v_add_f32 v39, 1.0, v39
    v_rcp_f32 v32, v32
    v_rcp_f32 v33, v33
    v_rcp_f32 v34, v34
    v_rcp_f32 v35, v35
    v_rcp_f32 v36, v36
    v_rcp_f32 v37, v37
    v_rcp_f32 v38, v38
    v_rcp_f32 v39, v39
    v_mul_f32 v32, v32, v24
    v_mul_f32 v33, v33, v25
    v_mul_f32 v34, v34, v26
    v_mul_f32 v35, v35, v27
    v_mul_f32 v36, v36, v28
    v_mul_f32 v37, v37, v29
    v_mul_f32 v38, v38, v30
    v_mul_f32 v39, v39, v31
    v_cvt_pk_bf16_f32 v16, v32, v33
    v_cvt_pk_bf16_f32 v17, v34, v35
    v_cvt_pk_bf16_f32 v18, v36, v37
    v_cvt_pk_bf16_f32 v19, v38, v39
    v_add_u32 v14, 0x20000, v3
    ds_write_b128 v14, v[16:19]
    v_bfe_u32 v4, v1, 4, 2
    v_lshlrev_b32 v14, 4, v4
    s_lshl_b32 s43, s13, 10
    s_add_u32 s43, s43, 0x20000
    v_add_u32 v14, s43, v14
    s_waitcnt lgkmcnt(0)
    ds_read_b128 v[64:67], v14 offset:0
    ds_read_b128 v[68:71], v14 offset:64
    ds_read_b128 v[72:75], v14 offset:128
    ds_read_b128 v[76:79], v14 offset:192
    ds_read_b128 v[80:83], v14 offset:256
    ds_read_b128 v[84:87], v14 offset:320
    ds_read_b128 v[88:91], v14 offset:384
    ds_read_b128 v[92:95], v14 offset:448
    ds_read_b128 v[96:99], v14 offset:512
    ds_read_b128 v[100:103], v14 offset:576
    ds_read_b128 v[104:107], v14 offset:640
    ds_read_b128 v[108:111], v14 offset:704
    ds_read_b128 v[112:115], v14 offset:768
    ds_read_b128 v[116:119], v14 offset:832
    ds_read_b128 v[120:123], v14 offset:896
    ds_read_b128 v[124:127], v14 offset:960
    s_waitcnt lgkmcnt(0)
    s_waitcnt vmcnt(30)
    ds_read_b64_tr_b16 a[0:1], v9 offset:0
    ds_read_b64_tr_b16 a[2:3], v9 offset:256
    ds_read_b64_tr_b16 a[4:5], v9 offset:32
    ds_read_b64_tr_b16 a[6:7], v9 offset:288
    s_waitcnt vmcnt(28)
    ds_read_b64_tr_b16 a[8:9], v9 offset:2048
    ds_read_b64_tr_b16 a[10:11], v9 offset:2304
    ds_read_b64_tr_b16 a[12:13], v9 offset:2080
    ds_read_b64_tr_b16 a[14:15], v9 offset:2336
    s_waitcnt vmcnt(26)
    ds_read_b64_tr_b16 a[16:17], v9 offset:4096
    ds_read_b64_tr_b16 a[18:19], v9 offset:4352
    ds_read_b64_tr_b16 a[20:21], v9 offset:4128
    ds_read_b64_tr_b16 a[22:23], v9 offset:4384
    s_waitcnt vmcnt(24)
    ds_read_b64_tr_b16 a[24:25], v9 offset:6144
    ds_read_b64_tr_b16 a[26:27], v9 offset:6400
    ds_read_b64_tr_b16 a[28:29], v9 offset:6176
    ds_read_b64_tr_b16 a[30:31], v9 offset:6432
    s_waitcnt vmcnt(22)
    ds_read_b64_tr_b16 a[32:33], v9 offset:8192
    ds_read_b64_tr_b16 a[34:35], v9 offset:8448
    ds_read_b64_tr_b16 a[36:37], v9 offset:8224
    ds_read_b64_tr_b16 a[38:39], v9 offset:8480
    s_waitcnt vmcnt(20)
    ds_read_b64_tr_b16 a[40:41], v9 offset:10240
    ds_read_b64_tr_b16 a[42:43], v9 offset:10496
    ds_read_b64_tr_b16 a[44:45], v9 offset:10272
    ds_read_b64_tr_b16 a[46:47], v9 offset:10528
    s_waitcnt vmcnt(18)
    ds_read_b64_tr_b16 a[48:49], v9 offset:12288
    ds_read_b64_tr_b16 a[50:51], v9 offset:12544
    ds_read_b64_tr_b16 a[52:53], v9 offset:12320
    ds_read_b64_tr_b16 a[54:55], v9 offset:12576
    s_waitcnt vmcnt(16)
    ds_read_b64_tr_b16 a[56:57], v9 offset:14336
    ds_read_b64_tr_b16 a[58:59], v9 offset:14592
    ds_read_b64_tr_b16 a[60:61], v9 offset:14368
    ds_read_b64_tr_b16 a[62:63], v9 offset:14624
    s_waitcnt vmcnt(14)
    ds_read_b64_tr_b16 a[64:65], v9 offset:16384
    ds_read_b64_tr_b16 a[66:67], v9 offset:16640
    ds_read_b64_tr_b16 a[68:69], v9 offset:16416
    ds_read_b64_tr_b16 a[70:71], v9 offset:16672
    s_waitcnt vmcnt(12)
    ds_read_b64_tr_b16 a[72:73], v9 offset:18432
    ds_read_b64_tr_b16 a[74:75], v9 offset:18688
    ds_read_b64_tr_b16 a[76:77], v9 offset:18464
    ds_read_b64_tr_b16 a[78:79], v9 offset:18720
    s_waitcnt vmcnt(10)
    ds_read_b64_tr_b16 a[80:81], v9 offset:20480
    ds_read_b64_tr_b16 a[82:83], v9 offset:20736
    ds_read_b64_tr_b16 a[84:85], v9 offset:20512
    ds_read_b64_tr_b16 a[86:87], v9 offset:20768
    s_waitcnt vmcnt(8)
    ds_read_b64_tr_b16 a[88:89], v9 offset:22528
    ds_read_b64_tr_b16 a[90:91], v9 offset:22784
    ds_read_b64_tr_b16 a[92:93], v9 offset:22560
    ds_read_b64_tr_b16 a[94:95], v9 offset:22816
    s_waitcnt vmcnt(6)
    ds_read_b64_tr_b16 a[96:97], v9 offset:24576
    ds_read_b64_tr_b16 a[98:99], v9 offset:24832
    ds_read_b64_tr_b16 a[100:101], v9 offset:24608
    ds_read_b64_tr_b16 a[102:103], v9 offset:24864
    s_waitcnt vmcnt(4)
    ds_read_b64_tr_b16 a[104:105], v9 offset:26624
    ds_read_b64_tr_b16 a[106:107], v9 offset:26880
    ds_read_b64_tr_b16 a[108:109], v9 offset:26656
    ds_read_b64_tr_b16 a[110:111], v9 offset:26912
    s_waitcnt vmcnt(2)
    ds_read_b64_tr_b16 a[112:113], v9 offset:28672
    ds_read_b64_tr_b16 a[114:115], v9 offset:28928
    ds_read_b64_tr_b16 a[116:117], v9 offset:28704
    ds_read_b64_tr_b16 a[118:119], v9 offset:28960
    s_waitcnt vmcnt(0)
    ds_read_b64_tr_b16 a[120:121], v9 offset:30720
    ds_read_b64_tr_b16 a[122:123], v9 offset:30976
    ds_read_b64_tr_b16 a[124:125], v9 offset:30752
    ds_read_b64_tr_b16 a[126:127], v9 offset:31008
    s_waitcnt lgkmcnt(0)
    v_mfma_f32_16x16x32_bf16 v[16:19], a[0:3], v[64:67], 0
    v_mfma_f32_16x16x32_bf16 v[20:23], a[4:7], v[64:67], 0
    v_mfma_f32_16x16x32_bf16 v[16:19], a[8:11], v[68:71], v[16:19]
    v_mfma_f32_16x16x32_bf16 v[20:23], a[12:15], v[68:71], v[20:23]
    v_mfma_f32_16x16x32_bf16 v[16:19], a[16:19], v[72:75], v[16:19]
    v_mfma_f32_16x16x32_bf16 v[20:23], a[20:23], v[72:75], v[20:23]
    v_mfma_f32_16x16x32_bf16 v[16:19], a[24:27], v[76:79], v[16:19]
    v_mfma_f32_16x16x32_bf16 v[20:23], a[28:31], v[76:79], v[20:23]
    v_mfma_f32_16x16x32_bf16 v[16:19], a[32:35], v[80:83], v[16:19]
    v_mfma_f32_16x16x32_bf16 v[20:23], a[36:39], v[80:83], v[20:23]
    v_mfma_f32_16x16x32_bf16 v[16:19], a[40:43], v[84:87], v[16:19]
    v_mfma_f32_16x16x32_bf16 v[20:23], a[44:47], v[84:87], v[20:23]
    v_mfma_f32_16x16x32_bf16 v[16:19], a[48:51], v[88:91], v[16:19]
    v_mfma_f32_16x16x32_bf16 v[20:23], a[52:55], v[88:91], v[20:23]
    v_mfma_f32_16x16x32_bf16 v[16:19], a[56:59], v[92:95], v[16:19]
    v_mfma_f32_16x16x32_bf16 v[20:23], a[60:63], v[92:95], v[20:23]
    v_mfma_f32_16x16x32_bf16 v[16:19], a[64:67], v[96:99], v[16:19]
    v_mfma_f32_16x16x32_bf16 v[20:23], a[68:71], v[96:99], v[20:23]
    v_mfma_f32_16x16x32_bf16 v[16:19], a[72:75], v[100:103], v[16:19]
    v_mfma_f32_16x16x32_bf16 v[20:23], a[76:79], v[100:103], v[20:23]
    v_mfma_f32_16x16x32_bf16 v[16:19], a[80:83], v[104:107], v[16:19]
    v_mfma_f32_16x16x32_bf16 v[20:23], a[84:87], v[104:107], v[20:23]
    v_mfma_f32_16x16x32_bf16 v[16:19], a[88:91], v[108:111], v[16:19]
    v_mfma_f32_16x16x32_bf16 v[20:23], a[92:95], v[108:111], v[20:23]
    v_mfma_f32_16x16x32_bf16 v[16:19], a[96:99], v[112:115], v[16:19]
    v_mfma_f32_16x16x32_bf16 v[20:23], a[100:103], v[112:115], v[20:23]
    v_mfma_f32_16x16x32_bf16 v[16:19], a[104:107], v[116:119], v[16:19]
    v_mfma_f32_16x16x32_bf16 v[20:23], a[108:111], v[116:119], v[20:23]
    v_mfma_f32_16x16x32_bf16 v[16:19], a[112:115], v[120:123], v[16:19]
    v_mfma_f32_16x16x32_bf16 v[20:23], a[116:119], v[120:123], v[20:23]
    v_mfma_f32_16x16x32_bf16 v[16:19], a[120:123], v[124:127], v[16:19]
    v_mfma_f32_16x16x32_bf16 v[20:23], a[124:127], v[124:127], v[20:23]
    v_bfe_u32 v4, v1, 0, 1
    v_lshlrev_b32 v14, 5, v4
    v_bfe_u32 v4, v1, 4, 2
    v_lshl_add_u32 v14, v4, 3, v14
    v_and_b32 v4, 15, v1
    v_cmp_gt_u32 vcc, 2, v4
    v_mov_b32 v5, 0x7fff0000
    s_nop 0
    v_cndmask_b32 v14, v5, v14, vcc
    v_cmp_eq_u32 vcc, 1, v4
    v_cvt_pk_bf16_f32 v24, v16, v17
    v_cvt_pk_bf16_f32 v25, v18, v19
    v_cvt_pk_bf16_f32 v26, v20, v21
    v_cvt_pk_bf16_f32 v27, v22, v23
    v_cndmask_b32 v24, v24, v26, vcc
    v_cndmask_b32 v25, v25, v27, vcc
    s_add_u32 s29, s16, 0x3e00000
    buffer_store_dwordx2 v[24:25], v14, s[4:7], s29 offen sc1
    s_waitcnt vmcnt(0)
    s_min_u32 s64, s13, 1
    s_lshl_b32 s64, s64, 6
    v_mov_b32 v5, s64
    v_mov_b32 v4, 1
    s_mov_b64 exec, 1
    global_atomic_add v5, v4, s[92:93] offset:0
    s_mov_b64 exec, -1
L_r_ng:
    s_cmp_eq_u32 s13, 0
    s_cbranch_scc0 L_s1_12
    v_mov_b32 v5, 0
    s_mov_b32 s42, 0
L_sp_13:
    global_load_dword v4, v5, s[92:93] offset:64 sc1
    s_waitcnt vmcnt(0)
    v_cmp_gt_u32 vcc, 64, v4
    s_cbranch_vccz L_sd_14
    s_add_u32 s42, s42, 1
    s_cmp_lt_u32 s42, 2097152
    s_cbranch_scc1 L_sp_13
    s_branch L_fail
L_sd_14:
L_s1_12:
    s_barrier
    s_mov_b32 s29, 0x3e00800
    buffer_load_dwordx4 v[16:19], v2, s[4:7], s29 offen offset:0 sc1
    buffer_load_dwordx4 v[20:23], v2, s[4:7], s29 offen offset:1024 sc1
    buffer_load_dwordx4 v[24:27], v2, s[4:7], s29 offen offset:2048 sc1
    buffer_load_dwordx4 v[28:31], v2, s[4:7], s29 offen offset:3072 sc1
    v_bfe_u32 v4, v1, 4, 2
    v_lshlrev_b32 v10, 15, v4
    v_bfe_u32 v4, v1, 0, 4
    v_lshl_add_u32 v10, v4, 4, v10
    v_cmp_gt_u32 vcc, 32, v1
    v_mov_b32 v5, 0x7fff0000
    s_nop 0
    v_cndmask_b32 v11, v5, v10, vcc
    v_bfe_u32 v4, v1, 0, 5
    v_lshlrev_b32 v12, 7, v4
    v_min_u32 v4, 21, v1
    v_mul_u32_u24 v13, 128, v4
    v_and_b32 v4, 1, v1
    v_lshlrev_b32 v4, 4, v4
    v_mov_b32 v5, 0x3f80
    v_lshlrev_b32 v5, v4, v5
    v_bfe_u32 v4, v1, 1, 3
    v_cmp_eq_u32 vcc, 0, v4
    s_nop 1
    v_cndmask_b32 v224, 0, v5, vcc
    v_cmp_eq_u32 vcc, 1, v4
    s_nop 1
    v_cndmask_b32 v225, 0, v5, vcc
    v_cmp_eq_u32 vcc, 2, v4
    s_nop 1
    v_cndmask_b32 v226, 0, v5, vcc
    v_cmp_eq_u32 vcc, 3, v4
    s_nop 1
    v_cndmask_b32 v227, 0, v5, vcc
    v_cmp_eq_u32 vcc, 4, v4
    s_nop 1
    v_cndmask_b32 v228, 0, v5, vcc
    v_cmp_eq_u32 vcc, 5, v4
    s_nop 1
    v_cndmask_b32 v229, 0, v5, vcc
    v_cmp_eq_u32 vcc, 6, v4
    s_nop 1
    v_cndmask_b32 v230, 0, v5, vcc
    v_cmp_eq_u32 vcc, 7, v4
    s_nop 1
    v_cndmask_b32 v231, 0, v5, vcc
    s_waitcnt vmcnt(0)
    v_lshlrev_b32 v192, 16, v16
    v_and_b32 v193, 0xffff0000, v16
    v_lshlrev_b32 v194, 16, v17
    v_and_b32 v195, 0xffff0000, v17
    v_lshlrev_b32 v196, 16, v18
    v_and_b32 v197, 0xffff0000, v18
    v_lshlrev_b32 v198, 16, v19
    v_and_b32 v199, 0xffff0000, v19
    v_lshlrev_b32 v200, 16, v20
    v_and_b32 v201, 0xffff0000, v20
    v_lshlrev_b32 v202, 16, v21
    v_and_b32 v203, 0xffff0000, v21
    v_lshlrev_b32 v204, 16, v22
    v_and_b32 v205, 0xffff0000, v22
    v_lshlrev_b32 v206, 16, v23
    v_and_b32 v207, 0xffff0000, v23
    v_lshlrev_b32 v208, 16, v24
    v_and_b32 v209, 0xffff0000, v24
    v_lshlrev_b32 v210, 16, v25
    v_and_b32 v211, 0xffff0000, v25
    v_lshlrev_b32 v212, 16, v26
    v_and_b32 v213, 0xffff0000, v26
    v_lshlrev_b32 v214, 16, v27
    v_and_b32 v215, 0xffff0000, v27
    v_lshlrev_b32 v216, 16, v28
    v_and_b32 v217, 0xffff0000, v28
    v_lshlrev_b32 v218, 16, v29
    v_and_b32 v219, 0xffff0000, v29
    v_lshlrev_b32 v220, 16, v30
    v_and_b32 v221, 0xffff0000, v30
    v_lshlrev_b32 v222, 16, v31
    v_and_b32 v223, 0xffff0000, v31
    v_add_f32 v208, 1.0, v208
    v_add_f32 v209, 1.0, v209
    v_add_f32 v210, 1.0, v210
    v_add_f32 v211, 1.0, v211
    v_add_f32 v212, 1.0, v212
    v_add_f32 v213, 1.0, v213
    v_add_f32 v214, 1.0, v214
    v_add_f32 v215, 1.0, v215
    v_cvt_pk_bf16_f32 v16, v208, v209
    v_cvt_pk_bf16_f32 v17, v210, v211
    v_cvt_pk_bf16_f32 v18, v212, v213
    v_cvt_pk_bf16_f32 v19, v214, v215
    v_lshlrev_b32 v208, 16, v16
    v_and_b32 v209, 0xffff0000, v16
    v_lshlrev_b32 v210, 16, v17
    v_and_b32 v211, 0xffff0000, v17
    v_lshlrev_b32 v212, 16, v18
    v_and_b32 v213, 0xffff0000, v18
    v_lshlrev_b32 v214, 16, v19
    v_and_b32 v215, 0xffff0000, v19
    s_and_b32 s64, s13, 1
    s_and_b32 s31, s14, 0
    v_lshlrev_b32 v8, 14, v1
    s_lshl_b32 s21, s64, 12
    s_lshl_b32 s43, s31, 13
    s_add_u32 s21, s21, s43
    s_add_u32 s21, s21, 0x184000
    s_lshl_b32 s22, s64, 12
    s_lshl_b32 s43, s31, 13
    s_add_u32 s22, s22, s43
    s_add_u32 s22, s22, 0x18c000
    s_lshl_b32 s23, s13, 12
    s_lshl_b32 s43, s14, 7
    s_add_u32 s23, s23, s43
    s_add_u32 s23, s23, 0x194000
    s_lshl_b32 s25, s13, 20
    s_lshl_b32 s43, s14, 10
    s_add_u32 s25, s25, s43
    s_add_u32 s25, s25, 0x4000000
    s_mul_i32 s26, s13, 720896
    s_lshl_b32 s43, s14, 10
    s_add_u32 s26, s26, s43
    s_add_u32 s26, s26, 0x8000000
    s_lshl_b32 s27, s13, 15
    s_lshl_b32 s43, s14, 10
    s_add_u32 s27, s27, s43
    s_mov_b32 s12, s13
    s_add_u32 s28, s12, 1
    s_mov_b32 s18, s27
    s_cmp_eq_u32 s13, 0
    s_cbranch_scc0 L_s1_15
    v_mov_b32 v5, 0
    s_mov_b32 s42, 0
L_sp_16:
    global_load_dword v4, v5, s[92:93] offset:132 sc1
    s_waitcnt vmcnt(0)
    v_cmp_gt_u32 vcc, 32, v4
    s_cbranch_vccz L_sd_17
    s_add_u32 s42, s42, 1
    s_cmp_lt_u32 s42, 2097152
    s_cbranch_scc1 L_sp_16
    s_branch L_fail
L_sd_17:
L_s1_15:
    s_barrier
    v_mov_b32 v16, -1
    v_mov_b32 v17, -1
    v_mov_b32 v18, -1
    v_mov_b32 v19, -1
    s_add_u32 s43, s27, 0x3cc0000
    buffer_store_dwordx4 v[16:19], v2, s[4:7], s43 offen sc1
    s_add_u32 s43, s27, 0x3ce0000
    buffer_store_dwordx4 v[16:19], v2, s[4:7], s43 offen sc1
    s_waitcnt vmcnt(0)
L_r:
    s_add_u32 s24, s12, 1
    s_cmp_lt_u32 s12, 56
    s_cselect_b32 s31, 0x80000000, s23
    buffer_load_dwordx4 v[240:243], v2, s[48:51], s27 offen
    s_mov_b32 s42, 0
    s_mov_b32 s42, 0
L_sp_21:
    buffer_load_dword v4, off, s[4:7], s21 sc1
    s_waitcnt vmcnt(0)
    v_cmp_gt_u32 vcc, s24, v4
    s_cbranch_vccz L_sd_22
    s_add_u32 s42, s42, 1
    s_cmp_lt_u32 s42, 2097152
    s_cbranch_scc1 L_sp_21
    s_branch L_fail
L_sd_22:
    s_mov_b32 exec_hi, 0
L_sp_18:
    buffer_load_dword v4, v12, s[4:7], s21 offen sc1
    s_waitcnt vmcnt(0)
    v_cmp_gt_u32 vcc, s24, v4
    s_mov_b64 exec, vcc
    s_cbranch_vccz L_s1_20
    s_add_u32 s42, s42, 1
    s_cmp_lt_u32 s42, 2097152
    s_cbranch_scc1 L_sp_18
    s_branch L_fail
L_s1_20:
    s_mov_b64 exec, -1
L_sd_19:
    v_mov_b32 v4, s24
    s_mov_b64 exec, 0x1
    buffer_store_dword v4, v8, s[4:7], s31 offen sc1
    s_mov_b64 exec, -1
    v_lshlrev_b32 v32, 16, v240
    v_and_b32 v33, 0xffff0000, v240
    v_lshlrev_b32 v34, 16, v241
    v_and_b32 v35, 0xffff0000, v241
    v_lshlrev_b32 v36, 16, v242
    v_and_b32 v37, 0xffff0000, v242
    v_lshlrev_b32 v38, 16, v243
    v_and_b32 v39, 0xffff0000, v243
    s_mov_b32 s42, 0
L_red8:
    s_add_u32 s43, s25, 0
    buffer_load_dwordx4 v[64:67], v10, s[4:7], s43 offen offset:0 sc1
    buffer_load_dwordx4 v[68:71], v10, s[4:7], s43 offen offset:256 sc1
    buffer_load_dwordx4 v[72:75], v10, s[4:7], s43 offen offset:512 sc1
    buffer_load_dwordx4 v[76:79], v10, s[4:7], s43 offen offset:768 sc1
    s_add_u32 s43, s25, 131072
    buffer_load_dwordx4 v[80:83], v10, s[4:7], s43 offen offset:0 sc1
    buffer_load_dwordx4 v[84:87], v10, s[4:7], s43 offen offset:256 sc1
    buffer_load_dwordx4 v[88:91], v10, s[4:7], s43 offen offset:512 sc1
    buffer_load_dwordx4 v[92:95], v10, s[4:7], s43 offen offset:768 sc1
    s_add_u32 s43, s25, 262144
    buffer_load_dwordx4 v[96:99], v10, s[4:7], s43 offen offset:0 sc1
    buffer_load_dwordx4 v[100:103], v10, s[4:7], s43 offen offset:256 sc1
    buffer_load_dwordx4 v[104:107], v10, s[4:7], s43 offen offset:512 sc1
    buffer_load_dwordx4 v[108:111], v10, s[4:7], s43 offen offset:768 sc1
    s_add_u32 s43, s25, 393216
    buffer_load_dwordx4 v[112:115], v10, s[4:7], s43 offen offset:0 sc1
    buffer_load_dwordx4 v[116:119], v10, s[4:7], s43 offen offset:256 sc1
    buffer_load_dwordx4 v[120:123], v10, s[4:7], s43 offen offset:512 sc1
    buffer_load_dwordx4 v[124:127], v10, s[4:7], s43 offen offset:768 sc1
    s_add_u32 s43, s25, 524288
    buffer_load_dwordx4 v[128:131], v10, s[4:7], s43 offen offset:0 sc1
    buffer_load_dwordx4 v[132:135], v10, s[4:7], s43 offen offset:256 sc1
    buffer_load_dwordx4 v[136:139], v10, s[4:7], s43 offen offset:512 sc1
    buffer_load_dwordx4 v[140:143], v10, s[4:7], s43 offen offset:768 sc1
    s_add_u32 s43, s25, 655360
    buffer_load_dwordx4 v[144:147], v10, s[4:7], s43 offen offset:0 sc1
    buffer_load_dwordx4 v[148:151], v10, s[4:7], s43 offen offset:256 sc1
    buffer_load_dwordx4 v[152:155], v10, s[4:7], s43 offen offset:512 sc1
    buffer_load_dwordx4 v[156:159], v10, s[4:7], s43 offen offset:768 sc1
    s_add_u32 s43, s25, 786432
    buffer_load_dwordx4 v[160:163], v10, s[4:7], s43 offen offset:0 sc1
    buffer_load_dwordx4 v[164:167], v10, s[4:7], s43 offen offset:256 sc1
    buffer_load_dwordx4 v[168:171], v10, s[4:7], s43 offen offset:512 sc1
    buffer_load_dwordx4 v[172:175], v10, s[4:7], s43 offen offset:768 sc1
    s_add_u32 s43, s25, 917504
    buffer_load_dwordx4 v[176:179], v10, s[4:7], s43 offen offset:0 sc1
    buffer_load_dwordx4 v[180:183], v10, s[4:7], s43 offen offset:256 sc1
    buffer_load_dwordx4 v[184:187], v10, s[4:7], s43 offen offset:512 sc1
    buffer_load_dwordx4 v[188:191], v10, s[4:7], s43 offen offset:768 sc1
    s_waitcnt vmcnt(31)
    v_mfma_f32_16x16x32_bf16 v[232:235], v[224:227], v[64:67], 0
    s_waitcnt vmcnt(30)
    v_mfma_f32_16x16x32_bf16 v[236:239], v[224:227], v[68:71], 0
    s_waitcnt vmcnt(29)
    v_mfma_f32_16x16x32_bf16 v[232:235], v[228:231], v[72:75], v[232:235]
    v_max3_u32 v16, v64, v68, v72
    s_waitcnt vmcnt(28)
    v_mfma_f32_16x16x32_bf16 v[236:239], v[228:231], v[76:79], v[236:239]
    s_waitcnt vmcnt(27)
    v_mfma_f32_16x16x32_bf16 v[232:235], v[224:227], v[80:83], v[232:235]
    s_waitcnt vmcnt(26)
    v_mfma_f32_16x16x32_bf16 v[236:239], v[224:227], v[84:87], v[236:239]
    v_max3_u32 v17, v76, v80, v84
    s_waitcnt vmcnt(25)
    v_mfma_f32_16x16x32_bf16 v[232:235], v[228:231], v[88:91], v[232:235]
    s_waitcnt vmcnt(24)
    v_mfma_f32_16x16x32_bf16 v[236:239], v[228:231], v[92:95], v[236:239]
    v_max3_u32 v16, v88, v92, v16
    s_waitcnt vmcnt(23)
    v_mfma_f32_16x16x32_bf16 v[232:235], v[224:227], v[96:99], v[232:235]
    s_waitcnt vmcnt(22)
    v_mfma_f32_16x16x32_bf16 v[236:239], v[224:227], v[100:103], v[236:239]
    v_max3_u32 v17, v96, v100, v17
    s_waitcnt vmcnt(21)
    v_mfma_f32_16x16x32_bf16 v[232:235], v[228:231], v[104:107], v[232:235]
    s_waitcnt vmcnt(20)
    v_mfma_f32_16x16x32_bf16 v[236:239], v[228:231], v[108:111], v[236:239]
    v_max3_u32 v16, v104, v108, v16
    s_waitcnt vmcnt(19)
    v_mfma_f32_16x16x32_bf16 v[232:235], v[224:227], v[112:115], v[232:235]
    s_waitcnt vmcnt(18)
    v_mfma_f32_16x16x32_bf16 v[236:239], v[224:227], v[116:119], v[236:239]
    v_max3_u32 v17, v112, v116, v17
    s_waitcnt vmcnt(17)
    v_mfma_f32_16x16x32_bf16 v[232:235], v[228:231], v[120:123], v[232:235]
    s_waitcnt vmcnt(16)
    v_mfma_f32_16x16x32_bf16 v[236:239], v[228:231], v[124:127], v[236:239]
    v_max3_u32 v16, v120, v124, v16
    s_waitcnt vmcnt(15)
    v_mfma_f32_16x16x32_bf16 v[232:235], v[224:227], v[128:131], v[232:235]
    s_waitcnt vmcnt(14)
    v_mfma_f32_16x16x32_bf16 v[236:239], v[224:227], v[132:135], v[236:239]
    v_max3_u32 v17, v128, v132, v17
    s_waitcnt vmcnt(13)
    v_mfma_f32_16x16x32_bf16 v[232:235], v[228:231], v[136:139], v[232:235]
    s_waitcnt vmcnt(12)
    v_mfma_f32_16x16x32_bf16 v[236:239], v[228:231], v[140:143], v[236:239]
    v_max3_u32 v16, v136, v140, v16
    s_waitcnt vmcnt(11)
    v_mfma_f32_16x16x32_bf16 v[232:235], v[224:227], v[144:147], v[232:235]
    s_waitcnt vmcnt(10)
    v_mfma_f32_16x16x32_bf16 v[236:239], v[224:227], v[148:151], v[236:239]
    v_max3_u32 v17, v144, v148, v17
    s_waitcnt vmcnt(9)
    v_mfma_f32_16x16x32_bf16 v[232:235], v[228:231], v[152:155], v[232:235]
    s_waitcnt vmcnt(8)
    v_mfma_f32_16x16x32_bf16 v[236:239], v[228:231], v[156:159], v[236:239]
    v_max3_u32 v16, v152, v156, v16
    s_waitcnt vmcnt(7)
    v_mfma_f32_16x16x32_bf16 v[232:235], v[224:227], v[160:163], v[232:235]
    s_waitcnt vmcnt(6)
    v_mfma_f32_16x16x32_bf16 v[236:239], v[224:227], v[164:167], v[236:239]
    v_max3_u32 v17, v160, v164, v17
    s_waitcnt vmcnt(5)
    v_mfma_f32_16x16x32_bf16 v[232:235], v[228:231], v[168:171], v[232:235]
    s_waitcnt vmcnt(4)
    v_mfma_f32_16x16x32_bf16 v[236:239], v[228:231], v[172:175], v[236:239]
    v_max3_u32 v16, v168, v172, v16
    s_waitcnt vmcnt(3)
    v_mfma_f32_16x16x32_bf16 v[232:235], v[224:227], v[176:179], v[232:235]
    s_waitcnt vmcnt(2)
    v_mfma_f32_16x16x32_bf16 v[236:239], v[224:227], v[180:183], v[236:239]
    v_max3_u32 v17, v176, v180, v17
    s_waitcnt vmcnt(1)
    v_mfma_f32_16x16x32_bf16 v[232:235], v[228:231], v[184:187], v[232:235]
    s_waitcnt vmcnt(0)
    v_mfma_f32_16x16x32_bf16 v[236:239], v[228:231], v[188:191], v[236:239]
    v_max3_u32 v16, v184, v188, v16
    v_max_u32 v16, v16, v17
    v_cmp_eq_u32 vcc, -1, v16
    s_cbranch_vccnz L_rer8
    s_nop 3
    v_permlane16_swap_b32 v232, v236
    v_permlane16_swap_b32 v233, v237
    v_permlane16_swap_b32 v234, v238
    v_permlane16_swap_b32 v235, v239
    v_pk_fma_f32 v[232:233], v[232:233], v[192:193], v[32:33]
    v_pk_fma_f32 v[234:235], v[234:235], v[194:195], v[34:35]
    v_pk_fma_f32 v[236:237], v[236:237], v[196:197], v[36:37]
    v_pk_fma_f32 v[238:239], v[238:239], v[198:199], v[38:39]
    v_cvt_pk_bf16_f32 v244, v232, v233
    v_cvt_pk_bf16_f32 v245, v234, v235
    v_cvt_pk_bf16_f32 v246, v236, v237
    v_cvt_pk_bf16_f32 v247, v238, v239
    v_lshlrev_b32 v32, 16, v244
    v_and_b32 v33, 0xffff0000, v244
    v_lshlrev_b32 v34, 16, v245
    v_and_b32 v35, 0xffff0000, v245
    v_lshlrev_b32 v36, 16, v246
    v_and_b32 v37, 0xffff0000, v246
    v_lshlrev_b32 v38, 16, v247
    v_and_b32 v39, 0xffff0000, v247
    v_add_f32 v16, v32, v33
    v_add_f32 v17, v34, v35
    v_add_f32 v16, v16, v36
    v_add_f32 v17, v17, v37
    v_add_f32 v16, v16, v38
    v_add_f32 v17, v17, v39
    v_add_f32 v16, v16, v17
    s_nop 1
    v_add_f32_dpp v16, v16, v16 row_ror:8 row_mask:0xf bank_mask:0xf
    s_nop 1
    v_add_f32_dpp v16, v16, v16 row_ror:4 row_mask:0xf bank_mask:0xf
    s_nop 1
    v_add_f32_dpp v16, v16, v16 row_ror:2 row_mask:0xf bank_mask:0xf
    s_nop 1
    v_add_f32_dpp v16, v16, v16 row_ror:1 row_mask:0xf bank_mask:0xf
    v_mov_b32 v17, v16
    s_nop 1
    v_permlane16_swap_b32 v16, v17
    v_add_f32 v16, v16, v17
    v_mov_b32 v17, v16
    s_nop 1
    v_permlane32_swap_b32 v16, v17
    v_add_f32 v16, v16, v17
    v_mul_f32 v16, s19, v16
    v_sub_f32 v32, v32, v16
    v_sub_f32 v33, v33, v16
    v_sub_f32 v34, v34, v16
    v_sub_f32 v35, v35, v16
    v_sub_f32 v36, v36, v16
    v_sub_f32 v37, v37, v16
    v_sub_f32 v38, v38, v16
    v_sub_f32 v39, v39, v16
    v_mul_f32 v16, v32, v32
    v_mul_f32 v17, v33, v33
    v_fmac_f32 v16, v34, v34
    v_fmac_f32 v17, v35, v35
    v_fmac_f32 v16, v36, v36
    v_fmac_f32 v17, v37, v37
    v_fmac_f32 v16, v38, v38
    v_fmac_f32 v17, v39, v39
    v_add_f32 v16, v16, v17
    s_nop 1
    v_add_f32_dpp v16, v16, v16 row_ror:8 row_mask:0xf bank_mask:0xf
    s_nop 1
    v_add_f32_dpp v16, v16, v16 row_ror:4 row_mask:0xf bank_mask:0xf
    s_nop 1
    v_add_f32_dpp v16, v16, v16 row_ror:2 row_mask:0xf bank_mask:0xf
    s_nop 1
    v_add_f32_dpp v16, v16, v16 row_ror:1 row_mask:0xf bank_mask:0xf
    v_mov_b32 v17, v16
    s_nop 1
    v_permlane16_swap_b32 v16, v17
    v_add_f32 v16, v16, v17
    v_mov_b32 v17, v16
    s_nop 1
    v_permlane32_swap_b32 v16, v17
    v_add_f32 v16, v16, v17
    v_mov_b32 v17, s20
    v_fma_f32 v16, v16, s19, v17
    v_rsq_f32 v16, v16
    s_nop 0
    v_mul_f32 v32, v32, v16
    v_mul_f32 v33, v33, v16
    v_mul_f32 v34, v34, v16
    v_mul_f32 v35, v35, v16
    v_mul_f32 v36, v36, v16
    v_mul_f32 v37, v37, v16
    v_mul_f32 v38, v38, v16
    v_mul_f32 v39, v39, v16
    v_pk_fma_f32 v[32:33], v[32:33], v[208:209], v[200:201]
    v_pk_fma_f32 v[34:35], v[34:35], v[210:211], v[202:203]
    v_pk_fma_f32 v[36:37], v[36:37], v[212:213], v[204:205]
    v_pk_fma_f32 v[38:39], v[38:39], v[214:215], v[206:207]
    v_cvt_pk_bf16_f32 v240, v32, v33
    v_cvt_pk_bf16_f32 v241, v34, v35
    v_cvt_pk_bf16_f32 v242, v36, v37
    v_cvt_pk_bf16_f32 v243, v38, v39
    v_min_u32 v240, -2, v240
    s_add_u32 s43, s27, 0x3b00000
    buffer_store_dwordx4 v[240:243], v2, s[4:7], s43 offen sc1
    s_waitcnt vmcnt(0)
    v_mov_b32 v4, s24
    s_mov_b64 exec, 0x1
    buffer_store_dword v4, v8, s[4:7], s23 offen sc1
    s_mov_b64 exec, -1
L_pf_23:
    s_cmp_lt_u32 s12, 4
    s_cbranch_scc1 L_r3
    s_cmp_lt_u32 s12, 64
    s_cbranch_scc1 L_r2
L_rc:
    v_mov_b64 v[248:249], v[244:245]
    v_mov_b64 v[250:251], v[246:247]
L_r2:
    s_mov_b32 s42, 0
    s_mov_b32 s42, 0
L_sp_27:
    buffer_load_dword v4, off, s[4:7], s22 sc1
    s_waitcnt vmcnt(0)
    v_cmp_gt_u32 vcc, s28, v4
    s_cbranch_vccz L_sd_28
    s_add_u32 s42, s42, 1
    s_cmp_lt_u32 s42, 2097152
    s_cbranch_scc1 L_sp_27
    s_branch L_fail
L_sd_28:
    s_mov_b32 exec_hi, 0
L_sp_24:
    buffer_load_dword v4, v13, s[4:7], s22 offen sc1
    s_waitcnt vmcnt(0)
    v_cmp_gt_u32 vcc, s28, v4
    s_mov_b64 exec, vcc
    s_cbranch_vccz L_s1_26
    s_add_u32 s42, s42, 1
    s_cmp_lt_u32 s42, 2097152
    s_cbranch_scc1 L_sp_24
    s_branch L_fail
L_s1_26:
    s_mov_b64 exec, -1
L_sd_25:
    v_lshlrev_b32 v32, 16, v248
    v_and_b32 v33, 0xffff0000, v248
    v_lshlrev_b32 v34, 16, v249
    v_and_b32 v35, 0xffff0000, v249
    v_lshlrev_b32 v36, 16, v250
    v_and_b32 v37, 0xffff0000, v250
    v_lshlrev_b32 v38, 16, v251
    v_and_b32 v39, 0xffff0000, v251
    s_mov_b32 s42, 0
L_red6:
    s_add_u32 s43, s26, 0
    buffer_load_dwordx4 v[64:67], v10, s[4:7], s43 offen offset:0 sc1
    buffer_load_dwordx4 v[68:71], v10, s[4:7], s43 offen offset:256 sc1
    buffer_load_dwordx4 v[72:75], v10, s[4:7], s43 offen offset:512 sc1
    buffer_load_dwordx4 v[76:79], v10, s[4:7], s43 offen offset:768 sc1
    s_add_u32 s43, s26, 131072
    buffer_load_dwordx4 v[80:83], v10, s[4:7], s43 offen offset:0 sc1
    buffer_load_dwordx4 v[84:87], v10, s[4:7], s43 offen offset:256 sc1
    buffer_load_dwordx4 v[88:91], v10, s[4:7], s43 offen offset:512 sc1
    buffer_load_dwordx4 v[92:95], v10, s[4:7], s43 offen offset:768 sc1
    s_add_u32 s43, s26, 262144
    buffer_load_dwordx4 v[96:99], v10, s[4:7], s43 offen offset:0 sc1
    buffer_load_dwordx4 v[100:103], v10, s[4:7], s43 offen offset:256 sc1
    buffer_load_dwordx4 v[104:107], v10, s[4:7], s43 offen offset:512 sc1
    buffer_load_dwordx4 v[108:111], v10, s[4:7], s43 offen offset:768 sc1
    s_add_u32 s43, s26, 393216
    buffer_load_dwordx4 v[112:115], v10, s[4:7], s43 offen offset:0 sc1
    buffer_load_dwordx4 v[116:119], v10, s[4:7], s43 offen offset:256 sc1
    buffer_load_dwordx4 v[120:123], v10, s[4:7], s43 offen offset:512 sc1
    buffer_load_dwordx4 v[124:127], v10, s[4:7], s43 offen offset:768 sc1
    s_add_u32 s43, s26, 524288
    buffer_load_dwordx4 v[128:131], v10, s[4:7], s43 offen offset:0 sc1
    buffer_load_dwordx4 v[132:135], v10, s[4:7], s43 offen offset:256 sc1
    buffer_load_dwordx4 v[136:139], v10, s[4:7], s43 offen offset:512 sc1
    buffer_load_dwordx4 v[140:143], v10, s[4:7], s43 offen offset:768 sc1
    s_add_u32 s43, s26, 655360
    buffer_load_dwordx4 v[144:147], v11, s[4:7], s43 offen offset:0 sc1
    buffer_load_dwordx4 v[148:151], v11, s[4:7], s43 offen offset:256 sc1
    buffer_load_dwordx4 v[152:155], v11, s[4:7], s43 offen offset:512 sc1
    buffer_load_dwordx4 v[156:159], v11, s[4:7], s43 offen offset:768 sc1
    s_waitcnt vmcnt(23)
    v_mfma_f32_16x16x32_bf16 v[232:235], v[224:227], v[64:67], 0
    s_waitcnt vmcnt(22)
    v_mfma_f32_16x16x32_bf16 v[236:239], v[224:227], v[68:71], 0
    s_waitcnt vmcnt(21)
    v_mfma_f32_16x16x32_bf16 v[232:235], v[228:231], v[72:75], v[232:235]
    v_max3_u32 v16, v64, v68, v72
    s_waitcnt vmcnt(20)
    v_mfma_f32_16x16x32_bf16 v[236:239], v[228:231], v[76:79], v[236:239]
    s_waitcnt vmcnt(19)
    v_mfma_f32_16x16x32_bf16 v[232:235], v[224:227], v[80:83], v[232:235]
    s_waitcnt vmcnt(18)
    v_mfma_f32_16x16x32_bf16 v[236:239], v[224:227], v[84:87], v[236:239]
    v_max3_u32 v17, v76, v80, v84
    s_waitcnt vmcnt(17)
    v_mfma_f32_16x16x32_bf16 v[232:235], v[228:231], v[88:91], v[232:235]
    s_waitcnt vmcnt(16)
    v_mfma_f32_16x16x32_bf16 v[236:239], v[228:231], v[92:95], v[236:239]
    v_max3_u32 v16, v88, v92, v16
    s_waitcnt vmcnt(15)
    v_mfma_f32_16x16x32_bf16 v[232:235], v[224:227], v[96:99], v[232:235]
    s_waitcnt vmcnt(14)
    v_mfma_f32_16x16x32_bf16 v[236:239], v[224:227], v[100:103], v[236:239]
    v_max3_u32 v17, v96, v100, v17
    s_waitcnt vmcnt(13)
    v_mfma_f32_16x16x32_bf16 v[232:235], v[228:231], v[104:107], v[232:235]
    s_waitcnt vmcnt(12)
    v_mfma_f32_16x16x32_bf16 v[236:239], v[228:231], v[108:111], v[236:239]
    v_max3_u32 v16, v104, v108, v16
    s_waitcnt vmcnt(11)
    v_mfma_f32_16x16x32_bf16 v[232:235], v[224:227], v[112:115], v[232:235]
    s_waitcnt vmcnt(10)
    v_mfma_f32_16x16x32_bf16 v[236:239], v[224:227], v[116:119], v[236:239]
    v_max3_u32 v17, v112, v116, v17
    s_waitcnt vmcnt(9)
    v_mfma_f32_16x16x32_bf16 v[232:235], v[228:231], v[120:123], v[232:235]
    s_waitcnt vmcnt(8)
    v_mfma_f32_16x16x32_bf16 v[236:239], v[228:231], v[124:127], v[236:239]
    v_max3_u32 v16, v120, v124, v16
    s_waitcnt vmcnt(7)
    v_mfma_f32_16x16x32_bf16 v[232:235], v[224:227], v[128:131], v[232:235]
    s_waitcnt vmcnt(6)
    v_mfma_f32_16x16x32_bf16 v[236:239], v[224:227], v[132:135], v[236:239]
    v_max3_u32 v17, v128, v132, v17
    s_waitcnt vmcnt(5)
    v_mfma_f32_16x16x32_bf16 v[232:235], v[228:231], v[136:139], v[232:235]
    s_waitcnt vmcnt(4)
    v_mfma_f32_16x16x32_bf16 v[236:239], v[228:231], v[140:143], v[236:239]
    v_max3_u32 v16, v136, v140, v16
    s_waitcnt vmcnt(3)
    v_mfma_f32_16x16x32_bf16 v[232:235], v[224:227], v[144:147], v[232:235]
    s_waitcnt vmcnt(2)
    v_mfma_f32_16x16x32_bf16 v[236:239], v[224:227], v[148:151], v[236:239]
    v_max3_u32 v17, v144, v148, v17
    s_waitcnt vmcnt(1)
    v_mfma_f32_16x16x32_bf16 v[232:235], v[228:231], v[152:155], v[232:235]
    s_waitcnt vmcnt(0)
    v_mfma_f32_16x16x32_bf16 v[236:239], v[228:231], v[156:159], v[236:239]
    v_max3_u32 v16, v152, v156, v16
    v_max_u32 v16, v16, v17
    v_cmp_eq_u32 vcc, -1, v16
    s_cbranch_vccnz L_rer6
    s_nop 3
    v_permlane16_swap_b32 v232, v236
    v_permlane16_swap_b32 v233, v237
    v_permlane16_swap_b32 v234, v238
    v_permlane16_swap_b32 v235, v239
    v_pk_fma_f32 v[232:233], v[232:233], v[216:217], v[32:33]
    v_pk_fma_f32 v[234:235], v[234:235], v[218:219], v[34:35]
    v_pk_fma_f32 v[236:237], v[236:237], v[220:221], v[36:37]
    v_pk_fma_f32 v[238:239], v[238:239], v[222:223], v[38:39]
    v_cvt_pk_bf16_f32 v248, v232, v233
    v_cvt_pk_bf16_f32 v249, v234, v235
    v_cvt_pk_bf16_f32 v250, v236, v237
    v_cvt_pk_bf16_f32 v251, v238, v239
    buffer_store_dwordx4 v[248:251], v2, s[60:63], s18 offen
    s_add_u32 s26, s26, 2883584
    s_add_u32 s18, s18, 131072
    s_add_u32 s28, s28, 4
    s_cmp_lt_u32 s12, 60
    s_cbranch_scc1 L_r3
    s_cmp_eq_u32 s28, s24
    s_cbranch_scc1 L_rc
L_r3:
    v_mov_b64 v[248:249], v[244:245]
    v_mov_b64 v[250:251], v[246:247]
    s_add_u32 s25, s25, 4194304
    s_add_u32 s27, s27, 131072
    s_add_u32 s12, s12, 4
    s_cmp_lt_u32 s12, 64
    s_cbranch_scc1 L_r
    s_branch L_done
L_rer8:
    s_add_u32 s42, s42, 1
    s_cmp_lt_u32 s42, 2097152
    s_cbranch_scc1 L_red8
    s_branch L_fail
L_rer6:
    s_add_u32 s42, s42, 1
    s_cmp_lt_u32 s42, 2097152
    s_cbranch_scc1 L_red6
    s_branch L_fail
L_role_kv:
    s_mov_b32 s44, s66
    s_mov_b32 s45, s67
    s_mov_b32 s46, 0x400000
    s_mov_b32 s47, 0x00020000
    s_mov_b32 s48, s68
    s_mov_b32 s49, s69
    s_mov_b32 s50, 0x400000
    s_mov_b32 s51, 0x00020000
    s_mov_b32 s52, s62
    s_mov_b32 s53, s63
    s_mov_b32 s54, 0x2000
    s_mov_b32 s55, 0x00020000
    s_mov_b32 s56, s64
    s_mov_b32 s57, s65
    s_mov_b32 s58, 0x400000
    s_mov_b32 s59, 0x00020000
    s_mov_b32 s8, s70
    s_mov_b32 s9, s71
    s_mov_b32 s10, 0x400000
    s_mov_b32 s11, 0x00020000
    v_and_b32 v1, 63, v0
    v_lshlrev_b32 v2, 4, v1
    s_lshl_b32 s43, s13, 10
    v_add_u32 v3, s43, v2
    s_mov_b32 s66, 0x05040100
    s_mov_b32 s67, 0x07060302
    s_lshr_b32 s64, s13, 1
    s_and_b32 s17, s13, 1
    s_lshl_b32 s16, s14, 8
    s_lshl_b32 s43, s64, 7
    s_add_u32 s16, s16, s43
    s_lshl_b32 s43, s17, 17
    s_add_u32 s16, s16, s43
    v_bfe_u32 v4, v1, 3, 3
    v_lshlrev_b32 v8, 13, v4
    v_bfe_u32 v4, v1, 0, 3
    v_lshl_add_u32 v8, v4, 4, v8
    v_bfe_u32 v4, v1, 4, 1
    v_lshlrev_b32 v4, 5, v4
    v_xor_b32 v8, v8, v4
    v_xor_b32 v9, 64, v8
    s_mul_i32 s17, s13, 32768
    s_add_u32 s43, s16, 0x0
    s_add_u32 m0, s17, 0
    s_nop 0
    buffer_load_dwordx4 v8, s[44:47], s43 offen lds
    s_add_u32 s43, s16, 0x10000
    s_add_u32 m0, s17, 1024
    s_nop 0
    buffer_load_dwordx4 v9, s[44:47], s43 offen lds
    s_add_u32 s43, s16, 0x40000
    s_add_u32 m0, s17, 2048
    s_nop 0
    buffer_load_dwordx4 v8, s[44:47], s43 offen lds
    s_add_u32 s43, s16, 0x50000
    s_add_u32 m0, s17, 3072
    s_nop 0
    buffer_load_dwordx4 v9, s[44:47], s43 offen lds
    s_add_u32 s43, s16, 0x80000
    s_add_u32 m0, s17, 4096
    s_nop 0
    buffer_load_dwordx4 v8, s[44:47], s43 offen lds
    s_add_u32 s43, s16, 0x90000
    s_add_u32 m0, s17, 5120
    s_nop 0
    buffer_load_dwordx4 v9, s[44:47], s43 offen lds
    s_add_u32 s43, s16, 0xc0000
    s_add_u32 m0, s17, 6144
    s_nop 0
    buffer_load_dwordx4 v8, s[44:47], s43 offen lds
    s_add_u32 s43, s16, 0xd0000
    s_add_u32 m0, s17, 7168
    s_nop 0
    buffer_load_dwordx4 v9, s[44:47], s43 offen lds
    s_add_u32 s43, s16, 0x100000
    s_add_u32 m0, s17, 8192
    s_nop 0
    buffer_load_dwordx4 v8, s[44:47], s43 offen lds
    s_add_u32 s43, s16, 0x110000
    s_add_u32 m0, s17, 9216
    s_nop 0
    buffer_load_dwordx4 v9, s[44:47], s43 offen lds
    s_add_u32 s43, s16, 0x140000
    s_add_u32 m0, s17, 10240
    s_nop 0
    buffer_load_dwordx4 v8, s[44:47], s43 offen lds
    s_add_u32 s43, s16, 0x150000
    s_add_u32 m0, s17, 11264
    s_nop 0
    buffer_load_dwordx4 v9, s[44:47], s43 offen lds
    s_add_u32 s43, s16, 0x180000
    s_add_u32 m0, s17, 12288
    s_nop 0
    buffer_load_dwordx4 v8, s[44:47], s43 offen lds
    s_add_u32 s43, s16, 0x190000
    s_add_u32 m0, s17, 13312
    s_nop 0
    buffer_load_dwordx4 v9, s[44:47], s43 offen lds
    s_add_u32 s43, s16, 0x1c0000
    s_add_u32 m0, s17, 14336
    s_nop 0
    buffer_load_dwordx4 v8, s[44:47], s43 offen lds
    s_add_u32 s43, s16, 0x1d0000
    s_add_u32 m0, s17, 15360
    s_nop 0
    buffer_load_dwordx4 v9, s[44:47], s43 offen lds
    s_add_u32 s43, s16, 0x200000
    s_add_u32 m0, s17, 16384
    s_nop 0
    buffer_load_dwordx4 v8, s[44:47], s43 offen lds
    s_add_u32 s43, s16, 0x210000
    s_add_u32 m0, s17, 17408
    s_nop 0
    buffer_load_dwordx4 v9, s[44:47], s43 offen lds
    s_add_u32 s43, s16, 0x240000
    s_add_u32 m0, s17, 18432
    s_nop 0
    buffer_load_dwordx4 v8, s[44:47], s43 offen lds
    s_add_u32 s43, s16, 0x250000
    s_add_u32 m0, s17, 19456
    s_nop 0
    buffer_load_dwordx4 v9, s[44:47], s43 offen lds
    s_add_u32 s43, s16, 0x280000
    s_add_u32 m0, s17, 20480
    s_nop 0
    buffer_load_dwordx4 v8, s[44:47], s43 offen lds
    s_add_u32 s43, s16, 0x290000
    s_add_u32 m0, s17, 21504
    s_nop 0
    buffer_load_dwordx4 v9, s[44:47], s43 offen lds
    s_add_u32 s43, s16, 0x2c0000
    s_add_u32 m0, s17, 22528
    s_nop 0
    buffer_load_dwordx4 v8, s[44:47], s43 offen lds
    s_add_u32 s43, s16, 0x2d0000
    s_add_u32 m0, s17, 23552
    s_nop 0
    buffer_load_dwordx4 v9, s[44:47], s43 offen lds
    s_add_u32 s43, s16, 0x300000
    s_add_u32 m0, s17, 24576
    s_nop 0
    buffer_load_dwordx4 v8, s[44:47], s43 offen lds
    s_add_u32 s43, s16, 0x310000
    s_add_u32 m0, s17, 25600
    s_nop 0
    buffer_load_dwordx4 v9, s[44:47], s43 offen lds
    s_add_u32 s43, s16, 0x340000
    s_add_u32 m0, s17, 26624
    s_nop 0
    buffer_load_dwordx4 v8, s[44:47], s43 offen lds
    s_add_u32 s43, s16, 0x350000
    s_add_u32 m0, s17, 27648
    s_nop 0
    buffer_load_dwordx4 v9, s[44:47], s43 offen lds
    s_add_u32 s43, s16, 0x380000
    s_add_u32 m0, s17, 28672
    s_nop 0
    buffer_load_dwordx4 v8, s[44:47], s43 offen lds
    s_add_u32 s43, s16, 0x390000
    s_add_u32 m0, s17, 29696
    s_nop 0
    buffer_load_dwordx4 v9, s[44:47], s43 offen lds
    s_add_u32 s43, s16, 0x3c0000
    s_add_u32 m0, s17, 30720
    s_nop 0
    buffer_load_dwordx4 v8, s[44:47], s43 offen lds
    s_add_u32 s43, s16, 0x3d0000
    s_add_u32 m0, s17, 31744
    s_nop 0
    buffer_load_dwordx4 v9, s[44:47], s43 offen lds
    v_bfe_u32 v4, v1, 5, 1
    v_lshlrev_b32 v10, 15, v4
    v_bfe_u32 v4, v1, 4, 1
    v_mul_u32_u24 v4, 1088, v4
    v_add_u32 v10, v10, v4
    v_bfe_u32 v4, v1, 3, 1
    v_mul_u32_u24 v4, 288, v4
    v_add_u32 v10, v10, v4
    v_bfe_u32 v4, v1, 2, 1
    v_lshl_add_u32 v10, v4, 7, v10
    v_bfe_u32 v4, v1, 0, 2
    v_lshl_add_u32 v10, v4, 3, v10
    s_and_b32 s43, s13, 1
    s_lshl_b32 s43, s43, 6
    v_xor_b32 v10, s43, v10
    s_and_b32 s43, s13, 2
    s_mul_i32 s43, s43, 32768
    v_add_u32 v10, s43, v10
    v_xor_b32 v11, 32, v10
    s_waitcnt vmcnt(28)
    s_waitcnt lgkmcnt(0)
    s_barrier
    ds_read_b64_tr_b16 a[0:1], v10 offset:0
    ds_read_b64_tr_b16 a[2:3], v10 offset:512
    ds_read_b64_tr_b16 a[4:5], v11 offset:0
    ds_read_b64_tr_b16 a[6:7], v11 offset:512
    ds_read_b64_tr_b16 a[8:9], v10 offset:2048
    ds_read_b64_tr_b16 a[10:11], v10 offset:2560
    ds_read_b64_tr_b16 a[12:13], v11 offset:2048
    ds_read_b64_tr_b16 a[14:15], v11 offset:2560
    s_waitcnt vmcnt(24)
    s_waitcnt lgkmcnt(0)
    s_barrier
    s_add_u32 s43, s16, 0x0
    s_add_u32 m0, s17, 0
    s_nop 0
    buffer_load_dwordx4 v8, s[48:51], s43 offen lds
    s_add_u32 s43, s16, 0x10000
    s_add_u32 m0, s17, 1024
    s_nop 0
    buffer_load_dwordx4 v9, s[48:51], s43 offen lds
    s_add_u32 s43, s16, 0x40000
    s_add_u32 m0, s17, 2048
    s_nop 0
    buffer_load_dwordx4 v8, s[48:51], s43 offen lds
    s_add_u32 s43, s16, 0x50000
    s_add_u32 m0, s17, 3072
    s_nop 0
    buffer_load_dwordx4 v9, s[48:51], s43 offen lds
    ds_read_b64_tr_b16 a[16:17], v10 offset:4096
    ds_read_b64_tr_b16 a[18:19], v10 offset:4608
    ds_read_b64_tr_b16 a[20:21], v11 offset:4096
    ds_read_b64_tr_b16 a[22:23], v11 offset:4608
    ds_read_b64_tr_b16 a[24:25], v10 offset:6144
    ds_read_b64_tr_b16 a[26:27], v10 offset:6656
    ds_read_b64_tr_b16 a[28:29], v11 offset:6144
    ds_read_b64_tr_b16 a[30:31], v11 offset:6656
    s_waitcnt vmcnt(24)
    s_waitcnt lgkmcnt(0)
    s_barrier
    s_add_u32 s43, s16, 0x80000
    s_add_u32 m0, s17, 4096
    s_nop 0
    buffer_load_dwordx4 v8, s[48:51], s43 offen lds
    s_add_u32 s43, s16, 0x90000
    s_add_u32 m0, s17, 5120
    s_nop 0
    buffer_load_dwordx4 v9, s[48:51], s43 offen lds
    s_add_u32 s43, s16, 0xc0000
    s_add_u32 m0, s17, 6144
    s_nop 0
    buffer_load_dwordx4 v8, s[48:51], s43 offen lds
    s_add_u32 s43, s16, 0xd0000
    s_add_u32 m0, s17, 7168
    s_nop 0
    buffer_load_dwordx4 v9, s[48:51], s43 offen lds
    ds_read_b64_tr_b16 a[32:33], v10 offset:8192
    ds_read_b64_tr_b16 a[34:35], v10 offset:8704
    ds_read_b64_tr_b16 a[36:37], v11 offset:8192
    ds_read_b64_tr_b16 a[38:39], v11 offset:8704
    ds_read_b64_tr_b16 a[40:41], v10 offset:10240
    ds_read_b64_tr_b16 a[42:43], v10 offset:10752
    ds_read_b64_tr_b16 a[44:45], v11 offset:10240
    ds_read_b64_tr_b16 a[46:47], v11 offset:10752
    s_waitcnt vmcnt(24)
    s_waitcnt lgkmcnt(0)
    s_barrier
    s_add_u32 s43, s16, 0x100000
    s_add_u32 m0, s17, 8192
    s_nop 0
    buffer_load_dwordx4 v8, s[48:51], s43 offen lds
    s_add_u32 s43, s16, 0x110000
    s_add_u32 m0, s17, 9216
    s_nop 0
    buffer_load_dwordx4 v9, s[48:51], s43 offen lds
    s_add_u32 s43, s16, 0x140000
    s_add_u32 m0, s17, 10240
    s_nop 0
    buffer_load_dwordx4 v8, s[48:51], s43 offen lds
    s_add_u32 s43, s16, 0x150000
    s_add_u32 m0, s17, 11264
    s_nop 0
    buffer_load_dwordx4 v9, s[48:51], s43 offen lds
    ds_read_b64_tr_b16 a[48:49], v10 offset:12288
    ds_read_b64_tr_b16 a[50:51], v10 offset:12800
    ds_read_b64_tr_b16 a[52:53], v11 offset:12288
    ds_read_b64_tr_b16 a[54:55], v11 offset:12800
    ds_read_b64_tr_b16 a[56:57], v10 offset:14336
    ds_read_b64_tr_b16 a[58:59], v10 offset:14848
    ds_read_b64_tr_b16 a[60:61], v11 offset:14336
    ds_read_b64_tr_b16 a[62:63], v11 offset:14848
    s_waitcnt vmcnt(24)
    s_waitcnt lgkmcnt(0)
    s_barrier
    s_add_u32 s43, s16, 0x180000
    s_add_u32 m0, s17, 12288
    s_nop 0
    buffer_load_dwordx4 v8, s[48:51], s43 offen lds
    s_add_u32 s43, s16, 0x190000
    s_add_u32 m0, s17, 13312
    s_nop 0
    buffer_load_dwordx4 v9, s[48:51], s43 offen lds
    s_add_u32 s43, s16, 0x1c0000
    s_add_u32 m0, s17, 14336
    s_nop 0
    buffer_load_dwordx4 v8, s[48:51], s43 offen lds
    s_add_u32 s43, s16, 0x1d0000
    s_add_u32 m0, s17, 15360
    s_nop 0
    buffer_load_dwordx4 v9, s[48:51], s43 offen lds
    ds_read_b64_tr_b16 a[64:65], v10 offset:16384
    ds_read_b64_tr_b16 a[66:67], v10 offset:16896
    ds_read_b64_tr_b16 a[68:69], v11 offset:16384
    ds_read_b64_tr_b16 a[70:71], v11 offset:16896
    ds_read_b64_tr_b16 a[72:73], v10 offset:18432
    ds_read_b64_tr_b16 a[74:75], v10 offset:18944
    ds_read_b64_tr_b16 a[76:77], v11 offset:18432
    ds_read_b64_tr_b16 a[78:79], v11 offset:18944
    s_waitcnt vmcnt(24)
    s_waitcnt lgkmcnt(0)
    s_barrier
    s_add_u32 s43, s16, 0x200000
    s_add_u32 m0, s17, 16384
    s_nop 0
    buffer_load_dwordx4 v8, s[48:51], s43 offen lds
    s_add_u32 s43, s16, 0x210000
    s_add_u32 m0, s17, 17408
    s_nop 0
    buffer_load_dwordx4 v9, s[48:51], s43 offen lds
    s_add_u32 s43, s16, 0x240000
    s_add_u32 m0, s17, 18432
    s_nop 0
    buffer_load_dwordx4 v8, s[48:51], s43 offen lds
    s_add_u32 s43, s16, 0x250000
    s_add_u32 m0, s17, 19456
    s_nop 0
    buffer_load_dwordx4 v9, s[48:51], s43 offen lds
    ds_read_b64_tr_b16 a[80:81], v10 offset:20480
    ds_read_b64_tr_b16 a[82:83], v10 offset:20992
    ds_read_b64_tr_b16 a[84:85], v11 offset:20480
    ds_read_b64_tr_b16 a[86:87], v11 offset:20992
    ds_read_b64_tr_b16 a[88:89], v10 offset:22528
    ds_read_b64_tr_b16 a[90:91], v10 offset:23040
    ds_read_b64_tr_b16 a[92:93], v11 offset:22528
    ds_read_b64_tr_b16 a[94:95], v11 offset:23040
    s_waitcnt vmcnt(24)
    s_waitcnt lgkmcnt(0)
    s_barrier
    s_add_u32 s43, s16, 0x280000
    s_add_u32 m0, s17, 20480
    s_nop 0
    buffer_load_dwordx4 v8, s[48:51], s43 offen lds
    s_add_u32 s43, s16, 0x290000
    s_add_u32 m0, s17, 21504
    s_nop 0
    buffer_load_dwordx4 v9, s[48:51], s43 offen lds
    s_add_u32 s43, s16, 0x2c0000
    s_add_u32 m0, s17, 22528
    s_nop 0
    buffer_load_dwordx4 v8, s[48:51], s43 offen lds
    s_add_u32 s43, s16, 0x2d0000
    s_add_u32 m0, s17, 23552
    s_nop 0
    buffer_load_dwordx4 v9, s[48:51], s43 offen lds
    ds_read_b64_tr_b16 a[96:97], v10 offset:24576
    ds_read_b64_tr_b16 a[98:99], v10 offset:25088
    ds_read_b64_tr_b16 a[100:101], v11 offset:24576
    ds_read_b64_tr_b16 a[102:103], v11 offset:25088
    ds_read_b64_tr_b16 a[104:105], v10 offset:26624
    ds_read_b64_tr_b16 a[106:107], v10 offset:27136
    ds_read_b64_tr_b16 a[108:109], v11 offset:26624
    ds_read_b64_tr_b16 a[110:111], v11 offset:27136
    s_waitcnt vmcnt(24)
    s_waitcnt lgkmcnt(0)
    s_barrier
    s_add_u32 s43, s16, 0x300000
    s_add_u32 m0, s17, 24576
    s_nop 0
    buffer_load_dwordx4 v8, s[48:51], s43 offen lds
    s_add_u32 s43, s16, 0x310000
    s_add_u32 m0, s17, 25600
    s_nop 0
    buffer_load_dwordx4 v9, s[48:51], s43 offen lds
    s_add_u32 s43, s16, 0x340000
    s_add_u32 m0, s17, 26624
    s_nop 0
    buffer_load_dwordx4 v8, s[48:51], s43 offen lds
    s_add_u32 s43, s16, 0x350000
    s_add_u32 m0, s17, 27648
    s_nop 0
    buffer_load_dwordx4 v9, s[48:51], s43 offen lds
    ds_read_b64_tr_b16 a[112:113], v10 offset:28672
    ds_read_b64_tr_b16 a[114:115], v10 offset:29184
    ds_read_b64_tr_b16 a[116:117], v11 offset:28672
    ds_read_b64_tr_b16 a[118:119], v11 offset:29184
    ds_read_b64_tr_b16 a[120:121], v10 offset:30720
    ds_read_b64_tr_b16 a[122:123], v10 offset:31232
    ds_read_b64_tr_b16 a[124:125], v11 offset:30720
    ds_read_b64_tr_b16 a[126:127], v11 offset:31232
    s_waitcnt vmcnt(24)
    s_waitcnt lgkmcnt(0)
    s_barrier
    s_add_u32 s43, s16, 0x380000
    s_add_u32 m0, s17, 28672
    s_nop 0
    buffer_load_dwordx4 v8, s[48:51], s43 offen lds
    s_add_u32 s43, s16, 0x390000
    s_add_u32 m0, s17, 29696
    s_nop 0
    buffer_load_dwordx4 v9, s[48:51], s43 offen lds
    s_add_u32 s43, s16, 0x3c0000
    s_add_u32 m0, s17, 30720
    s_nop 0
    buffer_load_dwordx4 v8, s[48:51], s43 offen lds
    s_add_u32 s43, s16, 0x3d0000
    s_add_u32 m0, s17, 31744
    s_nop 0
    buffer_load_dwordx4 v9, s[48:51], s43 offen lds
    ds_read_b64_tr_b16 a[128:129], v10 offset:0
    ds_read_b64_tr_b16 a[130:131], v10 offset:512
    ds_read_b64_tr_b16 a[132:133], v11 offset:0
    ds_read_b64_tr_b16 a[134:135], v11 offset:512
    ds_read_b64_tr_b16 a[136:137], v10 offset:2048
    ds_read_b64_tr_b16 a[138:139], v10 offset:2560
    ds_read_b64_tr_b16 a[140:141], v11 offset:2048
    ds_read_b64_tr_b16 a[142:143], v11 offset:2560
    s_waitcnt vmcnt(24)
    s_waitcnt lgkmcnt(0)
    s_barrier
    ds_read_b64_tr_b16 a[144:145], v10 offset:4096
    ds_read_b64_tr_b16 a[146:147], v10 offset:4608
    ds_read_b64_tr_b16 a[148:149], v11 offset:4096
    ds_read_b64_tr_b16 a[150:151], v11 offset:4608
    ds_read_b64_tr_b16 a[152:153], v10 offset:6144
    ds_read_b64_tr_b16 a[154:155], v10 offset:6656
    ds_read_b64_tr_b16 a[156:157], v11 offset:6144
    ds_read_b64_tr_b16 a[158:159], v11 offset:6656
    s_waitcnt vmcnt(20)
    s_waitcnt lgkmcnt(0)
    s_barrier
    ds_read_b64_tr_b16 a[160:161], v10 offset:8192
    ds_read_b64_tr_b16 a[162:163], v10 offset:8704
    ds_read_b64_tr_b16 a[164:165], v11 offset:8192
    ds_read_b64_tr_b16 a[166:167], v11 offset:8704
    ds_read_b64_tr_b16 a[168:169], v10 offset:10240
    ds_read_b64_tr_b16 a[170:171], v10 offset:10752
    ds_read_b64_tr_b16 a[172:173], v11 offset:10240
    ds_read_b64_tr_b16 a[174:175], v11 offset:10752
    s_waitcnt vmcnt(16)
    s_waitcnt lgkmcnt(0)
    s_barrier
    ds_read_b64_tr_b16 a[176:177], v10 offset:12288
    ds_read_b64_tr_b16 a[178:179], v10 offset:12800
    ds_read_b64_tr_b16 a[180:181], v11 offset:12288
    ds_read_b64_tr_b16 a[182:183], v11 offset:12800
    ds_read_b64_tr_b16 a[184:185], v10 offset:14336
    ds_read_b64_tr_b16 a[186:187], v10 offset:14848
    ds_read_b64_tr_b16 a[188:189], v11 offset:14336
    ds_read_b64_tr_b16 a[190:191], v11 offset:14848
    s_waitcnt vmcnt(12)
    s_waitcnt lgkmcnt(0)
    s_barrier
    ds_read_b64_tr_b16 a[192:193], v10 offset:16384
    ds_read_b64_tr_b16 a[194:195], v10 offset:16896
    ds_read_b64_tr_b16 a[196:197], v11 offset:16384
    ds_read_b64_tr_b16 a[198:199], v11 offset:16896
    ds_read_b64_tr_b16 a[200:201], v10 offset:18432
    ds_read_b64_tr_b16 a[202:203], v10 offset:18944
    ds_read_b64_tr_b16 a[204:205], v11 offset:18432
    ds_read_b64_tr_b16 a[206:207], v11 offset:18944
    s_waitcnt vmcnt(8)
    s_waitcnt lgkmcnt(0)
    s_barrier
    ds_read_b64_tr_b16 a[208:209], v10 offset:20480
    ds_read_b64_tr_b16 a[210:211], v10 offset:20992
    ds_read_b64_tr_b16 a[212:213], v11 offset:20480
    ds_read_b64_tr_b16 a[214:215], v11 offset:20992
    ds_read_b64_tr_b16 a[216:217], v10 offset:22528
    ds_read_b64_tr_b16 a[218:219], v10 offset:23040
    ds_read_b64_tr_b16 a[220:221], v11 offset:22528
    ds_read_b64_tr_b16 a[222:223], v11 offset:23040
    s_waitcnt vmcnt(4)
    s_waitcnt lgkmcnt(0)
    s_barrier
    ds_read_b64_tr_b16 a[224:225], v10 offset:24576
    ds_read_b64_tr_b16 a[226:227], v10 offset:25088
    ds_read_b64_tr_b16 a[228:229], v11 offset:24576
    ds_read_b64_tr_b16 a[230:231], v11 offset:25088
    ds_read_b64_tr_b16 a[232:233], v10 offset:26624
    ds_read_b64_tr_b16 a[234:235], v10 offset:27136
    ds_read_b64_tr_b16 a[236:237], v11 offset:26624
    ds_read_b64_tr_b16 a[238:239], v11 offset:27136
    s_waitcnt vmcnt(0)
    s_waitcnt lgkmcnt(0)
    s_barrier
    ds_read_b64_tr_b16 a[240:241], v10 offset:28672
    ds_read_b64_tr_b16 a[242:243], v10 offset:29184
    ds_read_b64_tr_b16 a[244:245], v11 offset:28672
    ds_read_b64_tr_b16 a[246:247], v11 offset:29184
    ds_read_b64_tr_b16 a[248:249], v10 offset:30720
    ds_read_b64_tr_b16 a[250:251], v10 offset:31232
    ds_read_b64_tr_b16 a[252:253], v11 offset:30720
    ds_read_b64_tr_b16 a[254:255], v11 offset:31232
    s_waitcnt lgkmcnt(0)
    s_barrier
    v_bfe_u32 v4, v1, 4, 2
    v_and_b32 v5, 7, v1
    v_xor_b32 v5, v5, v4
    s_and_b32 s64, s13, 1
    s_lshl_b32 s64, s64, 2
    v_xor_b32 v5, s64, v5
    v_lshrrev_b32 v4, 3, v1
    v_lshlrev_b32 v6, 10, v4
    v_lshl_add_u32 v6, v5, 4, v6
    s_lshl_b32 s19, s13, 13
    s_lshl_b32 s64, s15, 15
    s_add_u32 s18, s19, s64
    s_add_u32 s18, s18, 0x3900000
    v_bfe_u32 v4, v1, 1, 3
    v_lshrrev_b32 v5, 4, v1
    v_xor_b32 v5, v5, v4
    v_bfe_u32 v4, v1, 3, 1
    v_lshlrev_b32 v30, 13, v4
    v_bfe_u32 v4, v1, 0, 3
    v_lshl_add_u32 v30, v4, 7, v30
    v_lshl_add_u32 v30, v5, 4, v30
    v_xor_b32 v31, 64, v30
    s_lshl_b32 s20, s15, 19
    s_lshl_b32 s43, s14, 14
    s_add_u32 s20, s20, s43
    s_add_u32 s20, s20, 0x1000000
    s_lshl_b32 s24, s14, 8
    s_lshl_b32 s43, s15, 7
    s_add_u32 s24, s24, s43
    s_add_u32 s24, s24, 0x180000
    s_lshl_b32 s30, s15, 17
    s_lshl_b32 s43, s14, 12
    s_add_u32 s30, s30, s43
    s_add_u32 s30, s30, 0x3040000
    s_mov_b32 s31, s30
    v_mov_b32 v216, -1
    v_mov_b32 v217, -1
    v_mov_b32 v218, -1
    v_mov_b32 v219, -1
    s_lshl_b32 s27, s15, 13
    s_add_u32 s27, s27, 0x3840000
    s_sub_u32 s29, s15, 1
    v_bfe_u32 v4, v1, 5, 1
    v_lshlrev_b32 v10, 8, v4
    v_bfe_u32 v4, v1, 2, 2
    v_lshl_add_u32 v10, v4, 6, v10
    v_bfe_u32 v4, v1, 4, 1
    v_lshl_add_u32 v10, v4, 5, v10
    v_bfe_u32 v4, v1, 0, 1
    v_lshl_add_u32 v10, v4, 4, v10
    v_add_u32 v10, 65536, v10
    v_add_u32 v13, 65536, v3
    v_bfe_u32 v4, v1, 2, 2
    v_lshlrev_b32 v8, 11, v4
    v_bfe_u32 v4, v1, 0, 1
    v_lshl_add_u32 v8, v4, 10, v8
    v_bfe_u32 v4, v1, 1, 1
    v_lshl_add_u32 v8, v4, 4, v8
    v_bfe_u32 v4, v1, 4, 2
    v_lshl_add_u32 v8, v4, 5, v8
    s_lshl_b32 s43, s13, 7
    v_add_u32 v8, s43, v8
    s_mov_b32 s12, s15
    s_mov_b32 s26, s15
    s_cmp_eq_u32 s13, 0
    s_cbranch_scc0 L_kv_h1
    v_mov_b32 v5, 0
    s_mov_b32 s42, 0
L_kv_h0:
    global_load_dwordx2 v[220:221], v5, s[92:93] offset:128 sc1
    s_waitcnt vmcnt(0)
    v_and_b32 v4, 3, v220
    v_add_u32 v4, v4, v221
    v_cmp_gt_u32 vcc, 35, v4
    s_cbranch_vccz L_kv_h1
    s_add_u32 s42, s42, 1
    s_cmp_lt_u32 s42, 2097152
    s_cbranch_scc1 L_kv_h0
    s_branch L_fail
L_kv_h1:
    s_barrier
    s_add_u32 m0, s19, 0
    s_nop 0
    buffer_load_dwordx4 v6, s[4:7], s18 offen offset:0 sc1 lds
    s_add_u32 m0, s19, 896
    s_nop 0
    buffer_load_dwordx4 v6, s[4:7], s18 offen offset:128 sc1 lds
    s_add_u32 m0, s19, 1792
    s_nop 0
    buffer_load_dwordx4 v6, s[4:7], s18 offen offset:256 sc1 lds
    s_add_u32 m0, s19, 2688
    s_nop 0
    buffer_load_dwordx4 v6, s[4:7], s18 offen offset:384 sc1 lds
    s_add_u32 m0, s19, 3584
    s_nop 0
    buffer_load_dwordx4 v6, s[4:7], s18 offen offset:512 sc1 lds
    s_add_u32 m0, s19, 4480
    s_nop 0
    buffer_load_dwordx4 v6, s[4:7], s18 offen offset:640 sc1 lds
    s_add_u32 m0, s19, 5376
    s_nop 0
    buffer_load_dwordx4 v6, s[4:7], s18 offen offset:768 sc1 lds
    s_add_u32 m0, s19, 6272
    s_nop 0
    buffer_load_dwordx4 v6, s[4:7], s18 offen offset:896 sc1 lds
    s_waitcnt vmcnt(0)
    s_barrier
L_kv:
    s_add_u32 s18, s18, 65536
    s_xor_b32 s19, s19, 32768
    s_add_u32 s21, s20, 4096
    s_add_u32 s22, s20, 8192
    s_add_u32 s23, s20, 12288
    ds_read_b128 v[32:35], v30 offset:0
    ds_read_b128 v[36:39], v30 offset:16384
    ds_read_b128 v[40:43], v31 offset:0
    ds_read_b128 v[44:47], v31 offset:16384
    ds_read_b128 v[48:51], v30 offset:1024
    ds_read_b128 v[52:55], v30 offset:17408
    ds_read_b128 v[56:59], v31 offset:1024
    ds_read_b128 v[60:63], v31 offset:17408
    s_waitcnt lgkmcnt(6)
    v_mfma_f32_16x16x32_bf16 v[160:163], a[0:3], v[32:35], 0
    ds_read_b128 v[64:67], v30 offset:2048
    ds_read_b128 v[68:71], v30 offset:18432
    v_mfma_f32_16x16x32_bf16 v[176:179], v[32:35], a[128:131], 0
    v_mfma_f32_16x16x32_bf16 v[164:167], a[4:7], v[32:35], 0
    buffer_store_dwordx4 v[216:219], v3, s[4:7], s31 offen sc1
    v_mfma_f32_16x16x32_bf16 v[180:183], v[32:35], a[132:135], 0
    v_mfma_f32_16x16x32_bf16 v[168:171], a[0:3], v[36:39], 0
    v_mfma_f32_16x16x32_bf16 v[184:187], v[36:39], a[128:131], 0
    v_mfma_f32_16x16x32_bf16 v[172:175], a[4:7], v[36:39], 0
    v_mfma_f32_16x16x32_bf16 v[188:191], v[36:39], a[132:135], 0
    s_waitcnt lgkmcnt(6)
    v_mfma_f32_16x16x32_bf16 v[160:163], a[8:11], v[40:43], v[160:163]
    ds_read_b128 v[72:75], v31 offset:2048
    ds_read_b128 v[76:79], v31 offset:18432
    v_mfma_f32_16x16x32_bf16 v[176:179], v[40:43], a[136:139], v[176:179]
    v_mfma_f32_16x16x32_bf16 v[164:167], a[12:15], v[40:43], v[164:167]
    s_add_u32 m0, s19, 0
    s_nop 0
    buffer_load_dwordx4 v6, s[4:7], s18 offen offset:0 sc1 lds
    v_mfma_f32_16x16x32_bf16 v[180:183], v[40:43], a[140:143], v[180:183]
    v_mfma_f32_16x16x32_bf16 v[168:171], a[8:11], v[44:47], v[168:171]
    v_mfma_f32_16x16x32_bf16 v[184:187], v[44:47], a[136:139], v[184:187]
    v_mfma_f32_16x16x32_bf16 v[172:175], a[12:15], v[44:47], v[172:175]
    v_mfma_f32_16x16x32_bf16 v[188:191], v[44:47], a[140:143], v[188:191]
    s_waitcnt lgkmcnt(6)
    v_mfma_f32_16x16x32_bf16 v[160:163], a[16:19], v[48:51], v[160:163]
    ds_read_b128 v[80:83], v30 offset:3072
    ds_read_b128 v[84:87], v30 offset:19456
    v_mfma_f32_16x16x32_bf16 v[176:179], v[48:51], a[144:147], v[176:179]
    v_mfma_f32_16x16x32_bf16 v[164:167], a[20:23], v[48:51], v[164:167]
    s_add_u32 m0, s19, 896
    s_nop 0
    buffer_load_dwordx4 v6, s[4:7], s18 offen offset:128 sc1 lds
    v_mfma_f32_16x16x32_bf16 v[180:183], v[48:51], a[148:151], v[180:183]
    v_mfma_f32_16x16x32_bf16 v[168:171], a[16:19], v[52:55], v[168:171]
    v_mfma_f32_16x16x32_bf16 v[184:187], v[52:55], a[144:147], v[184:187]
    v_mfma_f32_16x16x32_bf16 v[172:175], a[20:23], v[52:55], v[172:175]
    v_mfma_f32_16x16x32_bf16 v[188:191], v[52:55], a[148:151], v[188:191]
    s_waitcnt lgkmcnt(6)
    v_mfma_f32_16x16x32_bf16 v[160:163], a[24:27], v[56:59], v[160:163]
    ds_read_b128 v[88:91], v31 offset:3072
    ds_read_b128 v[92:95], v31 offset:19456
    v_mfma_f32_16x16x32_bf16 v[176:179], v[56:59], a[152:155], v[176:179]
    v_mfma_f32_16x16x32_bf16 v[164:167], a[28:31], v[56:59], v[164:167]
    s_add_u32 m0, s19, 1792
    s_nop 0
    buffer_load_dwordx4 v6, s[4:7], s18 offen offset:256 sc1 lds
    v_mfma_f32_16x16x32_bf16 v[180:183], v[56:59], a[156:159], v[180:183]
    v_mfma_f32_16x16x32_bf16 v[168:171], a[24:27], v[60:63], v[168:171]
    v_mfma_f32_16x16x32_bf16 v[184:187], v[60:63], a[152:155], v[184:187]
    v_mfma_f32_16x16x32_bf16 v[172:175], a[28:31], v[60:63], v[172:175]
    v_mfma_f32_16x16x32_bf16 v[188:191], v[60:63], a[156:159], v[188:191]
    s_waitcnt lgkmcnt(6)
    v_mfma_f32_16x16x32_bf16 v[160:163], a[32:35], v[64:67], v[160:163]
    ds_read_b128 v[96:99], v30 offset:4096
    ds_read_b128 v[100:103], v30 offset:20480
    v_mfma_f32_16x16x32_bf16 v[176:179], v[64:67], a[160:163], v[176:179]
    v_mfma_f32_16x16x32_bf16 v[164:167], a[36:39], v[64:67], v[164:167]
    s_add_u32 m0, s19, 2688
    s_nop 0
    buffer_load_dwordx4 v6, s[4:7], s18 offen offset:384 sc1 lds
    v_mfma_f32_16x16x32_bf16 v[180:183], v[64:67], a[164:167], v[180:183]
    v_mfma_f32_16x16x32_bf16 v[168:171], a[32:35], v[68:71], v[168:171]
    v_mfma_f32_16x16x32_bf16 v[184:187], v[68:71], a[160:163], v[184:187]
    v_mfma_f32_16x16x32_bf16 v[172:175], a[36:39], v[68:71], v[172:175]
    v_mfma_f32_16x16x32_bf16 v[188:191], v[68:71], a[164:167], v[188:191]
    s_waitcnt lgkmcnt(6)
    v_mfma_f32_16x16x32_bf16 v[160:163], a[40:43], v[72:75], v[160:163]
    ds_read_b128 v[104:107], v31 offset:4096
    ds_read_b128 v[108:111], v31 offset:20480
    v_mfma_f32_16x16x32_bf16 v[176:179], v[72:75], a[168:171], v[176:179]
    v_mfma_f32_16x16x32_bf16 v[164:167], a[44:47], v[72:75], v[164:167]
    s_add_u32 m0, s19, 3584
    s_nop 0
    buffer_load_dwordx4 v6, s[4:7], s18 offen offset:512 sc1 lds
    v_mfma_f32_16x16x32_bf16 v[180:183], v[72:75], a[172:175], v[180:183]
    v_mfma_f32_16x16x32_bf16 v[168:171], a[40:43], v[76:79], v[168:171]
    v_mfma_f32_16x16x32_bf16 v[184:187], v[76:79], a[168:171], v[184:187]
    v_mfma_f32_16x16x32_bf16 v[172:175], a[44:47], v[76:79], v[172:175]
    v_mfma_f32_16x16x32_bf16 v[188:191], v[76:79], a[172:175], v[188:191]
    s_waitcnt lgkmcnt(6)
    v_mfma_f32_16x16x32_bf16 v[160:163], a[48:51], v[80:83], v[160:163]
    ds_read_b128 v[112:115], v30 offset:5120
    ds_read_b128 v[116:119], v30 offset:21504
    v_mfma_f32_16x16x32_bf16 v[176:179], v[80:83], a[176:179], v[176:179]
    v_mfma_f32_16x16x32_bf16 v[164:167], a[52:55], v[80:83], v[164:167]
    s_add_u32 m0, s19, 4480
    s_nop 0
    buffer_load_dwordx4 v6, s[4:7], s18 offen offset:640 sc1 lds
    v_mfma_f32_16x16x32_bf16 v[180:183], v[80:83], a[180:183], v[180:183]
    v_mfma_f32_16x16x32_bf16 v[168:171], a[48:51], v[84:87], v[168:171]
    v_mfma_f32_16x16x32_bf16 v[184:187], v[84:87], a[176:179], v[184:187]
    v_mfma_f32_16x16x32_bf16 v[172:175], a[52:55], v[84:87], v[172:175]
    v_mfma_f32_16x16x32_bf16 v[188:191], v[84:87], a[180:183], v[188:191]
    s_waitcnt lgkmcnt(6)
    v_mfma_f32_16x16x32_bf16 v[160:163], a[56:59], v[88:91], v[160:163]
    ds_read_b128 v[120:123], v31 offset:5120
    ds_read_b128 v[124:127], v31 offset:21504
    v_mfma_f32_16x16x32_bf16 v[176:179], v[88:91], a[184:187], v[176:179]
    v_mfma_f32_16x16x32_bf16 v[164:167], a[60:63], v[88:91], v[164:167]
    s_add_u32 m0, s19, 5376
    s_nop 0
    buffer_load_dwordx4 v6, s[4:7], s18 offen offset:768 sc1 lds
    v_mfma_f32_16x16x32_bf16 v[180:183], v[88:91], a[188:191], v[180:183]
    v_mfma_f32_16x16x32_bf16 v[168:171], a[56:59], v[92:95], v[168:171]
    v_mfma_f32_16x16x32_bf16 v[184:187], v[92:95], a[184:187], v[184:187]
    v_mfma_f32_16x16x32_bf16 v[172:175], a[60:63], v[92:95], v[172:175]
    v_mfma_f32_16x16x32_bf16 v[188:191], v[92:95], a[188:191], v[188:191]
    s_waitcnt lgkmcnt(6)
    v_mfma_f32_16x16x32_bf16 v[160:163], a[64:67], v[96:99], v[160:163]
    ds_read_b128 v[128:131], v30 offset:6144
    ds_read_b128 v[132:135], v30 offset:22528
    v_mfma_f32_16x16x32_bf16 v[176:179], v[96:99], a[192:195], v[176:179]
    v_mfma_f32_16x16x32_bf16 v[164:167], a[68:71], v[96:99], v[164:167]
    s_add_u32 m0, s19, 6272
    s_nop 0
    buffer_load_dwordx4 v6, s[4:7], s18 offen offset:896 sc1 lds
    v_mfma_f32_16x16x32_bf16 v[180:183], v[96:99], a[196:199], v[180:183]
    v_mfma_f32_16x16x32_bf16 v[168:171], a[64:67], v[100:103], v[168:171]
    v_mfma_f32_16x16x32_bf16 v[184:187], v[100:103], a[192:195], v[184:187]
    v_mfma_f32_16x16x32_bf16 v[172:175], a[68:71], v[100:103], v[172:175]
    v_mfma_f32_16x16x32_bf16 v[188:191], v[100:103], a[196:199], v[188:191]
    s_waitcnt lgkmcnt(6)
    v_mfma_f32_16x16x32_bf16 v[160:163], a[72:75], v[104:107], v[160:163]
    ds_read_b128 v[136:139], v31 offset:6144
    ds_read_b128 v[140:143], v31 offset:22528
    v_mfma_f32_16x16x32_bf16 v[176:179], v[104:107], a[200:203], v[176:179]
    v_mfma_f32_16x16x32_bf16 v[164:167], a[76:79], v[104:107], v[164:167]
    v_mfma_f32_16x16x32_bf16 v[180:183], v[104:107], a[204:207], v[180:183]
    v_mfma_f32_16x16x32_bf16 v[168:171], a[72:75], v[108:111], v[168:171]
    v_mfma_f32_16x16x32_bf16 v[184:187], v[108:111], a[200:203], v[184:187]
    v_mfma_f32_16x16x32_bf16 v[172:175], a[76:79], v[108:111], v[172:175]
    v_mfma_f32_16x16x32_bf16 v[188:191], v[108:111], a[204:207], v[188:191]
    s_waitcnt lgkmcnt(6)
    v_mfma_f32_16x16x32_bf16 v[160:163], a[80:83], v[112:115], v[160:163]
    ds_read_b128 v[144:147], v30 offset:7168
    ds_read_b128 v[148:151], v30 offset:23552
    v_mfma_f32_16x16x32_bf16 v[176:179], v[112:115], a[208:211], v[176:179]
    v_mfma_f32_16x16x32_bf16 v[164:167], a[84:87], v[112:115], v[164:167]
    v_mfma_f32_16x16x32_bf16 v[180:183], v[112:115], a[212:215], v[180:183]
    v_mfma_f32_16x16x32_bf16 v[168:171], a[80:83], v[116:119], v[168:171]
    v_mfma_f32_16x16x32_bf16 v[184:187], v[116:119], a[208:211], v[184:187]
    v_mfma_f32_16x16x32_bf16 v[172:175], a[84:87], v[116:119], v[172:175]
    v_mfma_f32_16x16x32_bf16 v[188:191], v[116:119], a[212:215], v[188:191]
    s_waitcnt lgkmcnt(6)
    v_mfma_f32_16x16x32_bf16 v[160:163], a[88:91], v[120:123], v[160:163]
    ds_read_b128 v[152:155], v31 offset:7168
    ds_read_b128 v[156:159], v31 offset:23552
    v_mfma_f32_16x16x32_bf16 v[176:179], v[120:123], a[216:219], v[176:179]
    v_mfma_f32_16x16x32_bf16 v[164:167], a[92:95], v[120:123], v[164:167]
    v_mfma_f32_16x16x32_bf16 v[180:183], v[120:123], a[220:223], v[180:183]
    v_mfma_f32_16x16x32_bf16 v[168:171], a[88:91], v[124:127], v[168:171]
    v_mfma_f32_16x16x32_bf16 v[184:187], v[124:127], a[216:219], v[184:187]
    v_mfma_f32_16x16x32_bf16 v[172:175], a[92:95], v[124:127], v[172:175]
    v_mfma_f32_16x16x32_bf16 v[188:191], v[124:127], a[220:223], v[188:191]
    s_waitcnt lgkmcnt(6)
    v_mfma_f32_16x16x32_bf16 v[160:163], a[96:99], v[128:131], v[160:163]
    v_mfma_f32_16x16x32_bf16 v[176:179], v[128:131], a[224:227], v[176:179]
    v_mfma_f32_16x16x32_bf16 v[164:167], a[100:103], v[128:131], v[164:167]
    v_mfma_f32_16x16x32_bf16 v[180:183], v[128:131], a[228:231], v[180:183]
    v_mfma_f32_16x16x32_bf16 v[168:171], a[96:99], v[132:135], v[168:171]
    v_mfma_f32_16x16x32_bf16 v[184:187], v[132:135], a[224:227], v[184:187]
    v_mfma_f32_16x16x32_bf16 v[172:175], a[100:103], v[132:135], v[172:175]
    v_mfma_f32_16x16x32_bf16 v[188:191], v[132:135], a[228:231], v[188:191]
    s_waitcnt lgkmcnt(4)
    v_mfma_f32_16x16x32_bf16 v[160:163], a[104:107], v[136:139], v[160:163]
    v_mfma_f32_16x16x32_bf16 v[176:179], v[136:139], a[232:235], v[176:179]
    v_mfma_f32_16x16x32_bf16 v[164:167], a[108:111], v[136:139], v[164:167]
    v_mfma_f32_16x16x32_bf16 v[180:183], v[136:139], a[236:239], v[180:183]
    v_mfma_f32_16x16x32_bf16 v[168:171], a[104:107], v[140:143], v[168:171]
    v_mfma_f32_16x16x32_bf16 v[184:187], v[140:143], a[232:235], v[184:187]
    v_mfma_f32_16x16x32_bf16 v[172:175], a[108:111], v[140:143], v[172:175]
    v_mfma_f32_16x16x32_bf16 v[188:191], v[140:143], a[236:239], v[188:191]
    s_waitcnt lgkmcnt(2)
    v_mfma_f32_16x16x32_bf16 v[160:163], a[112:115], v[144:147], v[160:163]
    v_mfma_f32_16x16x32_bf16 v[176:179], v[144:147], a[240:243], v[176:179]
    v_mfma_f32_16x16x32_bf16 v[164:167], a[116:119], v[144:147], v[164:167]
    v_mfma_f32_16x16x32_bf16 v[180:183], v[144:147], a[244:247], v[180:183]
    v_mfma_f32_16x16x32_bf16 v[168:171], a[112:115], v[148:151], v[168:171]
    v_mfma_f32_16x16x32_bf16 v[184:187], v[148:151], a[240:243], v[184:187]
    v_mfma_f32_16x16x32_bf16 v[172:175], a[116:119], v[148:151], v[172:175]
    v_mfma_f32_16x16x32_bf16 v[188:191], v[148:151], a[244:247], v[188:191]
    s_waitcnt lgkmcnt(0)
    v_mfma_f32_16x16x32_bf16 v[160:163], a[120:123], v[152:155], v[160:163]
    v_mfma_f32_16x16x32_bf16 v[176:179], v[152:155], a[248:251], v[176:179]
    v_mfma_f32_16x16x32_bf16 v[164:167], a[124:127], v[152:155], v[164:167]
    v_mfma_f32_16x16x32_bf16 v[180:183], v[152:155], a[252:255], v[180:183]
    v_mfma_f32_16x16x32_bf16 v[168:171], a[120:123], v[156:159], v[168:171]
    v_mfma_f32_16x16x32_bf16 v[184:187], v[156:159], a[248:251], v[184:187]
    v_mfma_f32_16x16x32_bf16 v[172:175], a[124:127], v[156:159], v[172:175]
    v_mfma_f32_16x16x32_bf16 v[188:191], v[156:159], a[252:255], v[188:191]
    v_cvt_pk_bf16_f32 v192, v160, v164
    v_cvt_pk_bf16_f32 v193, v161, v165
    v_cvt_pk_bf16_f32 v194, v162, v166
    v_cvt_pk_bf16_f32 v195, v163, v167
    buffer_store_dwordx4 v[192:195], v3, s[4:7], s20 offen sc1
    v_cvt_pk_bf16_f32 v196, v168, v172
    v_cvt_pk_bf16_f32 v197, v169, v173
    v_cvt_pk_bf16_f32 v198, v170, v174
    v_cvt_pk_bf16_f32 v199, v171, v175
    buffer_store_dwordx4 v[196:199], v3, s[4:7], s21 offen sc1
    v_cvt_pk_bf16_f32 v200, v176, v177
    v_cvt_pk_bf16_f32 v201, v178, v179
    v_cvt_pk_bf16_f32 v202, v184, v185
    v_cvt_pk_bf16_f32 v203, v186, v187
    buffer_store_dwordx4 v[200:203], v3, s[4:7], s22 offen sc1
    v_cvt_pk_bf16_f32 v204, v180, v181
    v_cvt_pk_bf16_f32 v205, v182, v183
    v_cvt_pk_bf16_f32 v206, v188, v189
    v_cvt_pk_bf16_f32 v207, v190, v191
    buffer_store_dwordx4 v[204:207], v3, s[4:7], s23 offen sc1
    v_xor_b32 v30, 0x8000, v30
    v_xor_b32 v31, 0x8000, v31
    s_add_u32 s20, s20, 1048576
    s_add_u32 s25, s12, 1
    s_cmp_lt_u32 s12, 2
    s_cbranch_scc0 L_kv_h2
    v_mov_b32 v5, 0
    global_load_dword v220, v5, s[92:93] offset:128 sc1
L_kv_h2:
    s_waitcnt vmcnt(0)
    s_barrier
    s_cmp_eq_u32 s13, 0
    s_cbranch_scc0 L_pf_29
    v_mov_b32 v4, s25
    s_mov_b64 exec, 0x1
    buffer_store_dword v4, off, s[4:7], s24 sc1
    s_mov_b64 exec, -1
L_pf_29:
    s_cmp_lt_u32 s12, 2
    s_cbranch_scc0 L_kv_h4
    s_cmp_eq_u32 s13, 0
    s_cbranch_scc0 L_kv_h3
    s_mov_b32 s42, 0
    v_cmp_gt_u32 vcc, -1, v220
    s_cbranch_vccz L_sd_31
L_sp_30:
    global_load_dword v220, v5, s[92:93] offset:128 sc1
    s_waitcnt vmcnt(0)
    v_cmp_gt_u32 vcc, -1, v220
    s_cbranch_vccz L_sd_31
    s_add_u32 s42, s42, 1
    s_cmp_lt_u32 s42, 2097152
    s_cbranch_scc1 L_sp_30
    s_branch L_fail
L_sd_31:
L_kv_h3:
    s_barrier
L_kv_h4:
    s_add_u32 s12, s12, 2
    s_add_u32 s31, s31, 262144
    s_sub_u32 s43, s12, s26
    s_cmp_lt_u32 s43, 6
    s_cbranch_scc1 L_kv
L_kvm:
    s_add_u32 s28, s27, 4096
    s_cmp_eq_u32 s26, 0
    s_cbranch_scc0 L_kvp
    buffer_load_dwordx4 v[208:211], v8, s[52:55], 0 offen offset:0
    buffer_load_dwordx4 v[212:215], v8, s[52:55], 0 offen offset:512
    s_waitcnt vmcnt(0)
    s_branch L_kvg
L_kvp:
    s_mov_b32 s42, 0
L_kvp2:
    buffer_load_dwordx4 v[208:211], v3, s[4:7], s27 offen sc1
    buffer_load_dwordx4 v[212:215], v3, s[4:7], s28 offen sc1
    s_waitcnt vmcnt(0)
    v_bitop3_b32 v4, v211, v215, s29 bitop3:0x7e
    v_and_b32 v4, 1, v4
    v_cmp_ne_u32 vcc, 0, v4
    s_cbranch_vccz L_kvg
    s_add_u32 s42, s42, 1
    s_cmp_lt_u32 s42, 2097152
    s_cbranch_scc1 L_kvp2
    s_branch L_fail
L_kvg:
    ds_write_b128 v13, v[208:211] offset:0
    ds_write_b128 v13, v[212:215] offset:4096
    s_waitcnt lgkmcnt(0)
    s_barrier
    ds_read_b128 v[32:35], v10 offset:0
    ds_read_b128 v[36:39], v10 offset:512
    ds_read_b128 v[40:43], v10 offset:1024
    ds_read_b128 v[44:47], v10 offset:1536
    ds_read_b128 v[48:51], v10 offset:2048
    ds_read_b128 v[52:55], v10 offset:2560
    ds_read_b128 v[56:59], v10 offset:3072
    ds_read_b128 v[60:63], v10 offset:3584
    ds_read_b128 v[64:67], v10 offset:4096
    ds_read_b128 v[68:71], v10 offset:4608
    ds_read_b128 v[72:75], v10 offset:5120
    ds_read_b128 v[76:79], v10 offset:5632
    ds_read_b128 v[80:83], v10 offset:6144
    ds_read_b128 v[84:87], v10 offset:6656
    ds_read_b128 v[88:91], v10 offset:7168
    ds_read_b128 v[92:95], v10 offset:7680
    s_waitcnt lgkmcnt(15)
    v_mfma_f32_16x16x32_bf16 v[160:163], v[32:35], a[0:3], 0
    v_mfma_f32_16x16x32_bf16 v[164:167], v[32:35], a[4:7], 0
    v_mfma_f32_16x16x32_bf16 v[168:171], v[32:35], a[128:131], 0
    v_mfma_f32_16x16x32_bf16 v[172:175], v[32:35], a[132:135], 0
    s_waitcnt lgkmcnt(14)
    v_mfma_f32_16x16x32_bf16 v[160:163], v[36:39], a[8:11], v[160:163]
    v_mfma_f32_16x16x32_bf16 v[164:167], v[36:39], a[12:15], v[164:167]
    v_mfma_f32_16x16x32_bf16 v[168:171], v[36:39], a[136:139], v[168:171]
    v_mfma_f32_16x16x32_bf16 v[172:175], v[36:39], a[140:143], v[172:175]
    s_waitcnt lgkmcnt(13)
    v_mfma_f32_16x16x32_bf16 v[160:163], v[40:43], a[16:19], v[160:163]
    v_mfma_f32_16x16x32_bf16 v[164:167], v[40:43], a[20:23], v[164:167]
    v_mfma_f32_16x16x32_bf16 v[168:171], v[40:43], a[144:147], v[168:171]
    v_mfma_f32_16x16x32_bf16 v[172:175], v[40:43], a[148:151], v[172:175]
    s_waitcnt lgkmcnt(12)
    v_mfma_f32_16x16x32_bf16 v[160:163], v[44:47], a[24:27], v[160:163]
    v_mfma_f32_16x16x32_bf16 v[164:167], v[44:47], a[28:31], v[164:167]
    v_mfma_f32_16x16x32_bf16 v[168:171], v[44:47], a[152:155], v[168:171]
    v_mfma_f32_16x16x32_bf16 v[172:175], v[44:47], a[156:159], v[172:175]
    s_waitcnt lgkmcnt(11)
    v_mfma_f32_16x16x32_bf16 v[160:163], v[48:51], a[32:35], v[160:163]
    v_mfma_f32_16x16x32_bf16 v[164:167], v[48:51], a[36:39], v[164:167]
    v_mfma_f32_16x16x32_bf16 v[168:171], v[48:51], a[160:163], v[168:171]
    v_mfma_f32_16x16x32_bf16 v[172:175], v[48:51], a[164:167], v[172:175]
    s_waitcnt lgkmcnt(10)
    v_mfma_f32_16x16x32_bf16 v[160:163], v[52:55], a[40:43], v[160:163]
    v_mfma_f32_16x16x32_bf16 v[164:167], v[52:55], a[44:47], v[164:167]
    v_mfma_f32_16x16x32_bf16 v[168:171], v[52:55], a[168:171], v[168:171]
    v_mfma_f32_16x16x32_bf16 v[172:175], v[52:55], a[172:175], v[172:175]
    s_waitcnt lgkmcnt(9)
    v_mfma_f32_16x16x32_bf16 v[160:163], v[56:59], a[48:51], v[160:163]
    v_mfma_f32_16x16x32_bf16 v[164:167], v[56:59], a[52:55], v[164:167]
    v_mfma_f32_16x16x32_bf16 v[168:171], v[56:59], a[176:179], v[168:171]
    v_mfma_f32_16x16x32_bf16 v[172:175], v[56:59], a[180:183], v[172:175]
    s_waitcnt lgkmcnt(8)
    v_mfma_f32_16x16x32_bf16 v[160:163], v[60:63], a[56:59], v[160:163]
    v_mfma_f32_16x16x32_bf16 v[164:167], v[60:63], a[60:63], v[164:167]
    v_mfma_f32_16x16x32_bf16 v[168:171], v[60:63], a[184:187], v[168:171]
    v_mfma_f32_16x16x32_bf16 v[172:175], v[60:63], a[188:191], v[172:175]
    s_waitcnt lgkmcnt(7)
    v_mfma_f32_16x16x32_bf16 v[160:163], v[64:67], a[64:67], v[160:163]
    v_mfma_f32_16x16x32_bf16 v[164:167], v[64:67], a[68:71], v[164:167]
    v_mfma_f32_16x16x32_bf16 v[168:171], v[64:67], a[192:195], v[168:171]
    v_mfma_f32_16x16x32_bf16 v[172:175], v[64:67], a[196:199], v[172:175]
    s_waitcnt lgkmcnt(6)
    v_mfma_f32_16x16x32_bf16 v[160:163], v[68:71], a[72:75], v[160:163]
    v_mfma_f32_16x16x32_bf16 v[164:167], v[68:71], a[76:79], v[164:167]
    v_mfma_f32_16x16x32_bf16 v[168:171], v[68:71], a[200:203], v[168:171]
    v_mfma_f32_16x16x32_bf16 v[172:175], v[68:71], a[204:207], v[172:175]
    s_waitcnt lgkmcnt(5)
    v_mfma_f32_16x16x32_bf16 v[160:163], v[72:75], a[80:83], v[160:163]
    v_mfma_f32_16x16x32_bf16 v[164:167], v[72:75], a[84:87], v[164:167]
    v_mfma_f32_16x16x32_bf16 v[168:171], v[72:75], a[208:211], v[168:171]
    v_mfma_f32_16x16x32_bf16 v[172:175], v[72:75], a[212:215], v[172:175]
    s_waitcnt lgkmcnt(4)
    v_mfma_f32_16x16x32_bf16 v[160:163], v[76:79], a[88:91], v[160:163]
    v_mfma_f32_16x16x32_bf16 v[164:167], v[76:79], a[92:95], v[164:167]
    v_mfma_f32_16x16x32_bf16 v[168:171], v[76:79], a[216:219], v[168:171]
    v_mfma_f32_16x16x32_bf16 v[172:175], v[76:79], a[220:223], v[172:175]
    s_waitcnt lgkmcnt(3)
    v_mfma_f32_16x16x32_bf16 v[160:163], v[80:83], a[96:99], v[160:163]
    v_mfma_f32_16x16x32_bf16 v[164:167], v[80:83], a[100:103], v[164:167]
    v_mfma_f32_16x16x32_bf16 v[168:171], v[80:83], a[224:227], v[168:171]
    v_mfma_f32_16x16x32_bf16 v[172:175], v[80:83], a[228:231], v[172:175]
    s_waitcnt lgkmcnt(2)
    v_mfma_f32_16x16x32_bf16 v[160:163], v[84:87], a[104:107], v[160:163]
    v_mfma_f32_16x16x32_bf16 v[164:167], v[84:87], a[108:111], v[164:167]
    v_mfma_f32_16x16x32_bf16 v[168:171], v[84:87], a[232:235], v[168:171]
    v_mfma_f32_16x16x32_bf16 v[172:175], v[84:87], a[236:239], v[172:175]
    s_waitcnt lgkmcnt(1)
    v_mfma_f32_16x16x32_bf16 v[160:163], v[88:91], a[112:115], v[160:163]
    v_mfma_f32_16x16x32_bf16 v[164:167], v[88:91], a[116:119], v[164:167]
    v_mfma_f32_16x16x32_bf16 v[168:171], v[88:91], a[240:243], v[168:171]
    v_mfma_f32_16x16x32_bf16 v[172:175], v[88:91], a[244:247], v[172:175]
    s_waitcnt lgkmcnt(0)
    v_mfma_f32_16x16x32_bf16 v[160:163], v[92:95], a[120:123], v[160:163]
    v_mfma_f32_16x16x32_bf16 v[164:167], v[92:95], a[124:127], v[164:167]
    v_mfma_f32_16x16x32_bf16 v[168:171], v[92:95], a[248:251], v[168:171]
    v_mfma_f32_16x16x32_bf16 v[172:175], v[92:95], a[252:255], v[172:175]
    s_nop 0
    v_cvt_pk_bf16_f32 v192, v160, v164
    v_cvt_pk_bf16_f32 v193, v161, v165
    s_nop 1
    v_cvt_pk_bf16_f32 v194, v168, v169
    s_nop 1
    v_cvt_pk_bf16_f32 v195, v172, v173
    buffer_store_dwordx4 v[192:195], v3, s[4:7], s30 offen sc1
    s_add_u32 s30, s30, 262144
    s_add_u32 s27, s27, 16384
    s_barrier
    s_add_u32 s26, s26, 2
    s_cmp_lt_u32 s12, 64
    s_cbranch_scc1 L_kv
    s_cmp_lt_u32 s26, 63
    s_cbranch_scc1 L_kvm
    s_branch L_done
L_role_att:
    s_mov_b32 s44, s64
    s_mov_b32 s45, s65
    s_mov_b32 s46, 0x400000
    s_mov_b32 s47, 0x00020000
    s_mov_b32 s48, s70
    s_mov_b32 s49, s71
    s_mov_b32 s50, 0x400000
    s_mov_b32 s51, 0x00020000
    s_mov_b32 s52, s66
    s_mov_b32 s53, s67
    s_mov_b32 s54, 0x400000
    s_mov_b32 s55, 0x00020000
    s_mov_b32 s56, s68
    s_mov_b32 s57, s69
    s_mov_b32 s58, 0x400000
    s_mov_b32 s59, 0x00020000
    v_and_b32 v1, 63, v0
    v_lshlrev_b32 v2, 4, v1
    s_lshl_b32 s43, s13, 10
    v_add_u32 v3, s43, v2
    s_mov_b32 s66, 0x05040100
    s_mov_b32 s67, 0x07060302
    v_lshlrev_b32 v8, 7, v1
    s_lshl_b32 s16, s14, 16
    s_lshl_b32 s43, s15, 15
    s_add_u32 s16, s16, s43
    s_lshl_b32 s43, s13, 13
    s_add_u32 s16, s16, s43
    s_add_u32 s17, s16, 2097152
    buffer_load_dword v40, v8, s[48:51], s16 offen
    buffer_load_dword v41, v8, s[48:51], s17 offen
    buffer_load_dword v42, v8, s[52:55], s16 offen
    buffer_load_dword v43, v8, s[52:55], s17 offen
    buffer_load_dword v44, v8, s[56:59], s16 offen
    buffer_load_dword v45, v8, s[56:59], s17 offen
    buffer_load_dword v46, v8, s[44:47], s16 offen
    buffer_load_dword v47, v8, s[44:47], s17 offen
    s_cmp_eq_u32 s13, 0
    s_cbranch_scc0 L_g_32
    v_mov_b32 v5, 0
    s_mov_b32 s42, 0
L_sp_33:
    global_load_dword v4, v5, s[92:93] offset:132 sc1
    s_waitcnt vmcnt(0)
    v_cmp_gt_u32 vcc, 32, v4
    s_cbranch_vccz L_sd_34
    s_sleep 127
    s_add_u32 s42, s42, 1
    s_cmp_lt_u32 s42, 2097152
    s_cbranch_scc1 L_sp_33
    s_branch L_fail
L_sd_34:
    s_lshl_b32 s16, s14, 8
    s_lshl_b32 s43, s15, 7
    s_add_u32 s16, s16, s43
    s_add_u32 s16, s16, 0x180000
    s_mov_b32 s42, 0
L_sp_35:
    buffer_load_dword v4, off, s[4:7], s16 sc1
    s_waitcnt vmcnt(0)
    v_cmp_gt_u32 vcc, 5, v4
    s_cbranch_vccz L_sd_36
    s_sleep 8
    s_add_u32 s42, s42, 1
    s_cmp_lt_u32 s42, 2097152
    s_cbranch_scc1 L_sp_35
    s_branch L_fail
L_sd_36:
L_g_32:
    s_barrier
    v_bfe_u32 v4, v1, 2, 4
    v_lshlrev_b32 v8, 13, v4
    v_bfe_u32 v4, v1, 0, 2
    v_lshl_add_u32 v8, v4, 4, v8
    v_bfe_u32 v4, v1, 5, 1
    v_lshlrev_b32 v9, 10, v4
    v_bfe_u32 v4, v1, 4, 1
    v_lshl_add_u32 v9, v4, 9, v9
    v_bfe_u32 v4, v1, 2, 2
    v_lshl_add_u32 v9, v4, 6, v9
    v_bfe_u32 v4, v1, 0, 2
    v_lshl_add_u32 v9, v4, 3, v9
    s_mul_i32 s17, s13, 16384
    v_add_u32 v9, s17, v9
    s_lshl_b32 s16, s14, 8
    s_lshl_b32 s43, s13, 6
    s_add_u32 s16, s16, s43
    v_bfe_u32 v4, v1, 4, 2
    v_lshlrev_b32 v13, 12, v4
    v_bfe_u32 v4, v1, 0, 4
    v_lshl_add_u32 v13, v4, 4, v13
    s_lshl_b32 s29, s14, 17
    s_lshl_b32 s43, s13, 8
    s_add_u32 s29, s29, s43
    s_add_u32 s43, s16, 0x0
    s_add_u32 m0, s17, 0
    s_nop 0
    buffer_load_dwordx4 v8, s[44:47], s43 offen lds
    s_add_u32 s43, s16, 0x20000
    s_add_u32 m0, s17, 1024
    s_nop 0
    buffer_load_dwordx4 v8, s[44:47], s43 offen lds
    s_add_u32 s43, s16, 0x40000
    s_add_u32 m0, s17, 2048
    s_nop 0
    buffer_load_dwordx4 v8, s[44:47], s43 offen lds
    s_add_u32 s43, s16, 0x60000
    s_add_u32 m0, s17, 3072
    s_nop 0
    buffer_load_dwordx4 v8, s[44:47], s43 offen lds
    s_add_u32 s43, s16, 0x80000
    s_add_u32 m0, s17, 4096
    s_nop 0
    buffer_load_dwordx4 v8, s[44:47], s43 offen lds
    s_add_u32 s43, s16, 0xa0000
    s_add_u32 m0, s17, 5120
    s_nop 0
    buffer_load_dwordx4 v8, s[44:47], s43 offen lds
    s_add_u32 s43, s16, 0xc0000
    s_add_u32 m0, s17, 6144
    s_nop 0
    buffer_load_dwordx4 v8, s[44:47], s43 offen lds
    s_add_u32 s43, s16, 0xe0000
    s_add_u32 m0, s17, 7168
    s_nop 0
    buffer_load_dwordx4 v8, s[44:47], s43 offen lds
    s_add_u32 s43, s16, 0x100000
    s_add_u32 m0, s17, 8192
    s_nop 0
    buffer_load_dwordx4 v8, s[44:47], s43 offen lds
    s_add_u32 s43, s16, 0x120000
    s_add_u32 m0, s17, 9216
    s_nop 0
    buffer_load_dwordx4 v8, s[44:47], s43 offen lds
    s_add_u32 s43, s16, 0x140000
    s_add_u32 m0, s17, 10240
    s_nop 0
    buffer_load_dwordx4 v8, s[44:47], s43 offen lds
    s_add_u32 s43, s16, 0x160000
    s_add_u32 m0, s17, 11264
    s_nop 0
    buffer_load_dwordx4 v8, s[44:47], s43 offen lds
    s_add_u32 s43, s16, 0x180000
    s_add_u32 m0, s17, 12288
    s_nop 0
    buffer_load_dwordx4 v8, s[44:47], s43 offen lds
    s_add_u32 s43, s16, 0x1a0000
    s_add_u32 m0, s17, 13312
    s_nop 0
    buffer_load_dwordx4 v8, s[44:47], s43 offen lds
    s_add_u32 s43, s16, 0x1c0000
    s_add_u32 m0, s17, 14336
    s_nop 0
    buffer_load_dwordx4 v8, s[44:47], s43 offen lds
    s_add_u32 s43, s16, 0x1e0000
    s_add_u32 m0, s17, 15360
    s_nop 0
    buffer_load_dwordx4 v8, s[44:47], s43 offen lds
    s_waitcnt vmcnt(14)
    ds_read_b64_tr_b16 a[0:1], v9 offset:0
    ds_read_b64_tr_b16 a[2:3], v9 offset:256
    ds_read_b64_tr_b16 a[4:5], v9 offset:32
    ds_read_b64_tr_b16 a[6:7], v9 offset:288
    s_waitcnt vmcnt(12)
    ds_read_b64_tr_b16 a[8:9], v9 offset:2048
    ds_read_b64_tr_b16 a[10:11], v9 offset:2304
    ds_read_b64_tr_b16 a[12:13], v9 offset:2080
    ds_read_b64_tr_b16 a[14:15], v9 offset:2336
    s_waitcnt lgkmcnt(4)
    s_add_u32 s43, s16, 0x200000
    s_add_u32 m0, s17, 0
    s_nop 0
    buffer_load_dwordx4 v8, s[44:47], s43 offen lds
    s_add_u32 s43, s16, 0x220000
    s_add_u32 m0, s17, 1024
    s_nop 0
    buffer_load_dwordx4 v8, s[44:47], s43 offen lds
    s_waitcnt vmcnt(12)
    ds_read_b64_tr_b16 a[16:17], v9 offset:4096
    ds_read_b64_tr_b16 a[18:19], v9 offset:4352
    ds_read_b64_tr_b16 a[20:21], v9 offset:4128
    ds_read_b64_tr_b16 a[22:23], v9 offset:4384
    s_waitcnt lgkmcnt(4)
    s_add_u32 s43, s16, 0x240000
    s_add_u32 m0, s17, 2048
    s_nop 0
    buffer_load_dwordx4 v8, s[44:47], s43 offen lds
    s_add_u32 s43, s16, 0x260000
    s_add_u32 m0, s17, 3072
    s_nop 0
    buffer_load_dwordx4 v8, s[44:47], s43 offen lds
    s_waitcnt vmcnt(12)
    ds_read_b64_tr_b16 a[24:25], v9 offset:6144
    ds_read_b64_tr_b16 a[26:27], v9 offset:6400
    ds_read_b64_tr_b16 a[28:29], v9 offset:6176
    ds_read_b64_tr_b16 a[30:31], v9 offset:6432
    s_waitcnt lgkmcnt(4)
    s_add_u32 s43, s16, 0x280000
    s_add_u32 m0, s17, 4096
    s_nop 0
    buffer_load_dwordx4 v8, s[44:47], s43 offen lds
    s_add_u32 s43, s16, 0x2a0000
    s_add_u32 m0, s17, 5120
    s_nop 0
    buffer_load_dwordx4 v8, s[44:47], s43 offen lds
    s_waitcnt vmcnt(12)
    ds_read_b64_tr_b16 a[32:33], v9 offset:8192
    ds_read_b64_tr_b16 a[34:35], v9 offset:8448
    ds_read_b64_tr_b16 a[36:37], v9 offset:8224
    ds_read_b64_tr_b16 a[38:39], v9 offset:8480
    s_waitcnt lgkmcnt(4)
    s_add_u32 s43, s16, 0x2c0000
    s_add_u32 m0, s17, 6144
    s_nop 0
    buffer_load_dwordx4 v8, s[44:47], s43 offen lds
    s_add_u32 s43, s16, 0x2e0000
    s_add_u32 m0, s17, 7168
    s_nop 0
    buffer_load_dwordx4 v8, s[44:47], s43 offen lds
    s_waitcnt vmcnt(12)
    ds_read_b64_tr_b16 a[40:41], v9 offset:10240
    ds_read_b64_tr_b16 a[42:43], v9 offset:10496
    ds_read_b64_tr_b16 a[44:45], v9 offset:10272
    ds_read_b64_tr_b16 a[46:47], v9 offset:10528
    s_waitcnt lgkmcnt(4)
    s_add_u32 s43, s16, 0x300000
    s_add_u32 m0, s17, 8192
    s_nop 0
    buffer_load_dwordx4 v8, s[44:47], s43 offen lds
    s_add_u32 s43, s16, 0x320000
    s_add_u32 m0, s17, 9216
    s_nop 0
    buffer_load_dwordx4 v8, s[44:47], s43 offen lds
    s_waitcnt vmcnt(12)
    ds_read_b64_tr_b16 a[48:49], v9 offset:12288
    ds_read_b64_tr_b16 a[50:51], v9 offset:12544
    ds_read_b64_tr_b16 a[52:53], v9 offset:12320
    ds_read_b64_tr_b16 a[54:55], v9 offset:12576
    s_waitcnt lgkmcnt(4)
    s_add_u32 s43, s16, 0x340000
    s_add_u32 m0, s17, 10240
    s_nop 0
    buffer_load_dwordx4 v8, s[44:47], s43 offen lds
    s_add_u32 s43, s16, 0x360000
    s_add_u32 m0, s17, 11264
    s_nop 0
    buffer_load_dwordx4 v8, s[44:47], s43 offen lds
    s_waitcnt vmcnt(12)
    ds_read_b64_tr_b16 a[56:57], v9 offset:14336
    ds_read_b64_tr_b16 a[58:59], v9 offset:14592
    ds_read_b64_tr_b16 a[60:61], v9 offset:14368
    ds_read_b64_tr_b16 a[62:63], v9 offset:14624
    s_waitcnt lgkmcnt(4)
    s_add_u32 s43, s16, 0x380000
    s_add_u32 m0, s17, 12288
    s_nop 0
    buffer_load_dwordx4 v8, s[44:47], s43 offen lds
    s_add_u32 s43, s16, 0x3a0000
    s_add_u32 m0, s17, 13312
    s_nop 0
    buffer_load_dwordx4 v8, s[44:47], s43 offen lds
    s_waitcnt vmcnt(12)
    ds_read_b64_tr_b16 a[64:65], v9 offset:0
    ds_read_b64_tr_b16 a[66:67], v9 offset:256
    ds_read_b64_tr_b16 a[68:69], v9 offset:32
    ds_read_b64_tr_b16 a[70:71], v9 offset:288
    s_waitcnt lgkmcnt(4)
    s_add_u32 s43, s16, 0x3c0000
    s_add_u32 m0, s17, 14336
    s_nop 0
    buffer_load_dwordx4 v8, s[44:47], s43 offen lds
    s_add_u32 s43, s16, 0x3e0000
    s_add_u32 m0, s17, 15360
    s_nop 0
    buffer_load_dwordx4 v8, s[44:47], s43 offen lds
    s_add_u32 s43, s29, 0
    buffer_load_dwordx4 v[64:67], v13, s[48:51], s43 offen offset:0
    buffer_load_dwordx4 v[68:71], v13, s[48:51], s43 offen offset:1024
    buffer_load_dwordx4 v[72:75], v13, s[48:51], s43 offen offset:2048
    buffer_load_dwordx4 v[76:79], v13, s[48:51], s43 offen offset:3072
    s_add_u32 s43, s29, 16384
    buffer_load_dwordx4 v[80:83], v13, s[48:51], s43 offen offset:0
    buffer_load_dwordx4 v[84:87], v13, s[48:51], s43 offen offset:1024
    buffer_load_dwordx4 v[88:91], v13, s[48:51], s43 offen offset:2048
    buffer_load_dwordx4 v[92:95], v13, s[48:51], s43 offen offset:3072
    s_waitcnt vmcnt(20)
    ds_read_b64_tr_b16 a[72:73], v9 offset:2048
    ds_read_b64_tr_b16 a[74:75], v9 offset:2304
    ds_read_b64_tr_b16 a[76:77], v9 offset:2080
    ds_read_b64_tr_b16 a[78:79], v9 offset:2336
    s_waitcnt vmcnt(18)
    ds_read_b64_tr_b16 a[80:81], v9 offset:4096
    ds_read_b64_tr_b16 a[82:83], v9 offset:4352
    ds_read_b64_tr_b16 a[84:85], v9 offset:4128
    ds_read_b64_tr_b16 a[86:87], v9 offset:4384
    s_waitcnt vmcnt(16)
    ds_read_b64_tr_b16 a[88:89], v9 offset:6144
    ds_read_b64_tr_b16 a[90:91], v9 offset:6400
    ds_read_b64_tr_b16 a[92:93], v9 offset:6176
    ds_read_b64_tr_b16 a[94:95], v9 offset:6432
    s_waitcnt vmcnt(14)
    ds_read_b64_tr_b16 a[96:97], v9 offset:8192
    ds_read_b64_tr_b16 a[98:99], v9 offset:8448
    ds_read_b64_tr_b16 a[100:101], v9 offset:8224
    ds_read_b64_tr_b16 a[102:103], v9 offset:8480
    s_waitcnt vmcnt(12)
    ds_read_b64_tr_b16 a[104:105], v9 offset:10240
    ds_read_b64_tr_b16 a[106:107], v9 offset:10496
    ds_read_b64_tr_b16 a[108:109], v9 offset:10272
    ds_read_b64_tr_b16 a[110:111], v9 offset:10528
    s_waitcnt vmcnt(10)
    ds_read_b64_tr_b16 a[112:113], v9 offset:12288
    ds_read_b64_tr_b16 a[114:115], v9 offset:12544
    ds_read_b64_tr_b16 a[116:117], v9 offset:12320
    ds_read_b64_tr_b16 a[118:119], v9 offset:12576
    s_waitcnt vmcnt(8)
    ds_read_b64_tr_b16 a[120:121], v9 offset:14336
    ds_read_b64_tr_b16 a[122:123], v9 offset:14592
    ds_read_b64_tr_b16 a[124:125], v9 offset:14368
    ds_read_b64_tr_b16 a[126:127], v9 offset:14624
    s_waitcnt lgkmcnt(0)
    s_add_u32 s43, s29, 32768
    buffer_load_dwordx4 v[96:99], v13, s[48:51], s43 offen offset:0
    buffer_load_dwordx4 v[100:103], v13, s[48:51], s43 offen offset:1024
    buffer_load_dwordx4 v[104:107], v13, s[48:51], s43 offen offset:2048
    buffer_load_dwordx4 v[108:111], v13, s[48:51], s43 offen offset:3072
    s_add_u32 s43, s29, 49152
    buffer_load_dwordx4 v[112:115], v13, s[48:51], s43 offen offset:0
    buffer_load_dwordx4 v[116:119], v13, s[48:51], s43 offen offset:1024
    buffer_load_dwordx4 v[120:123], v13, s[48:51], s43 offen offset:2048
    buffer_load_dwordx4 v[124:127], v13, s[48:51], s43 offen offset:3072
    s_waitcnt vmcnt(8)
    v_perm_b32 v32, v68, v64, s66
    v_perm_b32 v33, v76, v72, s66
    v_perm_b32 v34, v84, v80, s66
    v_perm_b32 v35, v92, v88, s66
    v_accvgpr_write_b32 a128, v32
    v_accvgpr_write_b32 a129, v33
    v_accvgpr_write_b32 a130, v34
    v_accvgpr_write_b32 a131, v35
    v_perm_b32 v32, v68, v64, s67
    v_perm_b32 v33, v76, v72, s67
    v_perm_b32 v34, v84, v80, s67
    v_perm_b32 v35, v92, v88, s67
    v_accvgpr_write_b32 a132, v32
    v_accvgpr_write_b32 a133, v33
    v_accvgpr_write_b32 a134, v34
    v_accvgpr_write_b32 a135, v35
    v_perm_b32 v32, v69, v65, s66
    v_perm_b32 v33, v77, v73, s66
    v_perm_b32 v34, v85, v81, s66
    v_perm_b32 v35, v93, v89, s66
    v_accvgpr_write_b32 a136, v32
    v_accvgpr_write_b32 a137, v33
    v_accvgpr_write_b32 a138, v34
    v_accvgpr_write_b32 a139, v35
    v_perm_b32 v32, v69, v65, s67
    v_perm_b32 v33, v77, v73, s67
    v_perm_b32 v34, v85, v81, s67
    v_perm_b32 v35, v93, v89, s67
    v_accvgpr_write_b32 a140, v32
    v_accvgpr_write_b32 a141, v33
    v_accvgpr_write_b32 a142, v34
    v_accvgpr_write_b32 a143, v35
    v_perm_b32 v32, v70, v66, s66
    v_perm_b32 v33, v78, v74, s66
    v_perm_b32 v34, v86, v82, s66
    v_perm_b32 v35, v94, v90, s66
    v_accvgpr_write_b32 a144, v32
    v_accvgpr_write_b32 a145, v33
    v_accvgpr_write_b32 a146, v34
    v_accvgpr_write_b32 a147, v35
    v_perm_b32 v32, v70, v66, s67
    v_perm_b32 v33, v78, v74, s67
    v_perm_b32 v34, v86, v82, s67
    v_perm_b32 v35, v94, v90, s67
    v_accvgpr_write_b32 a148, v32
    v_accvgpr_write_b32 a149, v33
    v_accvgpr_write_b32 a150, v34
    v_accvgpr_write_b32 a151, v35
    v_perm_b32 v32, v71, v67, s66
    v_perm_b32 v33, v79, v75, s66
    v_perm_b32 v34, v87, v83, s66
    v_perm_b32 v35, v95, v91, s66
    v_accvgpr_write_b32 a152, v32
    v_accvgpr_write_b32 a153, v33
    v_accvgpr_write_b32 a154, v34
    v_accvgpr_write_b32 a155, v35
    v_perm_b32 v32, v71, v67, s67
    v_perm_b32 v33, v79, v75, s67
    v_perm_b32 v34, v87, v83, s67
    v_perm_b32 v35, v95, v91, s67
    v_accvgpr_write_b32 a156, v32
    v_accvgpr_write_b32 a157, v33
    v_accvgpr_write_b32 a158, v34
    v_accvgpr_write_b32 a159, v35
    s_add_u32 s43, s29, 65536
    buffer_load_dwordx4 v[128:131], v13, s[48:51], s43 offen offset:0
    buffer_load_dwordx4 v[132:135], v13, s[48:51], s43 offen offset:1024
    buffer_load_dwordx4 v[136:139], v13, s[48:51], s43 offen offset:2048
    buffer_load_dwordx4 v[140:143], v13, s[48:51], s43 offen offset:3072
    s_add_u32 s43, s29, 81920
    buffer_load_dwordx4 v[144:147], v13, s[48:51], s43 offen offset:0
    buffer_load_dwordx4 v[148:151], v13, s[48:51], s43 offen offset:1024
    buffer_load_dwordx4 v[152:155], v13, s[48:51], s43 offen offset:2048
    buffer_load_dwordx4 v[156:159], v13, s[48:51], s43 offen offset:3072
    s_waitcnt vmcnt(8)
    v_perm_b32 v32, v100, v96, s66
    v_perm_b32 v33, v108, v104, s66
    v_perm_b32 v34, v116, v112, s66
    v_perm_b32 v35, v124, v120, s66
    v_accvgpr_write_b32 a160, v32
    v_accvgpr_write_b32 a161, v33
    v_accvgpr_write_b32 a162, v34
    v_accvgpr_write_b32 a163, v35
    v_perm_b32 v32, v100, v96, s67
    v_perm_b32 v33, v108, v104, s67
    v_perm_b32 v34, v116, v112, s67
    v_perm_b32 v35, v124, v120, s67
    v_accvgpr_write_b32 a164, v32
    v_accvgpr_write_b32 a165, v33
    v_accvgpr_write_b32 a166, v34
    v_accvgpr_write_b32 a167, v35
    v_perm_b32 v32, v101, v97, s66
    v_perm_b32 v33, v109, v105, s66
    v_perm_b32 v34, v117, v113, s66
    v_perm_b32 v35, v125, v121, s66
    v_accvgpr_write_b32 a168, v32
    v_accvgpr_write_b32 a169, v33
    v_accvgpr_write_b32 a170, v34
    v_accvgpr_write_b32 a171, v35
    v_perm_b32 v32, v101, v97, s67
    v_perm_b32 v33, v109, v105, s67
    v_perm_b32 v34, v117, v113, s67
    v_perm_b32 v35, v125, v121, s67
    v_accvgpr_write_b32 a172, v32
    v_accvgpr_write_b32 a173, v33
    v_accvgpr_write_b32 a174, v34
    v_accvgpr_write_b32 a175, v35
    v_perm_b32 v32, v102, v98, s66
    v_perm_b32 v33, v110, v106, s66
    v_perm_b32 v34, v118, v114, s66
    v_perm_b32 v35, v126, v122, s66
    v_accvgpr_write_b32 a176, v32
    v_accvgpr_write_b32 a177, v33
    v_accvgpr_write_b32 a178, v34
    v_accvgpr_write_b32 a179, v35
    v_perm_b32 v32, v102, v98, s67
    v_perm_b32 v33, v110, v106, s67
    v_perm_b32 v34, v118, v114, s67
    v_perm_b32 v35, v126, v122, s67
    v_accvgpr_write_b32 a180, v32
    v_accvgpr_write_b32 a181, v33
    v_accvgpr_write_b32 a182, v34
    v_accvgpr_write_b32 a183, v35
    v_perm_b32 v32, v103, v99, s66
    v_perm_b32 v33, v111, v107, s66
    v_perm_b32 v34, v119, v115, s66
    v_perm_b32 v35, v127, v123, s66
    v_accvgpr_write_b32 a184, v32
    v_accvgpr_write_b32 a185, v33
    v_accvgpr_write_b32 a186, v34
    v_accvgpr_write_b32 a187, v35
    v_perm_b32 v32, v103, v99, s67
    v_perm_b32 v33, v111, v107, s67
    v_perm_b32 v34, v119, v115, s67
    v_perm_b32 v35, v127, v123, s67
    v_accvgpr_write_b32 a188, v32
    v_accvgpr_write_b32 a189, v33
    v_accvgpr_write_b32 a190, v34
    v_accvgpr_write_b32 a191, v35
    s_add_u32 s43, s29, 98304
    buffer_load_dwordx4 v[160:163], v13, s[48:51], s43 offen offset:0
    buffer_load_dwordx4 v[164:167], v13, s[48:51], s43 offen offset:1024
    buffer_load_dwordx4 v[168:171], v13, s[48:51], s43 offen offset:2048
    buffer_load_dwordx4 v[172:175], v13, s[48:51], s43 offen offset:3072
    s_add_u32 s43, s29, 114688
    buffer_load_dwordx4 v[176:179], v13, s[48:51], s43 offen offset:0
    buffer_load_dwordx4 v[180:183], v13, s[48:51], s43 offen offset:1024
    buffer_load_dwordx4 v[184:187], v13, s[48:51], s43 offen offset:2048
    buffer_load_dwordx4 v[188:191], v13, s[48:51], s43 offen offset:3072
    s_waitcnt vmcnt(8)
    v_perm_b32 v32, v132, v128, s66
    v_perm_b32 v33, v140, v136, s66
    v_perm_b32 v34, v148, v144, s66
    v_perm_b32 v35, v156, v152, s66
    v_accvgpr_write_b32 a192, v32
    v_accvgpr_write_b32 a193, v33
    v_accvgpr_write_b32 a194, v34
    v_accvgpr_write_b32 a195, v35
    v_perm_b32 v32, v132, v128, s67
    v_perm_b32 v33, v140, v136, s67
    v_perm_b32 v34, v148, v144, s67
    v_perm_b32 v35, v156, v152, s67
    v_accvgpr_write_b32 a196, v32
    v_accvgpr_write_b32 a197, v33
    v_accvgpr_write_b32 a198, v34
    v_accvgpr_write_b32 a199, v35
    v_perm_b32 v32, v133, v129, s66
    v_perm_b32 v33, v141, v137, s66
    v_perm_b32 v34, v149, v145, s66
    v_perm_b32 v35, v157, v153, s66
    v_accvgpr_write_b32 a200, v32
    v_accvgpr_write_b32 a201, v33
    v_accvgpr_write_b32 a202, v34
    v_accvgpr_write_b32 a203, v35
    v_perm_b32 v32, v133, v129, s67
    v_perm_b32 v33, v141, v137, s67
    v_perm_b32 v34, v149, v145, s67
    v_perm_b32 v35, v157, v153, s67
    v_accvgpr_write_b32 a204, v32
    v_accvgpr_write_b32 a205, v33
    v_accvgpr_write_b32 a206, v34
    v_accvgpr_write_b32 a207, v35
    v_perm_b32 v32, v134, v130, s66
    v_perm_b32 v33, v142, v138, s66
    v_perm_b32 v34, v150, v146, s66
    v_perm_b32 v35, v158, v154, s66
    v_accvgpr_write_b32 a208, v32
    v_accvgpr_write_b32 a209, v33
    v_accvgpr_write_b32 a210, v34
    v_accvgpr_write_b32 a211, v35
    v_perm_b32 v32, v134, v130, s67
    v_perm_b32 v33, v142, v138, s67
    v_perm_b32 v34, v150, v146, s67
    v_perm_b32 v35, v158, v154, s67
    v_accvgpr_write_b32 a212, v32
    v_accvgpr_write_b32 a213, v33
    v_accvgpr_write_b32 a214, v34
    v_accvgpr_write_b32 a215, v35
    v_perm_b32 v32, v135, v131, s66
    v_perm_b32 v33, v143, v139, s66
    v_perm_b32 v34, v151, v147, s66
    v_perm_b32 v35, v159, v155, s66
    v_accvgpr_write_b32 a216, v32
    v_accvgpr_write_b32 a217, v33
    v_accvgpr_write_b32 a218, v34
    v_accvgpr_write_b32 a219, v35
    v_perm_b32 v32, v135, v131, s67
    v_perm_b32 v33, v143, v139, s67
    v_perm_b32 v34, v151, v147, s67
    v_perm_b32 v35, v159, v155, s67
    v_accvgpr_write_b32 a220, v32
    v_accvgpr_write_b32 a221, v33
    v_accvgpr_write_b32 a222, v34
    v_accvgpr_write_b32 a223, v35
    s_waitcnt vmcnt(0)
    v_perm_b32 v32, v164, v160, s66
    v_perm_b32 v33, v172, v168, s66
    v_perm_b32 v34, v180, v176, s66
    v_perm_b32 v35, v188, v184, s66
    v_accvgpr_write_b32 a224, v32
    v_accvgpr_write_b32 a225, v33
    v_accvgpr_write_b32 a226, v34
    v_accvgpr_write_b32 a227, v35
    v_perm_b32 v32, v164, v160, s67
    v_perm_b32 v33, v172, v168, s67
    v_perm_b32 v34, v180, v176, s67
    v_perm_b32 v35, v188, v184, s67
    v_accvgpr_write_b32 a228, v32
    v_accvgpr_write_b32 a229, v33
    v_accvgpr_write_b32 a230, v34
    v_accvgpr_write_b32 a231, v35
    v_perm_b32 v32, v165, v161, s66
    v_perm_b32 v33, v173, v169, s66
    v_perm_b32 v34, v181, v177, s66
    v_perm_b32 v35, v189, v185, s66
    v_accvgpr_write_b32 a232, v32
    v_accvgpr_write_b32 a233, v33
    v_accvgpr_write_b32 a234, v34
    v_accvgpr_write_b32 a235, v35
    v_perm_b32 v32, v165, v161, s67
    v_perm_b32 v33, v173, v169, s67
    v_perm_b32 v34, v181, v177, s67
    v_perm_b32 v35, v189, v185, s67
    v_accvgpr_write_b32 a236, v32
    v_accvgpr_write_b32 a237, v33
    v_accvgpr_write_b32 a238, v34
    v_accvgpr_write_b32 a239, v35
    v_perm_b32 v32, v166, v162, s66
    v_perm_b32 v33, v174, v170, s66
    v_perm_b32 v34, v182, v178, s66
    v_perm_b32 v35, v190, v186, s66
    v_accvgpr_write_b32 a240, v32
    v_accvgpr_write_b32 a241, v33
    v_accvgpr_write_b32 a242, v34
    v_accvgpr_write_b32 a243, v35
    v_perm_b32 v32, v166, v162, s67
    v_perm_b32 v33, v174, v170, s67
    v_perm_b32 v34, v182, v178, s67
    v_perm_b32 v35, v190, v186, s67
    v_accvgpr_write_b32 a244, v32
    v_accvgpr_write_b32 a245, v33
    v_accvgpr_write_b32 a246, v34
    v_accvgpr_write_b32 a247, v35
    v_perm_b32 v32, v167, v163, s66
    v_perm_b32 v33, v175, v171, s66
    v_perm_b32 v34, v183, v179, s66
    v_perm_b32 v35, v191, v187, s66
    v_accvgpr_write_b32 a248, v32
    v_accvgpr_write_b32 a249, v33
    v_accvgpr_write_b32 a250, v34
    v_accvgpr_write_b32 a251, v35
    v_perm_b32 v32, v167, v163, s67
    v_perm_b32 v33, v175, v171, s67
    v_perm_b32 v34, v183, v179, s67
    v_perm_b32 v35, v191, v187, s67
    v_accvgpr_write_b32 a252, v32
    v_accvgpr_write_b32 a253, v33
    v_accvgpr_write_b32 a254, v34
    v_accvgpr_write_b32 a255, v35
    s_lshl_b32 s43, s13, 8
    v_add_u32 v13, s43, v13
    v_bfe_u32 v4, v1, 4, 2
    v_and_b32 v5, 7, v1
    v_xor_b32 v5, v5, v4
    s_and_b32 s64, s13, 1
    s_lshl_b32 s64, s64, 2
    v_xor_b32 v5, s64, v5
    v_lshrrev_b32 v4, 3, v1
    v_lshlrev_b32 v6, 10, v4
    v_lshl_add_u32 v6, v5, 4, v6
    s_lshl_b32 s19, s13, 13
    s_lshl_b32 s64, s15, 15
    s_add_u32 s18, s19, s64
    s_add_u32 s18, s18, 0x3900000
    v_bfe_u32 v4, v1, 1, 3
    v_lshrrev_b32 v5, 4, v1
    v_xor_b32 v5, v5, v4
    v_bfe_u32 v4, v1, 3, 1
    v_lshlrev_b32 v30, 13, v4
    v_bfe_u32 v4, v1, 0, 3
    v_lshl_add_u32 v30, v4, 7, v30
    v_lshl_add_u32 v30, v5, 4, v30
    v_xor_b32 v31, 64, v30
    v_add_u32 v19, 0x10000, v2
    v_add_u32 v28, 0x10000, v3
    s_lshr_b32 s64, s13, 1
    s_lshl_b32 s43, s64, 12
    v_add_u32 v10, s43, v19
    s_and_b32 s43, s13, 1
    s_lshl_b32 s43, s43, 11
    v_add_u32 v11, s43, v2
    s_lshl_b32 s43, s13, 11
    v_add_u32 v12, s43, v19
    v_bfe_u32 v4, v1, 4, 2
    v_lshlrev_b32 v15, 7, v4
    v_bfe_u32 v4, v1, 2, 2
    v_lshl_add_u32 v15, v4, 5, v15
    v_bfe_u32 v4, v1, 0, 1
    v_lshl_add_u32 v15, v4, 4, v15
    v_add_u32 v15, 98304, v15
    v_lshrrev_b32 v14, 1, v11
    v_add_u32 v14, 98304, v14
    v_add_u32 v11, 0x10000, v11
    v_bfe_u32 v4, v1, 2, 2
    v_lshlrev_b32 v17, 7, v4
    v_bfe_u32 v4, v1, 4, 2
    v_lshl_add_u32 v17, v4, 5, v17
    v_bfe_u32 v4, v1, 0, 2
    v_lshl_add_u32 v17, v4, 2, v17
    s_lshl_b32 s43, s13, 9
    s_add_u32 s43, s43, 98304
    v_add_u32 v17, s43, v17
    v_lshrrev_b32 v29, 1, v3
    v_add_u32 v29, 98304, v29
    v_bfe_u32 v4, v1, 4, 2
    v_lshlrev_b32 v8, 2, v4
    v_and_b32 v9, 15, v1
    s_lshl_b32 s43, s64, 4
    v_add_u32 v9, s43, v9
    v_add_u32 v4, 0, v8
    v_cmp_le_u32 s[68:69], v4, v9
    v_add_u32 v4, 1, v8
    v_cmp_le_u32 s[70:71], v4, v9
    v_add_u32 v4, 2, v8
    v_cmp_le_u32 s[72:73], v4, v9
    v_add_u32 v4, 3, v8
    v_cmp_le_u32 s[74:75], v4, v9
    v_add_u32 v4, 16, v8
    v_cmp_le_u32 s[76:77], v4, v9
    v_add_u32 v4, 17, v8
    v_cmp_le_u32 s[78:79], v4, v9
    v_add_u32 v4, 18, v8
    v_cmp_le_u32 s[80:81], v4, v9
    v_add_u32 v4, 19, v8
    v_cmp_le_u32 s[82:83], v4, v9
    v_mov_b32 v16, 0xf149f2ca
    v_mov_b32 v20, 0x3f803f80
    v_mov_b32 v21, 0x3f803f80
    v_mov_b32 v22, 0x3f803f80
    v_mov_b32 v23, 0x3f803f80
    s_mov_b32 s31, 0x3e0293ee
    s_lshl_b32 s20, s15, 19
    s_lshl_b32 s43, s14, 14
    s_add_u32 s20, s20, s43
    s_add_u32 s20, s20, 0x1000000
    s_lshl_b32 s28, s15, 17
    s_lshl_b32 s43, s14, 12
    s_add_u32 s28, s28, s43
    s_add_u32 s28, s28, 0x3040000
    s_lshl_b32 s29, s15, 20
    s_lshl_b32 s43, s14, 15
    s_add_u32 s29, s29, s43
    s_add_u32 s29, s29, 0x4000000
    s_lshl_b32 s24, s14, 8
    s_lshl_b32 s43, s15, 7
    s_add_u32 s24, s24, s43
    s_add_u32 s24, s24, 0x180000
    s_lshl_b32 s27, s14, 7
    s_lshl_b32 s43, s15, 12
    s_add_u32 s27, s27, s43
    s_add_u32 s27, s27, 0x184000
    v_lshlrev_b32 v8, 13, v1
    s_mov_b32 s12, s15
    s_lshl_b32 s63, s13, 10
    s_add_u32 s63, s63, 0x14000
    s_barrier
    s_add_u32 s25, s12, 1
    s_mov_b32 s61, 0
    s_add_u32 s21, s20, 4096
    s_add_u32 s22, s20, 8192
    s_add_u32 s23, s20, 12288
    s_mov_b32 s42, 0
L_sp_37:
    buffer_load_dword v4, off, s[4:7], s24 sc1
    s_waitcnt vmcnt(0)
    v_cmp_gt_u32 vcc, s25, v4
    s_cbranch_vccz L_sd_38
    s_add_u32 s42, s42, 1
    s_cmp_lt_u32 s42, 2097152
    s_cbranch_scc1 L_sp_37
    s_branch L_fail
L_sd_38:
    s_add_u32 m0, s19, 0
    s_nop 0
    buffer_load_dwordx4 v6, s[4:7], s18 offen offset:0 sc1 lds
    s_add_u32 m0, s19, 896
    s_nop 0
    buffer_load_dwordx4 v6, s[4:7], s18 offen offset:128 sc1 lds
    s_add_u32 m0, s19, 1792
    s_nop 0
    buffer_load_dwordx4 v6, s[4:7], s18 offen offset:256 sc1 lds
    s_add_u32 m0, s19, 2688
    s_nop 0
    buffer_load_dwordx4 v6, s[4:7], s18 offen offset:384 sc1 lds
    s_add_u32 m0, s19, 3584
    s_nop 0
    buffer_load_dwordx4 v6, s[4:7], s18 offen offset:512 sc1 lds
    s_add_u32 m0, s19, 4480
    s_nop 0
    buffer_load_dwordx4 v6, s[4:7], s18 offen offset:640 sc1 lds
    s_add_u32 m0, s19, 5376
    s_nop 0
    buffer_load_dwordx4 v6, s[4:7], s18 offen offset:768 sc1 lds
    s_add_u32 m0, s19, 6272
    s_nop 0
    buffer_load_dwordx4 v6, s[4:7], s18 offen offset:896 sc1 lds
    s_add_u32 m0, s63, 0
    s_nop 0
    buffer_load_dwordx4 v3, s[4:7], s20 offen sc1 lds
    s_add_u32 m0, s63, 4096
    s_nop 0
    buffer_load_dwordx4 v3, s[4:7], s21 offen sc1 lds
    s_add_u32 m0, s63, 8192
    s_nop 0
    buffer_load_dwordx4 v3, s[4:7], s22 offen sc1 lds
    s_add_u32 m0, s63, 12288
    s_nop 0
    buffer_load_dwordx4 v3, s[4:7], s23 offen sc1 lds
    buffer_load_dword v18, off, s[4:7], s24 sc1
    v_mov_b32 v128, -1
    v_mov_b32 v129, -1
    v_mov_b32 v130, -1
    v_mov_b32 v131, -1
    s_add_u32 s43, s29, 0x3800000
    buffer_store_dwordx4 v[128:131], v13, s[4:7], s43 offen offset:0 sc1
    buffer_store_dwordx4 v[128:131], v13, s[4:7], s43 offen offset:1024 sc1
    buffer_store_dwordx4 v[128:131], v13, s[4:7], s43 offen offset:2048 sc1
    buffer_store_dwordx4 v[128:131], v13, s[4:7], s43 offen offset:3072 sc1
    s_add_u32 s43, s29, 0x3804000
    buffer_store_dwordx4 v[128:131], v13, s[4:7], s43 offen offset:0 sc1
    buffer_store_dwordx4 v[128:131], v13, s[4:7], s43 offen offset:1024 sc1
    buffer_store_dwordx4 v[128:131], v13, s[4:7], s43 offen offset:2048 sc1
    buffer_store_dwordx4 v[128:131], v13, s[4:7], s43 offen offset:3072 sc1
    s_add_u32 s43, s29, 0x3a00000
    buffer_store_dwordx4 v[128:131], v13, s[4:7], s43 offen offset:0 sc1
    buffer_store_dwordx4 v[128:131], v13, s[4:7], s43 offen offset:1024 sc1
    buffer_store_dwordx4 v[128:131], v13, s[4:7], s43 offen offset:2048 sc1
    buffer_store_dwordx4 v[128:131], v13, s[4:7], s43 offen offset:3072 sc1
    s_add_u32 s43, s29, 0x3a04000
    buffer_store_dwordx4 v[128:131], v13, s[4:7], s43 offen offset:0 sc1
    buffer_store_dwordx4 v[128:131], v13, s[4:7], s43 offen offset:1024 sc1
    buffer_store_dwordx4 v[128:131], v13, s[4:7], s43 offen offset:2048 sc1
    buffer_store_dwordx4 v[128:131], v13, s[4:7], s43 offen offset:3072 sc1
    s_add_u32 s43, s29, 0x3c00000
    buffer_store_dwordx4 v[128:131], v13, s[4:7], s43 offen offset:0 sc1
    buffer_store_dwordx4 v[128:131], v13, s[4:7], s43 offen offset:1024 sc1
    buffer_store_dwordx4 v[128:131], v13, s[4:7], s43 offen offset:2048 sc1
    buffer_store_dwordx4 v[128:131], v13, s[4:7], s43 offen offset:3072 sc1
    s_add_u32 s43, s29, 0x3c04000
    buffer_store_dwordx4 v[128:131], v13, s[4:7], s43 offen offset:0 sc1
    buffer_store_dwordx4 v[128:131], v13, s[4:7], s43 offen offset:1024 sc1
    buffer_store_dwordx4 v[128:131], v13, s[4:7], s43 offen offset:2048 sc1
    buffer_store_dwordx4 v[128:131], v13, s[4:7], s43 offen offset:3072 sc1
    s_add_u32 s43, s29, 0x3e00000
    buffer_store_dwordx4 v[128:131], v13, s[4:7], s43 offen offset:0 sc1
    buffer_store_dwordx4 v[128:131], v13, s[4:7], s43 offen offset:1024 sc1
    buffer_store_dwordx4 v[128:131], v13, s[4:7], s43 offen offset:2048 sc1
    buffer_store_dwordx4 v[128:131], v13, s[4:7], s43 offen offset:3072 sc1
    s_add_u32 s43, s29, 0x3e04000
    buffer_store_dwordx4 v[128:131], v13, s[4:7], s43 offen offset:0 sc1
    buffer_store_dwordx4 v[128:131], v13, s[4:7], s43 offen offset:1024 sc1
    buffer_store_dwordx4 v[128:131], v13, s[4:7], s43 offen offset:2048 sc1
    buffer_store_dwordx4 v[128:131], v13, s[4:7], s43 offen offset:3072 sc1
    s_waitcnt vmcnt(0)
L_att:
    s_add_u32 s25, s12, 1
    s_add_u32 s62, s12, 3
    s_min_u32 s62, s62, 63
    s_add_u32 s20, s20, 1048576
    s_add_u32 s18, s18, 65536
    s_cmp_lt_u32 s12, 62
    s_cselect_b32 s20, s20, 0x80000000
    s_cselect_b32 s18, s18, 0x80000000
    s_add_u32 s21, s20, 4096
    s_add_u32 s22, s20, 8192
    s_add_u32 s23, s20, 12288
    s_add_u32 s30, s29, 16384
    s_xor_b32 s19, s19, 32768
    s_cmp_lt_u32 s12, 56
    s_cselect_b32 s60, 0x80000000, s27
    s_cmp_eq_u32 s13, 0
    s_cselect_b32 s60, s60, 0x80000000
    s_waitcnt vmcnt(8)
    s_barrier
    ds_read_b128 v[32:35], v30 offset:0
    ds_read_b128 v[36:39], v30 offset:16384
    ds_read_b128 v[40:43], v31 offset:0
    ds_read_b128 v[44:47], v31 offset:16384
    ds_read_b128 v[48:51], v30 offset:1024
    ds_read_b128 v[52:55], v30 offset:17408
    ds_read_b128 v[56:59], v31 offset:1024
    ds_read_b128 v[60:63], v31 offset:17408
    s_waitcnt lgkmcnt(6)
    v_mfma_f32_16x16x32_bf16 v[160:163], a[0:3], v[32:35], 0
    ds_read_b128 v[64:67], v30 offset:2048
    ds_read_b128 v[68:71], v30 offset:18432
    v_mfma_f32_16x16x32_bf16 v[164:167], a[4:7], v[32:35], 0
    v_mfma_f32_16x16x32_bf16 v[168:171], a[0:3], v[36:39], 0
    v_mfma_f32_16x16x32_bf16 v[172:175], a[4:7], v[36:39], 0
    s_waitcnt lgkmcnt(6)
    v_mfma_f32_16x16x32_bf16 v[160:163], a[8:11], v[40:43], v[160:163]
    ds_read_b128 v[72:75], v31 offset:2048
    ds_read_b128 v[76:79], v31 offset:18432
    v_mfma_f32_16x16x32_bf16 v[164:167], a[12:15], v[40:43], v[164:167]
    v_mfma_f32_16x16x32_bf16 v[168:171], a[8:11], v[44:47], v[168:171]
    v_mfma_f32_16x16x32_bf16 v[172:175], a[12:15], v[44:47], v[172:175]
    s_waitcnt lgkmcnt(6)
    v_mfma_f32_16x16x32_bf16 v[160:163], a[16:19], v[48:51], v[160:163]
    ds_read_b128 v[80:83], v30 offset:3072
    ds_read_b128 v[84:87], v30 offset:19456
    v_mfma_f32_16x16x32_bf16 v[164:167], a[20:23], v[48:51], v[164:167]
    v_mfma_f32_16x16x32_bf16 v[168:171], a[16:19], v[52:55], v[168:171]
    v_mfma_f32_16x16x32_bf16 v[172:175], a[20:23], v[52:55], v[172:175]
    s_waitcnt lgkmcnt(6)
    v_mfma_f32_16x16x32_bf16 v[160:163], a[24:27], v[56:59], v[160:163]
    ds_read_b128 v[88:91], v31 offset:3072
    ds_read_b128 v[92:95], v31 offset:19456
    v_mfma_f32_16x16x32_bf16 v[164:167], a[28:31], v[56:59], v[164:167]
    v_mfma_f32_16x16x32_bf16 v[168:171], a[24:27], v[60:63], v[168:171]
    buffer_load_dwordx4 v[52:55], v3, s[4:7], s28 offen sc1
    v_mfma_f32_16x16x32_bf16 v[172:175], a[28:31], v[60:63], v[172:175]
    s_waitcnt lgkmcnt(6)
    v_mfma_f32_16x16x32_bf16 v[160:163], a[32:35], v[64:67], v[160:163]
    ds_read_b128 v[96:99], v30 offset:4096
    ds_read_b128 v[100:103], v30 offset:20480
    v_mfma_f32_16x16x32_bf16 v[164:167], a[36:39], v[64:67], v[164:167]
    v_mfma_f32_16x16x32_bf16 v[168:171], a[32:35], v[68:71], v[168:171]
    s_add_u32 m0, s19, 0
    s_nop 0
    buffer_load_dwordx4 v6, s[4:7], s18 offen offset:0 sc1 lds
    v_mfma_f32_16x16x32_bf16 v[172:175], a[36:39], v[68:71], v[172:175]
    s_waitcnt lgkmcnt(6)
    v_mfma_f32_16x16x32_bf16 v[160:163], a[40:43], v[72:75], v[160:163]
    ds_read_b128 v[104:107], v31 offset:4096
    ds_read_b128 v[108:111], v31 offset:20480
    v_mfma_f32_16x16x32_bf16 v[164:167], a[44:47], v[72:75], v[164:167]
    v_mfma_f32_16x16x32_bf16 v[168:171], a[40:43], v[76:79], v[168:171]
    s_add_u32 m0, s19, 896
    s_nop 0
    buffer_load_dwordx4 v6, s[4:7], s18 offen offset:128 sc1 lds
    v_mfma_f32_16x16x32_bf16 v[172:175], a[44:47], v[76:79], v[172:175]
    s_waitcnt lgkmcnt(6)
    v_mfma_f32_16x16x32_bf16 v[160:163], a[48:51], v[80:83], v[160:163]
    ds_read_b128 v[112:115], v30 offset:5120
    ds_read_b128 v[116:119], v30 offset:21504
    v_mfma_f32_16x16x32_bf16 v[164:167], a[52:55], v[80:83], v[164:167]
    v_mfma_f32_16x16x32_bf16 v[168:171], a[48:51], v[84:87], v[168:171]
    s_add_u32 m0, s19, 1792
    s_nop 0
    buffer_load_dwordx4 v6, s[4:7], s18 offen offset:256 sc1 lds
    v_mfma_f32_16x16x32_bf16 v[172:175], a[52:55], v[84:87], v[172:175]
    s_waitcnt lgkmcnt(6)
    v_mfma_f32_16x16x32_bf16 v[160:163], a[56:59], v[88:91], v[160:163]
    ds_read_b128 v[120:123], v31 offset:5120
    ds_read_b128 v[124:127], v31 offset:21504
    v_mfma_f32_16x16x32_bf16 v[164:167], a[60:63], v[88:91], v[164:167]
    v_mfma_f32_16x16x32_bf16 v[168:171], a[56:59], v[92:95], v[168:171]
    s_add_u32 m0, s19, 2688
    s_nop 0
    buffer_load_dwordx4 v6, s[4:7], s18 offen offset:384 sc1 lds
    v_mfma_f32_16x16x32_bf16 v[172:175], a[60:63], v[92:95], v[172:175]
    s_waitcnt lgkmcnt(6)
    v_mfma_f32_16x16x32_bf16 v[160:163], a[64:67], v[96:99], v[160:163]
    ds_read_b128 v[128:131], v30 offset:6144
    ds_read_b128 v[132:135], v30 offset:22528
    v_mfma_f32_16x16x32_bf16 v[164:167], a[68:71], v[96:99], v[164:167]
    v_mfma_f32_16x16x32_bf16 v[168:171], a[64:67], v[100:103], v[168:171]
    s_add_u32 m0, s19, 3584
    s_nop 0
    buffer_load_dwordx4 v6, s[4:7], s18 offen offset:512 sc1 lds
    v_mfma_f32_16x16x32_bf16 v[172:175], a[68:71], v[100:103], v[172:175]
    s_waitcnt lgkmcnt(6)
    v_mfma_f32_16x16x32_bf16 v[160:163], a[72:75], v[104:107], v[160:163]
    ds_read_b128 v[136:139], v31 offset:6144
    ds_read_b128 v[140:143], v31 offset:22528
    v_mfma_f32_16x16x32_bf16 v[164:167], a[76:79], v[104:107], v[164:167]
    v_mfma_f32_16x16x32_bf16 v[168:171], a[72:75], v[108:111], v[168:171]
    s_add_u32 m0, s19, 4480
    s_nop 0
    buffer_load_dwordx4 v6, s[4:7], s18 offen offset:640 sc1 lds
    v_mfma_f32_16x16x32_bf16 v[172:175], a[76:79], v[108:111], v[172:175]
    s_waitcnt lgkmcnt(6)
    v_mfma_f32_16x16x32_bf16 v[160:163], a[80:83], v[112:115], v[160:163]
    ds_read_b128 v[144:147], v30 offset:7168
    ds_read_b128 v[148:151], v30 offset:23552
    v_mfma_f32_16x16x32_bf16 v[164:167], a[84:87], v[112:115], v[164:167]
    v_mfma_f32_16x16x32_bf16 v[168:171], a[80:83], v[116:119], v[168:171]
    s_add_u32 m0, s19, 5376
    s_nop 0
    buffer_load_dwordx4 v6, s[4:7], s18 offen offset:768 sc1 lds
    v_mfma_f32_16x16x32_bf16 v[172:175], a[84:87], v[116:119], v[172:175]
    s_waitcnt lgkmcnt(6)
    v_mfma_f32_16x16x32_bf16 v[160:163], a[88:91], v[120:123], v[160:163]
    ds_read_b128 v[152:155], v31 offset:7168
    ds_read_b128 v[156:159], v31 offset:23552
    v_mfma_f32_16x16x32_bf16 v[164:167], a[92:95], v[120:123], v[164:167]
    v_mfma_f32_16x16x32_bf16 v[168:171], a[88:91], v[124:127], v[168:171]
    s_add_u32 m0, s19, 6272
    s_nop 0
    buffer_load_dwordx4 v6, s[4:7], s18 offen offset:896 sc1 lds
    v_mfma_f32_16x16x32_bf16 v[172:175], a[92:95], v[124:127], v[172:175]
    s_waitcnt lgkmcnt(6)
    v_mfma_f32_16x16x32_bf16 v[160:163], a[96:99], v[128:131], v[160:163]
    ds_read_b128 v[176:179], v19 offset:16384
    v_mfma_f32_16x16x32_bf16 v[164:167], a[100:103], v[128:131], v[164:167]
    ds_read_b128 v[180:183], v19 offset:17408
    v_mfma_f32_16x16x32_bf16 v[168:171], a[96:99], v[132:135], v[168:171]
    ds_read_b128 v[184:187], v19 offset:18432
    v_mfma_f32_16x16x32_bf16 v[172:175], a[100:103], v[132:135], v[172:175]
    ds_read_b128 v[188:191], v19 offset:19456
    s_waitcnt lgkmcnt(8)
    v_mfma_f32_16x16x32_bf16 v[160:163], a[104:107], v[136:139], v[160:163]
    ds_read_b128 v[192:195], v19 offset:20480
    v_mfma_f32_16x16x32_bf16 v[164:167], a[108:111], v[136:139], v[164:167]
    ds_read_b128 v[196:199], v19 offset:21504
    v_mfma_f32_16x16x32_bf16 v[168:171], a[104:107], v[140:143], v[168:171]
    ds_read_b128 v[200:203], v19 offset:22528
    v_mfma_f32_16x16x32_bf16 v[172:175], a[108:111], v[140:143], v[172:175]
    ds_read_b128 v[204:207], v19 offset:23552
    s_waitcnt lgkmcnt(10)
    v_mfma_f32_16x16x32_bf16 v[160:163], a[112:115], v[144:147], v[160:163]
    ds_read_b128 v[208:211], v11 offset:24576
    v_mfma_f32_16x16x32_bf16 v[164:167], a[116:119], v[144:147], v[164:167]
    ds_read_b128 v[212:215], v11 offset:28672
    v_mfma_f32_16x16x32_bf16 v[168:171], a[112:115], v[148:151], v[168:171]
    ds_read_b128 v[216:219], v11 offset:25600
    v_mfma_f32_16x16x32_bf16 v[172:175], a[116:119], v[148:151], v[172:175]
    ds_read_b128 v[220:223], v11 offset:29696
    s_waitcnt lgkmcnt(12)
    v_mfma_f32_16x16x32_bf16 v[160:163], a[120:123], v[152:155], v[160:163]
    v_mfma_f32_16x16x32_bf16 v[164:167], a[124:127], v[152:155], v[164:167]
    v_mfma_f32_16x16x32_bf16 v[168:171], a[120:123], v[156:159], v[168:171]
    v_mfma_f32_16x16x32_bf16 v[172:175], a[124:127], v[156:159], v[172:175]
    v_xor_b32 v30, 0x8000, v30
    v_xor_b32 v31, 0x8000, v31
    v_cvt_pk_bf16_f32 v128, v160, v164
    v_cvt_pk_bf16_f32 v129, v161, v165
    v_cvt_pk_bf16_f32 v130, v162, v166
    v_cvt_pk_bf16_f32 v131, v163, v167
    ds_write_b128 v28, v[128:131] offset:0
    s_nop 0
    v_cvt_pk_bf16_f32 v132, v168, v172
    v_cvt_pk_bf16_f32 v133, v169, v173
    v_cvt_pk_bf16_f32 v134, v170, v174
    v_cvt_pk_bf16_f32 v135, v171, v175
    ds_write_b128 v28, v[132:135] offset:4096
    s_waitcnt vmcnt(8) lgkmcnt(0)
    s_barrier
    ds_read_b128 v[224:227], v10 offset:0
    ds_read_b128 v[228:231], v10 offset:1024
    ds_read_b128 v[232:235], v10 offset:2048
    ds_read_b128 v[236:239], v10 offset:3072
    s_cmp_eq_u32 s13, 0
    s_cbranch_scc0 L_pf_39
    v_mov_b32 v4, s61
    s_mov_b64 exec, 0x1
    buffer_store_dword v4, v8, s[4:7], s27 offen sc1
    s_mov_b64 exec, -1
L_pf_39:
    s_mov_b32 s42, 0
    v_cmp_gt_u32 vcc, s62, v18
    s_cbranch_vccz L_sd_41
L_sp_40:
    buffer_load_dword v18, off, s[4:7], s24 sc1
    s_waitcnt vmcnt(0)
    v_cmp_gt_u32 vcc, s62, v18
    s_cbranch_vccz L_sd_41
    s_add_u32 s42, s42, 1
    s_cmp_lt_u32 s42, 2097152
    s_cbranch_scc1 L_sp_40
    s_branch L_fail
L_sd_41:
    s_waitcnt lgkmcnt(3)
    v_mfma_f32_16x16x32_bf16 v[240:243], v[176:179], v[224:227], 0
    v_mfma_f32_16x16x32_bf16 v[244:247], v[192:195], v[224:227], 0
    s_add_u32 m0, s63, 0
    s_nop 0
    buffer_load_dwordx4 v3, s[4:7], s20 offen sc1 lds
    s_waitcnt lgkmcnt(2)
    v_mfma_f32_16x16x32_bf16 v[240:243], v[180:183], v[228:231], v[240:243]
    v_mfma_f32_16x16x32_bf16 v[244:247], v[196:199], v[228:231], v[244:247]
    s_add_u32 m0, s63, 4096
    s_nop 0
    buffer_load_dwordx4 v3, s[4:7], s21 offen sc1 lds
    s_waitcnt lgkmcnt(1)
    v_mfma_f32_16x16x32_bf16 v[240:243], v[184:187], v[232:235], v[240:243]
    v_mfma_f32_16x16x32_bf16 v[244:247], v[200:203], v[232:235], v[244:247]
    s_add_u32 m0, s63, 8192
    s_nop 0
    buffer_load_dwordx4 v3, s[4:7], s22 offen sc1 lds
    s_waitcnt lgkmcnt(0)
    v_mfma_f32_16x16x32_bf16 v[240:243], v[188:191], v[236:239], v[240:243]
    v_mfma_f32_16x16x32_bf16 v[244:247], v[204:207], v[236:239], v[244:247]
    s_add_u32 m0, s63, 12288
    s_nop 0
    buffer_load_dwordx4 v3, s[4:7], s23 offen sc1 lds
    v_mov_b32 v205, 0
    v_mov_b32 v206, 0
    v_cndmask_b32 v240, v16, v240, s[68:69]
    v_cndmask_b32 v241, v16, v241, s[70:71]
    v_cndmask_b32 v242, v16, v242, s[72:73]
    v_cndmask_b32 v243, v16, v243, s[74:75]
    v_cndmask_b32 v244, v16, v244, s[76:77]
    v_cndmask_b32 v245, v16, v245, s[78:79]
    v_cndmask_b32 v246, v16, v246, s[80:81]
    v_cndmask_b32 v247, v16, v247, s[82:83]
    v_max3_f32 v252, v240, v241, v242
    v_max3_f32 v253, v243, v244, v245
    v_max3_f32 v252, v246, v247, v252
    v_max_f32 v252, v252, v253
    s_mov_b32 s42, 0
L_att_kc:
    v_cmp_eq_u32 vcc, -1, v52
    s_cbranch_vccz L_att_km
    buffer_load_dwordx4 v[52:55], v3, s[4:7], s28 offen sc1
    s_waitcnt vmcnt(0)
    s_add_u32 s42, s42, 1
    s_cmp_lt_u32 s42, 2097152
    s_cbranch_scc1 L_att_kc
    s_branch L_fail
L_att_km:
    ds_write2_b32 v17, v52, v53 offset0:0 offset1:4
    ds_write_b64 v29, v[54:55] offset:2048
    s_waitcnt lgkmcnt(0)
    s_barrier
    ds_read_b128 v[32:35], v15 offset:0
    ds_read_b128 v[36:39], v15 offset:512
    ds_read_b128 v[40:43], v15 offset:1024
    ds_read_b128 v[44:47], v15 offset:1536
    ds_read_b64 v[48:49], v14 offset:2048
    ds_read_b64 v[50:51], v14 offset:2560
    s_waitcnt lgkmcnt(5)
    v_mfma_f32_16x16x32_bf16 v[248:251], v[32:35], v[224:227], 0
    s_waitcnt lgkmcnt(4)
    v_mfma_f32_16x16x32_bf16 v[248:251], v[36:39], v[228:231], v[248:251]
    s_waitcnt lgkmcnt(3)
    v_mfma_f32_16x16x32_bf16 v[248:251], v[40:43], v[232:235], v[248:251]
    s_waitcnt lgkmcnt(2)
    v_mfma_f32_16x16x32_bf16 v[248:251], v[44:47], v[236:239], v[248:251]
    s_nop 7
    v_max3_f32 v253, v248, v249, v252
    v_max3_f32 v252, v248, v249, v252
    s_nop 1
    v_permlane32_swap_b32 v252, v253
    v_max_f32 v252, v252, v253
    v_mov_b32 v253, v252
    s_nop 1
    v_permlane16_swap_b32 v252, v253
    v_max_f32 v252, v252, v253
    v_mul_f32 v252, s31, v252
    v_fma_f32 v240, v240, s31, -v252
    v_fma_f32 v241, v241, s31, -v252
    v_fma_f32 v242, v242, s31, -v252
    v_fma_f32 v243, v243, s31, -v252
    v_fma_f32 v244, v244, s31, -v252
    v_fma_f32 v245, v245, s31, -v252
    v_fma_f32 v246, v246, s31, -v252
    v_fma_f32 v247, v247, s31, -v252
    v_fma_f32 v248, v248, s31, -v252
    v_fma_f32 v249, v249, s31, -v252
    v_exp_f32 v240, v240
    v_exp_f32 v241, v241
    v_exp_f32 v242, v242
    v_exp_f32 v243, v243
    v_exp_f32 v244, v244
    v_exp_f32 v245, v245
    v_exp_f32 v246, v246
    v_exp_f32 v247, v247
    v_exp_f32 v248, v248
    v_exp_f32 v249, v249
    v_cvt_pk_bf16_f32 v200, v240, v241
    v_cvt_pk_bf16_f32 v201, v242, v243
    v_cvt_pk_bf16_f32 v202, v244, v245
    v_cvt_pk_bf16_f32 v203, v246, v247
    v_cvt_pk_bf16_f32 v204, v248, v249
    v_cvt_pk_bf16_f32 v207, v248, v249
    v_mfma_f32_16x16x32_bf16 v[24:27], v[20:23], v[200:203], 0
    v_mfma_f32_16x16x32_bf16 v[160:163], v[208:211], v[200:203], 0
    v_mfma_f32_16x16x32_bf16 v[164:167], v[212:215], v[200:203], 0
    v_mfma_f32_16x16x16_bf16 v[24:27], v[20:21], v[204:205], v[24:27]
    v_mfma_f32_16x16x32_bf16 v[168:171], v[216:219], v[200:203], 0
    v_mfma_f32_16x16x32_bf16 v[172:175], v[220:223], v[200:203], 0
    s_waitcnt lgkmcnt(0)
    v_mfma_f32_16x16x16_bf16 v[160:163], v[48:49], v[204:205], v[160:163]
    v_rcp_f32 v24, v24
    v_mfma_f32_16x16x16_bf16 v[164:167], v[48:49], v[206:207], v[164:167]
    v_mfma_f32_16x16x16_bf16 v[168:171], v[50:51], v[204:205], v[168:171]
    v_mfma_f32_16x16x16_bf16 v[172:175], v[50:51], v[206:207], v[172:175]
    v_mul_f32 v160, v160, v24
    v_mul_f32 v161, v161, v24
    v_mul_f32 v162, v162, v24
    v_mul_f32 v163, v163, v24
    v_mul_f32 v164, v164, v24
    v_mul_f32 v165, v165, v24
    v_mul_f32 v166, v166, v24
    v_mul_f32 v167, v167, v24
    v_cvt_pk_bf16_f32 v128, v160, v161
    v_cvt_pk_bf16_f32 v129, v162, v163
    v_cvt_pk_bf16_f32 v130, v164, v165
    v_cvt_pk_bf16_f32 v131, v166, v167
    ds_write_b128 v12, v[128:131] offset:8192
    v_mul_f32 v168, v168, v24
    v_mul_f32 v169, v169, v24
    v_mul_f32 v170, v170, v24
    v_mul_f32 v171, v171, v24
    v_mul_f32 v172, v172, v24
    v_mul_f32 v173, v173, v24
    v_mul_f32 v174, v174, v24
    v_mul_f32 v175, v175, v24
    v_cvt_pk_bf16_f32 v132, v168, v169
    v_cvt_pk_bf16_f32 v133, v170, v171
    v_cvt_pk_bf16_f32 v134, v172, v173
    v_cvt_pk_bf16_f32 v135, v174, v175
    ds_write_b128 v12, v[132:135] offset:9216
    s_waitcnt lgkmcnt(0)
    s_barrier
    ds_read_b128 v[32:35], v19 offset:8192
    ds_read_b128 v[36:39], v19 offset:9216
    ds_read_b128 v[40:43], v19 offset:10240
    ds_read_b128 v[44:47], v19 offset:11264
    ds_read_b128 v[48:51], v19 offset:12288
    ds_read_b128 v[52:55], v19 offset:13312
    ds_read_b128 v[56:59], v19 offset:14336
    ds_read_b128 v[60:63], v19 offset:15360
    s_waitcnt lgkmcnt(7)
    v_mfma_f32_16x16x32_bf16 v[64:67], v[32:35], a[128:131], 0
    v_mov_b32 v4, s25
    s_mov_b64 exec, 0x1
    buffer_store_dword v4, v8, s[4:7], s60 offen sc1
    s_mov_b64 exec, -1
    v_mfma_f32_16x16x32_bf16 v[68:71], v[32:35], a[132:135], 0
    v_mfma_f32_16x16x32_bf16 v[72:75], v[32:35], a[136:139], 0
    v_mfma_f32_16x16x32_bf16 v[76:79], v[32:35], a[140:143], 0
    v_mfma_f32_16x16x32_bf16 v[80:83], v[32:35], a[144:147], 0
    v_mfma_f32_16x16x32_bf16 v[84:87], v[32:35], a[148:151], 0
    v_mfma_f32_16x16x32_bf16 v[88:91], v[32:35], a[152:155], 0
    v_mfma_f32_16x16x32_bf16 v[92:95], v[32:35], a[156:159], 0
    s_waitcnt lgkmcnt(6)
    v_mfma_f32_16x16x32_bf16 v[64:67], v[36:39], a[160:163], v[64:67]
    v_mfma_f32_16x16x32_bf16 v[68:71], v[36:39], a[164:167], v[68:71]
    v_mfma_f32_16x16x32_bf16 v[72:75], v[36:39], a[168:171], v[72:75]
    v_mfma_f32_16x16x32_bf16 v[76:79], v[36:39], a[172:175], v[76:79]
    v_mfma_f32_16x16x32_bf16 v[80:83], v[36:39], a[176:179], v[80:83]
    v_mfma_f32_16x16x32_bf16 v[84:87], v[36:39], a[180:183], v[84:87]
    v_mfma_f32_16x16x32_bf16 v[88:91], v[36:39], a[184:187], v[88:91]
    v_mfma_f32_16x16x32_bf16 v[92:95], v[36:39], a[188:191], v[92:95]
    s_waitcnt lgkmcnt(5)
    v_mfma_f32_16x16x32_bf16 v[64:67], v[40:43], a[192:195], v[64:67]
    v_mfma_f32_16x16x32_bf16 v[68:71], v[40:43], a[196:199], v[68:71]
    v_mfma_f32_16x16x32_bf16 v[72:75], v[40:43], a[200:203], v[72:75]
    v_mfma_f32_16x16x32_bf16 v[76:79], v[40:43], a[204:207], v[76:79]
    v_mfma_f32_16x16x32_bf16 v[80:83], v[40:43], a[208:211], v[80:83]
    v_mfma_f32_16x16x32_bf16 v[84:87], v[40:43], a[212:215], v[84:87]
    v_mfma_f32_16x16x32_bf16 v[88:91], v[40:43], a[216:219], v[88:91]
    v_mfma_f32_16x16x32_bf16 v[92:95], v[40:43], a[220:223], v[92:95]
    s_waitcnt lgkmcnt(4)
    v_mfma_f32_16x16x32_bf16 v[64:67], v[44:47], a[224:227], v[64:67]
    buffer_load_dword v18, off, s[4:7], s24 sc1
    v_mfma_f32_16x16x32_bf16 v[68:71], v[44:47], a[228:231], v[68:71]
    v_mfma_f32_16x16x32_bf16 v[72:75], v[44:47], a[232:235], v[72:75]
    v_mfma_f32_16x16x32_bf16 v[76:79], v[44:47], a[236:239], v[76:79]
    v_mfma_f32_16x16x32_bf16 v[80:83], v[44:47], a[240:243], v[80:83]
    v_mfma_f32_16x16x32_bf16 v[84:87], v[44:47], a[244:247], v[84:87]
    v_mfma_f32_16x16x32_bf16 v[88:91], v[44:47], a[248:251], v[88:91]
    v_mfma_f32_16x16x32_bf16 v[92:95], v[44:47], a[252:255], v[92:95]
    s_waitcnt lgkmcnt(3)
    v_mfma_f32_16x16x32_bf16 v[96:99], v[48:51], a[128:131], 0
    v_mfma_f32_16x16x32_bf16 v[100:103], v[48:51], a[132:135], 0
    v_mfma_f32_16x16x32_bf16 v[104:107], v[48:51], a[136:139], 0
    v_cvt_pk_bf16_f32 v128, v64, v68
    v_cvt_pk_bf16_f32 v129, v72, v76
    v_mfma_f32_16x16x32_bf16 v[108:111], v[48:51], a[140:143], 0
    v_cvt_pk_bf16_f32 v130, v80, v84
    v_cvt_pk_bf16_f32 v131, v88, v92
    v_mfma_f32_16x16x32_bf16 v[112:115], v[48:51], a[144:147], 0
    buffer_store_dwordx4 v[128:131], v13, s[4:7], s29 offen offset:0 sc1
    v_mfma_f32_16x16x32_bf16 v[116:119], v[48:51], a[148:151], 0
    v_cvt_pk_bf16_f32 v132, v65, v69
    v_cvt_pk_bf16_f32 v133, v73, v77
    v_mfma_f32_16x16x32_bf16 v[120:123], v[48:51], a[152:155], 0
    v_cvt_pk_bf16_f32 v134, v81, v85
    v_cvt_pk_bf16_f32 v135, v89, v93
    v_mfma_f32_16x16x32_bf16 v[124:127], v[48:51], a[156:159], 0
    buffer_store_dwordx4 v[132:135], v13, s[4:7], s29 offen offset:1024 sc1
    s_waitcnt lgkmcnt(2)
    v_mfma_f32_16x16x32_bf16 v[96:99], v[52:55], a[160:163], v[96:99]
    v_cvt_pk_bf16_f32 v136, v66, v70
    v_cvt_pk_bf16_f32 v137, v74, v78
    v_mfma_f32_16x16x32_bf16 v[100:103], v[52:55], a[164:167], v[100:103]
    v_cvt_pk_bf16_f32 v138, v82, v86
    v_cvt_pk_bf16_f32 v139, v90, v94
    v_mfma_f32_16x16x32_bf16 v[104:107], v[52:55], a[168:171], v[104:107]
    buffer_store_dwordx4 v[136:139], v13, s[4:7], s29 offen offset:2048 sc1
    v_mfma_f32_16x16x32_bf16 v[108:111], v[52:55], a[172:175], v[108:111]
    v_cvt_pk_bf16_f32 v140, v67, v71
    v_cvt_pk_bf16_f32 v141, v75, v79
    v_mfma_f32_16x16x32_bf16 v[112:115], v[52:55], a[176:179], v[112:115]
    v_cvt_pk_bf16_f32 v142, v83, v87
    v_cvt_pk_bf16_f32 v143, v91, v95
    v_mfma_f32_16x16x32_bf16 v[116:119], v[52:55], a[180:183], v[116:119]
    buffer_store_dwordx4 v[140:143], v13, s[4:7], s29 offen offset:3072 sc1
    v_mfma_f32_16x16x32_bf16 v[120:123], v[52:55], a[184:187], v[120:123]
    v_mfma_f32_16x16x32_bf16 v[124:127], v[52:55], a[188:191], v[124:127]
    s_waitcnt lgkmcnt(1)
    v_mfma_f32_16x16x32_bf16 v[96:99], v[56:59], a[192:195], v[96:99]
    v_mfma_f32_16x16x32_bf16 v[100:103], v[56:59], a[196:199], v[100:103]
    v_mfma_f32_16x16x32_bf16 v[104:107], v[56:59], a[200:203], v[104:107]
    v_mfma_f32_16x16x32_bf16 v[108:111], v[56:59], a[204:207], v[108:111]
    v_mfma_f32_16x16x32_bf16 v[112:115], v[56:59], a[208:211], v[112:115]
    v_mfma_f32_16x16x32_bf16 v[116:119], v[56:59], a[212:215], v[116:119]
    v_mfma_f32_16x16x32_bf16 v[120:123], v[56:59], a[216:219], v[120:123]
    v_mfma_f32_16x16x32_bf16 v[124:127], v[56:59], a[220:223], v[124:127]
    s_waitcnt lgkmcnt(0)
    v_mfma_f32_16x16x32_bf16 v[96:99], v[60:63], a[224:227], v[96:99]
    v_mfma_f32_16x16x32_bf16 v[100:103], v[60:63], a[228:231], v[100:103]
    v_mfma_f32_16x16x32_bf16 v[104:107], v[60:63], a[232:235], v[104:107]
    v_mfma_f32_16x16x32_bf16 v[108:111], v[60:63], a[236:239], v[108:111]
    v_mfma_f32_16x16x32_bf16 v[112:115], v[60:63], a[240:243], v[112:115]
    v_mfma_f32_16x16x32_bf16 v[116:119], v[60:63], a[244:247], v[116:119]
    v_mfma_f32_16x16x32_bf16 v[120:123], v[60:63], a[248:251], v[120:123]
    v_mfma_f32_16x16x32_bf16 v[124:127], v[60:63], a[252:255], v[124:127]
    v_cvt_pk_bf16_f32 v144, v96, v100
    v_cvt_pk_bf16_f32 v145, v104, v108
    v_cvt_pk_bf16_f32 v146, v112, v116
    s_nop 4
    v_cvt_pk_bf16_f32 v147, v120, v124
    buffer_store_dwordx4 v[144:147], v13, s[4:7], s30 offen offset:0 sc1
    v_cvt_pk_bf16_f32 v148, v97, v101
    v_cvt_pk_bf16_f32 v149, v105, v109
    v_cvt_pk_bf16_f32 v150, v113, v117
    v_cvt_pk_bf16_f32 v151, v121, v125
    buffer_store_dwordx4 v[148:151], v13, s[4:7], s30 offen offset:1024 sc1
    v_cvt_pk_bf16_f32 v152, v98, v102
    v_cvt_pk_bf16_f32 v153, v106, v110
    v_cvt_pk_bf16_f32 v154, v114, v118
    v_cvt_pk_bf16_f32 v155, v122, v126
    buffer_store_dwordx4 v[152:155], v13, s[4:7], s30 offen offset:2048 sc1
    v_cvt_pk_bf16_f32 v156, v99, v103
    v_cvt_pk_bf16_f32 v157, v107, v111
    v_cvt_pk_bf16_f32 v158, v115, v119
    v_cvt_pk_bf16_f32 v159, v123, v127
    buffer_store_dwordx4 v[156:159], v13, s[4:7], s30 offen offset:3072 sc1
    s_add_u32 s28, s28, 262144
    s_add_u32 s29, s29, 2097152
    s_mov_b32 s61, s25
    s_add_u32 s12, s12, 2
    s_cmp_lt_u32 s12, 64
    s_cbranch_scc1 L_att
    s_waitcnt vmcnt(0)
    s_barrier
    s_cmp_eq_u32 s13, 0
    s_cbranch_scc0 L_pf_42
    v_mov_b32 v4, s25
    s_mov_b64 exec, 0x1
    buffer_store_dword v4, v8, s[4:7], s27 offen sc1
    s_mov_b64 exec, -1
L_pf_42:
    s_branch L_done
L_role_ffn:
    s_mov_b32 s44, s76
    s_mov_b32 s45, s77
    s_mov_b32 s46, 0x158000
    s_mov_b32 s47, 0x00020000
    s_mov_b32 s48, s78
    s_mov_b32 s49, s79
    s_mov_b32 s50, 0x158000
    s_mov_b32 s51, 0x00020000
    s_mov_b32 s52, s80
    s_mov_b32 s53, s81
    s_mov_b32 s54, 0x158000
    s_mov_b32 s55, 0x00020000
    s_mov_b32 s56, s84
    s_mov_b32 s57, s85
    s_mov_b32 s58, 0x300000
    s_mov_b32 s59, 0x00020000
    v_and_b32 v1, 63, v0
    v_lshlrev_b32 v2, 4, v1
    s_lshl_b32 s43, s13, 10
    v_add_u32 v3, s43, v2
    s_mov_b32 s66, 0x05040100
    s_mov_b32 s67, 0x07060302
    v_bfe_u32 v4, v1, 4, 2
    v_mul_u32_u24 v8, 6144, v4
    v_bfe_u32 v4, v1, 0, 4
    v_lshl_add_u32 v8, v4, 7, v8
    s_mul_i32 s16, s14, 196608
    s_mul_i32 s43, s15, 98304
    s_add_u32 s16, s16, s43
    s_mul_i32 s43, s13, 24576
    s_add_u32 s16, s16, s43
    buffer_load_dword v40, v8, s[56:59], s16 offen
    s_cmp_eq_u32 s13, 0
    s_cbranch_scc0 L_g_43
    v_mov_b32 v5, 0
    s_mov_b32 s42, 0
L_sp_44:
    global_load_dword v4, v5, s[92:93] offset:132 sc1
    s_waitcnt vmcnt(0)
    v_cmp_gt_u32 vcc, 32, v4
    s_cbranch_vccz L_sd_45
    s_sleep 127
    s_add_u32 s42, s42, 1
    s_cmp_lt_u32 s42, 2097152
    s_cbranch_scc1 L_sp_44
    s_branch L_fail
L_sd_45:
    s_lshl_b32 s16, s14, 8
    s_lshl_b32 s43, s15, 7
    s_add_u32 s16, s16, s43
    s_add_u32 s16, s16, 0x180000
    s_mov_b32 s42, 0
L_sp_46:
    buffer_load_dword v4, off, s[4:7], s16 sc1
    s_waitcnt vmcnt(0)
    v_cmp_gt_u32 vcc, 5, v4
    s_cbranch_vccz L_sd_47
    s_sleep 8
    s_add_u32 s42, s42, 1
    s_cmp_lt_u32 s42, 2097152
    s_cbranch_scc1 L_sp_46
    s_branch L_fail
L_sd_47:
L_g_43:
    s_barrier
    v_bfe_u32 v4, v1, 1, 5
    v_mul_u32_u24 v8, 2752, v4
    v_bfe_u32 v4, v1, 0, 1
    v_lshl_add_u32 v8, v4, 4, v8
    v_bfe_u32 v4, v1, 4, 2
    v_lshlrev_b32 v9, 8, v4
    v_bfe_u32 v4, v1, 2, 2
    v_lshl_add_u32 v9, v4, 5, v9
    v_bfe_u32 v4, v1, 0, 2
    v_lshl_add_u32 v9, v4, 3, v9
    s_mul_i32 s17, s13, 16384
    v_add_u32 v9, s17, v9
    s_lshl_b32 s16, s14, 7
    s_lshl_b32 s43, s13, 5
    s_add_u32 s16, s16, s43
    s_cmp_lt_u32 s16, 2752
    s_cselect_b32 s16, s16, 0x40000000
    v_bfe_u32 v4, v1, 4, 2
    v_lshlrev_b32 v10, 12, v4
    v_bfe_u32 v4, v1, 0, 4
    v_lshl_add_u32 v10, v4, 4, v10
    s_lshl_b32 s23, s14, 16
    s_lshl_b32 s43, s13, 8
    s_add_u32 s23, s23, s43
    s_add_u32 s43, s16, 0x0
    s_add_u32 m0, s17, 0
    s_nop 0
    buffer_load_dwordx4 v8, s[44:47], s43 offen lds
    s_add_u32 s43, s16, 0x15800
    s_add_u32 m0, s17, 1024
    s_nop 0
    buffer_load_dwordx4 v8, s[44:47], s43 offen lds
    s_add_u32 s43, s16, 0x2b000
    s_add_u32 m0, s17, 2048
    s_nop 0
    buffer_load_dwordx4 v8, s[44:47], s43 offen lds
    s_add_u32 s43, s16, 0x40800
    s_add_u32 m0, s17, 3072
    s_nop 0
    buffer_load_dwordx4 v8, s[44:47], s43 offen lds
    s_add_u32 s43, s16, 0x56000
    s_add_u32 m0, s17, 4096
    s_nop 0
    buffer_load_dwordx4 v8, s[44:47], s43 offen lds
    s_add_u32 s43, s16, 0x6b800
    s_add_u32 m0, s17, 5120
    s_nop 0
    buffer_load_dwordx4 v8, s[44:47], s43 offen lds
    s_add_u32 s43, s16, 0x81000
    s_add_u32 m0, s17, 6144
    s_nop 0
    buffer_load_dwordx4 v8, s[44:47], s43 offen lds
    s_add_u32 s43, s16, 0x96800
    s_add_u32 m0, s17, 7168
    s_nop 0
    buffer_load_dwordx4 v8, s[44:47], s43 offen lds
    s_add_u32 s43, s16, 0xac000
    s_add_u32 m0, s17, 8192
    s_nop 0
    buffer_load_dwordx4 v8, s[44:47], s43 offen lds
    s_add_u32 s43, s16, 0xc1800
    s_add_u32 m0, s17, 9216
    s_nop 0
    buffer_load_dwordx4 v8, s[44:47], s43 offen lds
    s_add_u32 s43, s16, 0xd7000
    s_add_u32 m0, s17, 10240
    s_nop 0
    buffer_load_dwordx4 v8, s[44:47], s43 offen lds
    s_add_u32 s43, s16, 0xec800
    s_add_u32 m0, s17, 11264
    s_nop 0
    buffer_load_dwordx4 v8, s[44:47], s43 offen lds
    s_add_u32 s43, s16, 0x102000
    s_add_u32 m0, s17, 12288
    s_nop 0
    buffer_load_dwordx4 v8, s[44:47], s43 offen lds
    s_add_u32 s43, s16, 0x117800
    s_add_u32 m0, s17, 13312
    s_nop 0
    buffer_load_dwordx4 v8, s[44:47], s43 offen lds
    s_add_u32 s43, s16, 0x12d000
    s_add_u32 m0, s17, 14336
    s_nop 0
    buffer_load_dwordx4 v8, s[44:47], s43 offen lds
    s_add_u32 s43, s16, 0x142800
    s_add_u32 m0, s17, 15360
    s_nop 0
    buffer_load_dwordx4 v8, s[44:47], s43 offen lds
    s_waitcnt vmcnt(15)
    ds_read_b64_tr_b16 a[0:1], v9 offset:0
    ds_read_b64_tr_b16 a[2:3], v9 offset:128
    s_waitcnt vmcnt(14)
    ds_read_b64_tr_b16 a[4:5], v9 offset:1024
    ds_read_b64_tr_b16 a[6:7], v9 offset:1152
    s_waitcnt lgkmcnt(2)
    s_add_u32 s43, s16, 0x0
    s_add_u32 m0, s17, 0
    s_nop 0
    buffer_load_dwordx4 v8, s[48:51], s43 offen lds
    s_waitcnt vmcnt(14)
    ds_read_b64_tr_b16 a[8:9], v9 offset:2048
    ds_read_b64_tr_b16 a[10:11], v9 offset:2176
    s_waitcnt lgkmcnt(2)
    s_add_u32 s43, s16, 0x15800
    s_add_u32 m0, s17, 1024
    s_nop 0
    buffer_load_dwordx4 v8, s[48:51], s43 offen lds
    s_waitcnt vmcnt(14)
    ds_read_b64_tr_b16 a[12:13], v9 offset:3072
    ds_read_b64_tr_b16 a[14:15], v9 offset:3200
    s_waitcnt lgkmcnt(2)
    s_add_u32 s43, s16, 0x2b000
    s_add_u32 m0, s17, 2048
    s_nop 0
    buffer_load_dwordx4 v8, s[48:51], s43 offen lds
    s_waitcnt vmcnt(14)
    ds_read_b64_tr_b16 a[16:17], v9 offset:4096
    ds_read_b64_tr_b16 a[18:19], v9 offset:4224
    s_waitcnt lgkmcnt(2)
    s_add_u32 s43, s16, 0x40800
    s_add_u32 m0, s17, 3072
    s_nop 0
    buffer_load_dwordx4 v8, s[48:51], s43 offen lds
    s_waitcnt vmcnt(14)
    ds_read_b64_tr_b16 a[20:21], v9 offset:5120
    ds_read_b64_tr_b16 a[22:23], v9 offset:5248
    s_waitcnt lgkmcnt(2)
    s_add_u32 s43, s16, 0x56000
    s_add_u32 m0, s17, 4096
    s_nop 0
    buffer_load_dwordx4 v8, s[48:51], s43 offen lds
    s_waitcnt vmcnt(14)
    ds_read_b64_tr_b16 a[24:25], v9 offset:6144
    ds_read_b64_tr_b16 a[26:27], v9 offset:6272
    s_waitcnt lgkmcnt(2)
    s_add_u32 s43, s16, 0x6b800
    s_add_u32 m0, s17, 5120
    s_nop 0
    buffer_load_dwordx4 v8, s[48:51], s43 offen lds
    s_waitcnt vmcnt(14)
    ds_read_b64_tr_b16 a[28:29], v9 offset:7168
    ds_read_b64_tr_b16 a[30:31], v9 offset:7296
    s_waitcnt lgkmcnt(2)
    s_add_u32 s43, s16, 0x81000
    s_add_u32 m0, s17, 6144
    s_nop 0
    buffer_load_dwordx4 v8, s[48:51], s43 offen lds
    s_waitcnt vmcnt(14)
    ds_read_b64_tr_b16 a[32:33], v9 offset:8192
    ds_read_b64_tr_b16 a[34:35], v9 offset:8320
    s_waitcnt lgkmcnt(2)
    s_add_u32 s43, s16, 0x96800
    s_add_u32 m0, s17, 7168
    s_nop 0
    buffer_load_dwordx4 v8, s[48:51], s43 offen lds
    s_waitcnt vmcnt(14)
    ds_read_b64_tr_b16 a[36:37], v9 offset:9216
    ds_read_b64_tr_b16 a[38:39], v9 offset:9344
    s_waitcnt lgkmcnt(2)
    s_add_u32 s43, s16, 0xac000
    s_add_u32 m0, s17, 8192
    s_nop 0
    buffer_load_dwordx4 v8, s[48:51], s43 offen lds
    s_waitcnt vmcnt(14)
    ds_read_b64_tr_b16 a[40:41], v9 offset:10240
    ds_read_b64_tr_b16 a[42:43], v9 offset:10368
    s_waitcnt lgkmcnt(2)
    s_add_u32 s43, s16, 0xc1800
    s_add_u32 m0, s17, 9216
    s_nop 0
    buffer_load_dwordx4 v8, s[48:51], s43 offen lds
    s_waitcnt vmcnt(14)
    ds_read_b64_tr_b16 a[44:45], v9 offset:11264
    ds_read_b64_tr_b16 a[46:47], v9 offset:11392
    s_waitcnt lgkmcnt(2)
    s_add_u32 s43, s16, 0xd7000
    s_add_u32 m0, s17, 10240
    s_nop 0
    buffer_load_dwordx4 v8, s[48:51], s43 offen lds
    s_waitcnt vmcnt(14)
    ds_read_b64_tr_b16 a[48:49], v9 offset:12288
    ds_read_b64_tr_b16 a[50:51], v9 offset:12416
    s_waitcnt lgkmcnt(2)
    s_add_u32 s43, s16, 0xec800
    s_add_u32 m0, s17, 11264
    s_nop 0
    buffer_load_dwordx4 v8, s[48:51], s43 offen lds
    s_waitcnt vmcnt(14)
    ds_read_b64_tr_b16 a[52:53], v9 offset:13312
    ds_read_b64_tr_b16 a[54:55], v9 offset:13440
    s_waitcnt lgkmcnt(2)
    s_add_u32 s43, s16, 0x102000
    s_add_u32 m0, s17, 12288
    s_nop 0
    buffer_load_dwordx4 v8, s[48:51], s43 offen lds
    s_waitcnt vmcnt(14)
    ds_read_b64_tr_b16 a[56:57], v9 offset:14336
    ds_read_b64_tr_b16 a[58:59], v9 offset:14464
    s_waitcnt lgkmcnt(2)
    s_add_u32 s43, s16, 0x117800
    s_add_u32 m0, s17, 13312
    s_nop 0
    buffer_load_dwordx4 v8, s[48:51], s43 offen lds
    s_waitcnt vmcnt(14)
    ds_read_b64_tr_b16 a[60:61], v9 offset:15360
    ds_read_b64_tr_b16 a[62:63], v9 offset:15488
    s_waitcnt lgkmcnt(2)
    s_add_u32 s43, s16, 0x12d000
    s_add_u32 m0, s17, 14336
    s_nop 0
    buffer_load_dwordx4 v8, s[48:51], s43 offen lds
    s_waitcnt vmcnt(14)
    ds_read_b64_tr_b16 a[64:65], v9 offset:0
    ds_read_b64_tr_b16 a[66:67], v9 offset:128
    s_waitcnt lgkmcnt(2)
    s_add_u32 s43, s16, 0x142800
    s_add_u32 m0, s17, 15360
    s_nop 0
    buffer_load_dwordx4 v8, s[48:51], s43 offen lds
    s_add_u32 s43, s23, 0
    buffer_load_dwordx4 v[64:67], v10, s[52:55], s43 offen offset:0
    buffer_load_dwordx4 v[68:71], v10, s[52:55], s43 offen offset:1024
    buffer_load_dwordx4 v[72:75], v10, s[52:55], s43 offen offset:2048
    buffer_load_dwordx4 v[76:79], v10, s[52:55], s43 offen offset:3072
    s_add_u32 s43, s23, 16384
    buffer_load_dwordx4 v[80:83], v10, s[52:55], s43 offen offset:0
    buffer_load_dwordx4 v[84:87], v10, s[52:55], s43 offen offset:1024
    buffer_load_dwordx4 v[88:91], v10, s[52:55], s43 offen offset:2048
    buffer_load_dwordx4 v[92:95], v10, s[52:55], s43 offen offset:3072
    s_waitcnt vmcnt(22)
    ds_read_b64_tr_b16 a[68:69], v9 offset:1024
    ds_read_b64_tr_b16 a[70:71], v9 offset:1152
    s_waitcnt vmcnt(21)
    ds_read_b64_tr_b16 a[72:73], v9 offset:2048
    ds_read_b64_tr_b16 a[74:75], v9 offset:2176
    s_waitcnt vmcnt(20)
    ds_read_b64_tr_b16 a[76:77], v9 offset:3072
    ds_read_b64_tr_b16 a[78:79], v9 offset:3200
    s_waitcnt vmcnt(19)
    ds_read_b64_tr_b16 a[80:81], v9 offset:4096
    ds_read_b64_tr_b16 a[82:83], v9 offset:4224
    s_waitcnt vmcnt(18)
    ds_read_b64_tr_b16 a[84:85], v9 offset:5120
    ds_read_b64_tr_b16 a[86:87], v9 offset:5248
    s_waitcnt vmcnt(17)
    ds_read_b64_tr_b16 a[88:89], v9 offset:6144
    ds_read_b64_tr_b16 a[90:91], v9 offset:6272
    s_waitcnt vmcnt(16)
    ds_read_b64_tr_b16 a[92:93], v9 offset:7168
    ds_read_b64_tr_b16 a[94:95], v9 offset:7296
    s_waitcnt vmcnt(15)
    ds_read_b64_tr_b16 a[96:97], v9 offset:8192
    ds_read_b64_tr_b16 a[98:99], v9 offset:8320
    s_waitcnt vmcnt(14)
    ds_read_b64_tr_b16 a[100:101], v9 offset:9216
    ds_read_b64_tr_b16 a[102:103], v9 offset:9344
    s_waitcnt vmcnt(13)
    ds_read_b64_tr_b16 a[104:105], v9 offset:10240
    ds_read_b64_tr_b16 a[106:107], v9 offset:10368
    s_waitcnt vmcnt(12)
    ds_read_b64_tr_b16 a[108:109], v9 offset:11264
    ds_read_b64_tr_b16 a[110:111], v9 offset:11392
    s_waitcnt vmcnt(11)
    ds_read_b64_tr_b16 a[112:113], v9 offset:12288
    ds_read_b64_tr_b16 a[114:115], v9 offset:12416
    s_waitcnt vmcnt(10)
    ds_read_b64_tr_b16 a[116:117], v9 offset:13312
    ds_read_b64_tr_b16 a[118:119], v9 offset:13440
    s_waitcnt vmcnt(9)
    ds_read_b64_tr_b16 a[120:121], v9 offset:14336
    ds_read_b64_tr_b16 a[122:123], v9 offset:14464
    s_waitcnt vmcnt(8)
    ds_read_b64_tr_b16 a[124:125], v9 offset:15360
    ds_read_b64_tr_b16 a[126:127], v9 offset:15488
    s_waitcnt lgkmcnt(0)
    s_add_u32 s43, s23, 32768
    buffer_load_dwordx4 v[96:99], v10, s[52:55], s43 offen offset:0
    buffer_load_dwordx4 v[100:103], v10, s[52:55], s43 offen offset:1024
    buffer_load_dwordx4 v[104:107], v10, s[52:55], s43 offen offset:2048
    buffer_load_dwordx4 v[108:111], v10, s[52:55], s43 offen offset:3072
    s_add_u32 s43, s23, 49152
    buffer_load_dwordx4 v[112:115], v10, s[52:55], s43 offen offset:0
    buffer_load_dwordx4 v[116:119], v10, s[52:55], s43 offen offset:1024
    buffer_load_dwordx4 v[120:123], v10, s[52:55], s43 offen offset:2048
    buffer_load_dwordx4 v[124:127], v10, s[52:55], s43 offen offset:3072
    s_waitcnt vmcnt(8)
    v_perm_b32 v32, v68, v64, s66
    v_perm_b32 v33, v76, v72, s66
    v_perm_b32 v34, v84, v80, s66
    v_perm_b32 v35, v92, v88, s66
    v_accvgpr_write_b32 a128, v32
    v_accvgpr_write_b32 a129, v33
    v_accvgpr_write_b32 a130, v34
    v_accvgpr_write_b32 a131, v35
    v_perm_b32 v32, v68, v64, s67
    v_perm_b32 v33, v76, v72, s67
    v_perm_b32 v34, v84, v80, s67
    v_perm_b32 v35, v92, v88, s67
    v_accvgpr_write_b32 a132, v32
    v_accvgpr_write_b32 a133, v33
    v_accvgpr_write_b32 a134, v34
    v_accvgpr_write_b32 a135, v35
    v_perm_b32 v32, v69, v65, s66
    v_perm_b32 v33, v77, v73, s66
    v_perm_b32 v34, v85, v81, s66
    v_perm_b32 v35, v93, v89, s66
    v_accvgpr_write_b32 a136, v32
    v_accvgpr_write_b32 a137, v33
    v_accvgpr_write_b32 a138, v34
    v_accvgpr_write_b32 a139, v35
    v_perm_b32 v32, v69, v65, s67
    v_perm_b32 v33, v77, v73, s67
    v_perm_b32 v34, v85, v81, s67
    v_perm_b32 v35, v93, v89, s67
    v_accvgpr_write_b32 a140, v32
    v_accvgpr_write_b32 a141, v33
    v_accvgpr_write_b32 a142, v34
    v_accvgpr_write_b32 a143, v35
    v_perm_b32 v32, v70, v66, s66
    v_perm_b32 v33, v78, v74, s66
    v_perm_b32 v34, v86, v82, s66
    v_perm_b32 v35, v94, v90, s66
    v_accvgpr_write_b32 a144, v32
    v_accvgpr_write_b32 a145, v33
    v_accvgpr_write_b32 a146, v34
    v_accvgpr_write_b32 a147, v35
    v_perm_b32 v32, v70, v66, s67
    v_perm_b32 v33, v78, v74, s67
    v_perm_b32 v34, v86, v82, s67
    v_perm_b32 v35, v94, v90, s67
    v_accvgpr_write_b32 a148, v32
    v_accvgpr_write_b32 a149, v33
    v_accvgpr_write_b32 a150, v34
    v_accvgpr_write_b32 a151, v35
    v_perm_b32 v32, v71, v67, s66
    v_perm_b32 v33, v79, v75, s66
    v_perm_b32 v34, v87, v83, s66
    v_perm_b32 v35, v95, v91, s66
    v_accvgpr_write_b32 a152, v32
    v_accvgpr_write_b32 a153, v33
    v_accvgpr_write_b32 a154, v34
    v_accvgpr_write_b32 a155, v35
    v_perm_b32 v32, v71, v67, s67
    v_perm_b32 v33, v79, v75, s67
    v_perm_b32 v34, v87, v83, s67
    v_perm_b32 v35, v95, v91, s67
    v_accvgpr_write_b32 a156, v32
    v_accvgpr_write_b32 a157, v33
    v_accvgpr_write_b32 a158, v34
    v_accvgpr_write_b32 a159, v35
    s_waitcnt vmcnt(0)
    v_perm_b32 v32, v100, v96, s66
    v_perm_b32 v33, v108, v104, s66
    v_perm_b32 v34, v116, v112, s66
    v_perm_b32 v35, v124, v120, s66
    v_accvgpr_write_b32 a160, v32
    v_accvgpr_write_b32 a161, v33
    v_accvgpr_write_b32 a162, v34
    v_accvgpr_write_b32 a163, v35
    v_perm_b32 v32, v100, v96, s67
    v_perm_b32 v33, v108, v104, s67
    v_perm_b32 v34, v116, v112, s67
    v_perm_b32 v35, v124, v120, s67
    v_accvgpr_write_b32 a164, v32
    v_accvgpr_write_b32 a165, v33
    v_accvgpr_write_b32 a166, v34
    v_accvgpr_write_b32 a167, v35
    v_perm_b32 v32, v101, v97, s66
    v_perm_b32 v33, v109, v105, s66
    v_perm_b32 v34, v117, v113, s66
    v_perm_b32 v35, v125, v121, s66
    v_accvgpr_write_b32 a168, v32
    v_accvgpr_write_b32 a169, v33
    v_accvgpr_write_b32 a170, v34
    v_accvgpr_write_b32 a171, v35
    v_perm_b32 v32, v101, v97, s67
    v_perm_b32 v33, v109, v105, s67
    v_perm_b32 v34, v117, v113, s67
    v_perm_b32 v35, v125, v121, s67
    v_accvgpr_write_b32 a172, v32
    v_accvgpr_write_b32 a173, v33
    v_accvgpr_write_b32 a174, v34
    v_accvgpr_write_b32 a175, v35
    v_perm_b32 v32, v102, v98, s66
    v_perm_b32 v33, v110, v106, s66
    v_perm_b32 v34, v118, v114, s66
    v_perm_b32 v35, v126, v122, s66
    v_accvgpr_write_b32 a176, v32
    v_accvgpr_write_b32 a177, v33
    v_accvgpr_write_b32 a178, v34
    v_accvgpr_write_b32 a179, v35
    v_perm_b32 v32, v102, v98, s67
    v_perm_b32 v33, v110, v106, s67
    v_perm_b32 v34, v118, v114, s67
    v_perm_b32 v35, v126, v122, s67
    v_accvgpr_write_b32 a180, v32
    v_accvgpr_write_b32 a181, v33
    v_accvgpr_write_b32 a182, v34
    v_accvgpr_write_b32 a183, v35
    v_perm_b32 v32, v103, v99, s66
    v_perm_b32 v33, v111, v107, s66
    v_perm_b32 v34, v119, v115, s66
    v_perm_b32 v35, v127, v123, s66
    v_accvgpr_write_b32 a184, v32
    v_accvgpr_write_b32 a185, v33
    v_accvgpr_write_b32 a186, v34
    v_accvgpr_write_b32 a187, v35
    v_perm_b32 v32, v103, v99, s67
    v_perm_b32 v33, v111, v107, s67
    v_perm_b32 v34, v119, v115, s67
    v_perm_b32 v35, v127, v123, s67
    v_accvgpr_write_b32 a188, v32
    v_accvgpr_write_b32 a189, v33
    v_accvgpr_write_b32 a190, v34
    v_accvgpr_write_b32 a191, v35
    s_lshl_b32 s43, s13, 8
    v_add_u32 v10, s43, v10
    v_bfe_u32 v4, v1, 4, 2
    v_and_b32 v5, 7, v1
    v_xor_b32 v5, v5, v4
    s_and_b32 s64, s13, 1
    s_lshl_b32 s64, s64, 2
    v_xor_b32 v5, s64, v5
    v_lshrrev_b32 v4, 3, v1
    v_lshlrev_b32 v6, 10, v4
    v_lshl_add_u32 v6, v5, 4, v6
    s_lshl_b32 s19, s13, 13
    s_lshl_b32 s64, s15, 15
    s_add_u32 s18, s19, s64
    s_add_u32 s18, s18, 0x3b00000
    v_bfe_u32 v4, v1, 1, 3
    v_lshrrev_b32 v5, 4, v1
    v_xor_b32 v5, v5, v4
    v_bfe_u32 v4, v1, 3, 1
    v_lshlrev_b32 v30, 13, v4
    v_bfe_u32 v4, v1, 0, 3
    v_lshl_add_u32 v30, v4, 7, v30
    v_lshl_add_u32 v30, v5, 4, v30
    v_xor_b32 v31, 64, v30
    v_bfe_u32 v4, v1, 0, 5
    v_lshlrev_b32 v11, 7, v4
    s_lshr_b32 s64, s13, 1
    s_lshl_b32 s64, s64, 10
    s_and_b32 s43, s13, 1
    s_lshl_b32 s43, s43, 3
    s_add_u32 s43, s43, s64
    v_add_u32 v12, s43, v2
    s_mov_b32 s25, 0xbfb8aa3b
    s_mul_i32 s23, s15, 720896
    s_lshl_b32 s43, s14, 15
    s_add_u32 s23, s23, s43
    s_add_u32 s23, s23, 0x8000000
    s_lshl_b32 s22, s14, 7
    s_lshl_b32 s43, s15, 12
    s_add_u32 s22, s22, s43
    s_add_u32 s22, s22, 0x18c000
    s_and_b32 s64, s13, 0
    s_lshl_b32 s20, s15, 12
    s_lshl_b32 s43, s64, 14
    s_add_u32 s20, s20, s43
    s_add_u32 s20, s20, 0x194000
    v_lshlrev_b32 v8, 13, v1
    s_mov_b32 s12, s15
    s_barrier
    s_mov_b32 s27, 0
    v_mov_b32 v13, 0
    v_add_u32 v14, s19, v2
    v_mov_b32 v128, -1
    v_mov_b32 v129, -1
    v_mov_b32 v130, -1
    v_mov_b32 v131, -1
    s_add_u32 s43, s23, 0x2680000
    buffer_store_dwordx4 v[128:131], v10, s[4:7], s43 offen offset:0 sc1
    buffer_store_dwordx4 v[128:131], v10, s[4:7], s43 offen offset:1024 sc1
    buffer_store_dwordx4 v[128:131], v10, s[4:7], s43 offen offset:2048 sc1
    buffer_store_dwordx4 v[128:131], v10, s[4:7], s43 offen offset:3072 sc1
    s_add_u32 s43, s23, 0x2684000
    buffer_store_dwordx4 v[128:131], v10, s[4:7], s43 offen offset:0 sc1
    buffer_store_dwordx4 v[128:131], v10, s[4:7], s43 offen offset:1024 sc1
    buffer_store_dwordx4 v[128:131], v10, s[4:7], s43 offen offset:2048 sc1
    buffer_store_dwordx4 v[128:131], v10, s[4:7], s43 offen offset:3072 sc1
    s_add_u32 s43, s23, 0x27e0000
    buffer_store_dwordx4 v[128:131], v10, s[4:7], s43 offen offset:0 sc1
    buffer_store_dwordx4 v[128:131], v10, s[4:7], s43 offen offset:1024 sc1
    buffer_store_dwordx4 v[128:131], v10, s[4:7], s43 offen offset:2048 sc1
    buffer_store_dwordx4 v[128:131], v10, s[4:7], s43 offen offset:3072 sc1
    s_add_u32 s43, s23, 0x27e4000
    buffer_store_dwordx4 v[128:131], v10, s[4:7], s43 offen offset:0 sc1
    buffer_store_dwordx4 v[128:131], v10, s[4:7], s43 offen offset:1024 sc1
    buffer_store_dwordx4 v[128:131], v10, s[4:7], s43 offen offset:2048 sc1
    buffer_store_dwordx4 v[128:131], v10, s[4:7], s43 offen offset:3072 sc1
    s_add_u32 s43, s23, 0x2940000
    buffer_store_dwordx4 v[128:131], v10, s[4:7], s43 offen offset:0 sc1
    buffer_store_dwordx4 v[128:131], v10, s[4:7], s43 offen offset:1024 sc1
    buffer_store_dwordx4 v[128:131], v10, s[4:7], s43 offen offset:2048 sc1
    buffer_store_dwordx4 v[128:131], v10, s[4:7], s43 offen offset:3072 sc1
    s_add_u32 s43, s23, 0x2944000
    buffer_store_dwordx4 v[128:131], v10, s[4:7], s43 offen offset:0 sc1
    buffer_store_dwordx4 v[128:131], v10, s[4:7], s43 offen offset:1024 sc1
    buffer_store_dwordx4 v[128:131], v10, s[4:7], s43 offen offset:2048 sc1
    buffer_store_dwordx4 v[128:131], v10, s[4:7], s43 offen offset:3072 sc1
    s_add_u32 s43, s23, 0x2aa0000
    buffer_store_dwordx4 v[128:131], v10, s[4:7], s43 offen offset:0 sc1
    buffer_store_dwordx4 v[128:131], v10, s[4:7], s43 offen offset:1024 sc1
    buffer_store_dwordx4 v[128:131], v10, s[4:7], s43 offen offset:2048 sc1
    buffer_store_dwordx4 v[128:131], v10, s[4:7], s43 offen offset:3072 sc1
    s_add_u32 s43, s23, 0x2aa4000
    buffer_store_dwordx4 v[128:131], v10, s[4:7], s43 offen offset:0 sc1
    buffer_store_dwordx4 v[128:131], v10, s[4:7], s43 offen offset:1024 sc1
    buffer_store_dwordx4 v[128:131], v10, s[4:7], s43 offen offset:2048 sc1
    buffer_store_dwordx4 v[128:131], v10, s[4:7], s43 offen offset:3072 sc1
    s_waitcnt vmcnt(0)
L_ffn:
    s_add_u32 s21, s12, 1
    s_add_u32 s24, s23, 16384
    s_cmp_lt_u32 s12, 56
    s_cselect_b32 s26, 0x80000000, s22
    s_cmp_eq_u32 s13, 0
    s_cselect_b32 s26, s26, 0x80000000
    v_cmp_gt_u32 vcc, s21, v13
    s_cbranch_vccz L_sd_49
    s_mov_b32 s42, 0
    s_mov_b32 s42, 0
L_sp_51:
    buffer_load_dword v13, off, s[4:7], s20 sc1
    s_waitcnt vmcnt(0)
    v_cmp_gt_u32 vcc, s21, v13
    s_cbranch_vccz L_sd_52
    s_add_u32 s42, s42, 1
    s_cmp_lt_u32 s42, 2097152
    s_cbranch_scc1 L_sp_51
    s_branch L_fail
L_sd_52:
    s_mov_b32 exec_hi, 0
L_sp_48:
    buffer_load_dword v13, v11, s[4:7], s20 offen sc1
    s_waitcnt vmcnt(0)
    v_cmp_gt_u32 vcc, s21, v13
    s_mov_b64 exec, vcc
    s_cbranch_vccz L_s1_50
    s_add_u32 s42, s42, 1
    s_cmp_lt_u32 s42, 2097152
    s_cbranch_scc1 L_sp_48
    s_branch L_fail
L_s1_50:
    s_mov_b64 exec, -1
L_sd_49:
    s_mov_b32 s42, 0
L_ffn_g:
    buffer_load_dwordx4 v[192:195], v6, s[4:7], s18 offen offset:0 sc1
    buffer_load_dwordx4 v[196:199], v6, s[4:7], s18 offen offset:128 sc1
    buffer_load_dwordx4 v[200:203], v6, s[4:7], s18 offen offset:256 sc1
    buffer_load_dwordx4 v[204:207], v6, s[4:7], s18 offen offset:384 sc1
    buffer_load_dwordx4 v[208:211], v6, s[4:7], s18 offen offset:512 sc1
    buffer_load_dwordx4 v[212:215], v6, s[4:7], s18 offen offset:640 sc1
    buffer_load_dwordx4 v[216:219], v6, s[4:7], s18 offen offset:768 sc1
    buffer_load_dwordx4 v[220:223], v6, s[4:7], s18 offen offset:896 sc1
    s_waitcnt vmcnt(7)
    ds_write_b128 v14, v[192:195] offset:0
    s_waitcnt vmcnt(6)
    ds_write_b128 v14, v[196:199] offset:1024
    s_waitcnt vmcnt(5)
    ds_write_b128 v14, v[200:203] offset:2048
    v_max3_u32 v176, v192, v196, v200
    s_waitcnt vmcnt(4)
    ds_write_b128 v14, v[204:207] offset:3072
    s_waitcnt vmcnt(3)
    ds_write_b128 v14, v[208:211] offset:4096
    s_waitcnt vmcnt(2)
    ds_write_b128 v14, v[212:215] offset:5120
    v_max3_u32 v177, v204, v208, v212
    s_waitcnt vmcnt(1)
    ds_write_b128 v14, v[216:219] offset:6144
    s_waitcnt vmcnt(0)
    ds_write_b128 v14, v[220:223] offset:7168
    v_max3_u32 v176, v216, v220, v176
    v_max_u32 v176, v176, v177
    v_cmp_eq_u32 vcc, -1, v176
L_ffn_h:
    s_cbranch_vccnz L_ffn_r
    s_add_u32 s18, s18, 65536
    s_xor_b32 s20, s20, 8192
    s_waitcnt lgkmcnt(0)
    s_barrier
    ds_read_b128 v[32:35], v30 offset:0
    ds_read_b128 v[36:39], v30 offset:16384
    ds_read_b128 v[40:43], v31 offset:0
    ds_read_b128 v[44:47], v31 offset:16384
    ds_read_b128 v[48:51], v30 offset:1024
    ds_read_b128 v[52:55], v30 offset:17408
    ds_read_b128 v[56:59], v31 offset:1024
    ds_read_b128 v[60:63], v31 offset:17408
    s_waitcnt lgkmcnt(6)
    v_mfma_f32_16x16x32_bf16 v[160:163], a[0:3], v[32:35], 0
    ds_read_b128 v[64:67], v30 offset:2048
    ds_read_b128 v[68:71], v30 offset:18432
    v_mfma_f32_16x16x32_bf16 v[164:167], a[64:67], v[32:35], 0
    v_mfma_f32_16x16x32_bf16 v[168:171], a[0:3], v[36:39], 0
    v_mfma_f32_16x16x32_bf16 v[172:175], a[64:67], v[36:39], 0
    s_waitcnt lgkmcnt(6)
    v_mfma_f32_16x16x32_bf16 v[160:163], a[4:7], v[40:43], v[160:163]
    ds_read_b128 v[72:75], v31 offset:2048
    ds_read_b128 v[76:79], v31 offset:18432
    v_mfma_f32_16x16x32_bf16 v[164:167], a[68:71], v[40:43], v[164:167]
    v_mfma_f32_16x16x32_bf16 v[168:171], a[4:7], v[44:47], v[168:171]
    v_mfma_f32_16x16x32_bf16 v[172:175], a[68:71], v[44:47], v[172:175]
    s_waitcnt lgkmcnt(6)
    v_mfma_f32_16x16x32_bf16 v[160:163], a[8:11], v[48:51], v[160:163]
    ds_read_b128 v[80:83], v30 offset:3072
    ds_read_b128 v[84:87], v30 offset:19456
    v_mfma_f32_16x16x32_bf16 v[164:167], a[72:75], v[48:51], v[164:167]
    v_mfma_f32_16x16x32_bf16 v[168:171], a[8:11], v[52:55], v[168:171]
    v_mfma_f32_16x16x32_bf16 v[172:175], a[72:75], v[52:55], v[172:175]
    s_waitcnt lgkmcnt(6)
    v_mfma_f32_16x16x32_bf16 v[160:163], a[12:15], v[56:59], v[160:163]
    ds_read_b128 v[88:91], v31 offset:3072
    ds_read_b128 v[92:95], v31 offset:19456
    v_mfma_f32_16x16x32_bf16 v[164:167], a[76:79], v[56:59], v[164:167]
    v_mfma_f32_16x16x32_bf16 v[168:171], a[12:15], v[60:63], v[168:171]
    v_mfma_f32_16x16x32_bf16 v[172:175], a[76:79], v[60:63], v[172:175]
    s_waitcnt lgkmcnt(6)
    v_mfma_f32_16x16x32_bf16 v[160:163], a[16:19], v[64:67], v[160:163]
    ds_read_b128 v[96:99], v30 offset:4096
    ds_read_b128 v[100:103], v30 offset:20480
    v_mfma_f32_16x16x32_bf16 v[164:167], a[80:83], v[64:67], v[164:167]
    v_mfma_f32_16x16x32_bf16 v[168:171], a[16:19], v[68:71], v[168:171]
    v_mfma_f32_16x16x32_bf16 v[172:175], a[80:83], v[68:71], v[172:175]
    s_waitcnt lgkmcnt(6)
    v_mfma_f32_16x16x32_bf16 v[160:163], a[20:23], v[72:75], v[160:163]
    ds_read_b128 v[104:107], v31 offset:4096
    ds_read_b128 v[108:111], v31 offset:20480
    v_mfma_f32_16x16x32_bf16 v[164:167], a[84:87], v[72:75], v[164:167]
    v_mfma_f32_16x16x32_bf16 v[168:171], a[20:23], v[76:79], v[168:171]
    v_mfma_f32_16x16x32_bf16 v[172:175], a[84:87], v[76:79], v[172:175]
    s_waitcnt lgkmcnt(6)
    v_mfma_f32_16x16x32_bf16 v[160:163], a[24:27], v[80:83], v[160:163]
    ds_read_b128 v[112:115], v30 offset:5120
    ds_read_b128 v[116:119], v30 offset:21504
    v_mfma_f32_16x16x32_bf16 v[164:167], a[88:91], v[80:83], v[164:167]
    v_mfma_f32_16x16x32_bf16 v[168:171], a[24:27], v[84:87], v[168:171]
    v_mfma_f32_16x16x32_bf16 v[172:175], a[88:91], v[84:87], v[172:175]
    s_waitcnt lgkmcnt(6)
    v_mfma_f32_16x16x32_bf16 v[160:163], a[28:31], v[88:91], v[160:163]
    ds_read_b128 v[120:123], v31 offset:5120
    ds_read_b128 v[124:127], v31 offset:21504
    v_mfma_f32_16x16x32_bf16 v[164:167], a[92:95], v[88:91], v[164:167]
    v_mfma_f32_16x16x32_bf16 v[168:171], a[28:31], v[92:95], v[168:171]
    v_mfma_f32_16x16x32_bf16 v[172:175], a[92:95], v[92:95], v[172:175]
    s_waitcnt lgkmcnt(6)
    v_mfma_f32_16x16x32_bf16 v[160:163], a[32:35], v[96:99], v[160:163]
    ds_read_b128 v[128:131], v30 offset:6144
    ds_read_b128 v[132:135], v30 offset:22528
    v_mfma_f32_16x16x32_bf16 v[164:167], a[96:99], v[96:99], v[164:167]
    v_mfma_f32_16x16x32_bf16 v[168:171], a[32:35], v[100:103], v[168:171]
    v_mfma_f32_16x16x32_bf16 v[172:175], a[96:99], v[100:103], v[172:175]
    s_waitcnt lgkmcnt(6)
    v_mfma_f32_16x16x32_bf16 v[160:163], a[36:39], v[104:107], v[160:163]
    ds_read_b128 v[136:139], v31 offset:6144
    ds_read_b128 v[140:143], v31 offset:22528
    v_mfma_f32_16x16x32_bf16 v[164:167], a[100:103], v[104:107], v[164:167]
    v_mfma_f32_16x16x32_bf16 v[168:171], a[36:39], v[108:111], v[168:171]
    v_mfma_f32_16x16x32_bf16 v[172:175], a[100:103], v[108:111], v[172:175]
    s_waitcnt lgkmcnt(6)
    v_mfma_f32_16x16x32_bf16 v[160:163], a[40:43], v[112:115], v[160:163]
    ds_read_b128 v[144:147], v30 offset:7168
    ds_read_b128 v[148:151], v30 offset:23552
    v_mfma_f32_16x16x32_bf16 v[164:167], a[104:107], v[112:115], v[164:167]
    v_mfma_f32_16x16x32_bf16 v[168:171], a[40:43], v[116:119], v[168:171]
    v_mfma_f32_16x16x32_bf16 v[172:175], a[104:107], v[116:119], v[172:175]
    s_waitcnt lgkmcnt(6)
    v_mfma_f32_16x16x32_bf16 v[160:163], a[44:47], v[120:123], v[160:163]
    ds_read_b128 v[152:155], v31 offset:7168
    ds_read_b128 v[156:159], v31 offset:23552
    v_mfma_f32_16x16x32_bf16 v[164:167], a[108:111], v[120:123], v[164:167]
    v_mfma_f32_16x16x32_bf16 v[168:171], a[44:47], v[124:127], v[168:171]
    v_mfma_f32_16x16x32_bf16 v[172:175], a[108:111], v[124:127], v[172:175]
    s_waitcnt lgkmcnt(6)
    v_mfma_f32_16x16x32_bf16 v[160:163], a[48:51], v[128:131], v[160:163]
    v_mfma_f32_16x16x32_bf16 v[164:167], a[112:115], v[128:131], v[164:167]
    v_mfma_f32_16x16x32_bf16 v[168:171], a[48:51], v[132:135], v[168:171]
    v_mfma_f32_16x16x32_bf16 v[172:175], a[112:115], v[132:135], v[172:175]
    s_waitcnt lgkmcnt(4)
    v_mfma_f32_16x16x32_bf16 v[160:163], a[52:55], v[136:139], v[160:163]
    v_mfma_f32_16x16x32_bf16 v[164:167], a[116:119], v[136:139], v[164:167]
    v_mfma_f32_16x16x32_bf16 v[168:171], a[52:55], v[140:143], v[168:171]
    v_mfma_f32_16x16x32_bf16 v[172:175], a[116:119], v[140:143], v[172:175]
    s_waitcnt lgkmcnt(2)
    v_mfma_f32_16x16x32_bf16 v[160:163], a[56:59], v[144:147], v[160:163]
    v_mfma_f32_16x16x32_bf16 v[164:167], a[120:123], v[144:147], v[164:167]
    v_mfma_f32_16x16x32_bf16 v[168:171], a[56:59], v[148:151], v[168:171]
    v_mfma_f32_16x16x32_bf16 v[172:175], a[120:123], v[148:151], v[172:175]
    s_waitcnt lgkmcnt(0)
    v_mfma_f32_16x16x32_bf16 v[160:163], a[60:63], v[152:155], v[160:163]
    v_mfma_f32_16x16x32_bf16 v[164:167], a[124:127], v[152:155], v[164:167]
    v_mfma_f32_16x16x32_bf16 v[168:171], a[60:63], v[156:159], v[168:171]
    v_mfma_f32_16x16x32_bf16 v[172:175], a[124:127], v[156:159], v[172:175]
    v_mov_b32 v4, s21
    s_mov_b64 exec, 0x1
    buffer_store_dword v4, v8, s[4:7], s26 offen sc1
    s_mov_b64 exec, -1
    v_mul_f32 v176, s25, v160
    v_mul_f32 v177, s25, v161
    v_mul_f32 v178, s25, v162
    v_mul_f32 v179, s25, v163
    v_mul_f32 v180, s25, v168
    v_mul_f32 v181, s25, v169
    v_mul_f32 v182, s25, v170
    v_mul_f32 v183, s25, v171
    v_exp_f32 v176, v176
    v_exp_f32 v177, v177
    v_exp_f32 v178, v178
    v_exp_f32 v179, v179
    v_exp_f32 v180, v180
    v_exp_f32 v181, v181
    v_exp_f32 v182, v182
    v_exp_f32 v183, v183
    v_add_f32 v176, 1.0, v176
    v_add_f32 v177, 1.0, v177
    v_add_f32 v178, 1.0, v178
    v_add_f32 v179, 1.0, v179
    v_add_f32 v180, 1.0, v180
    v_add_f32 v181, 1.0, v181
    v_add_f32 v182, 1.0, v182
    v_add_f32 v183, 1.0, v183
    v_rcp_f32 v176, v176
    v_rcp_f32 v177, v177
    v_rcp_f32 v178, v178
    v_rcp_f32 v179, v179
    v_rcp_f32 v180, v180
    v_rcp_f32 v181, v181
    v_rcp_f32 v182, v182
    v_rcp_f32 v183, v183
    v_mul_f32 v176, v176, v160
    v_mul_f32 v177, v177, v161
    v_mul_f32 v178, v178, v162
    v_mul_f32 v179, v179, v163
    v_mul_f32 v180, v180, v168
    v_mul_f32 v181, v181, v169
    v_mul_f32 v182, v182, v170
    v_mul_f32 v183, v183, v171
    v_mul_f32 v176, v176, v164
    v_mul_f32 v177, v177, v165
    v_mul_f32 v178, v178, v166
    v_mul_f32 v179, v179, v167
    v_mul_f32 v180, v180, v172
    v_mul_f32 v181, v181, v173
    v_mul_f32 v182, v182, v174
    v_mul_f32 v183, v183, v175
    v_cvt_pk_bf16_f32 v128, v176, v177
    v_cvt_pk_bf16_f32 v129, v178, v179
    v_cvt_pk_bf16_f32 v130, v180, v181
    v_cvt_pk_bf16_f32 v131, v182, v183
    ds_write_b64 v12, v[128:129] offset:32768
    ds_write_b64 v12, v[130:131] offset:34816
    s_waitcnt lgkmcnt(0)
    s_barrier
    ds_read_b128 v[32:35], v2 offset:32768
    ds_read_b128 v[36:39], v2 offset:33792
    ds_read_b128 v[40:43], v2 offset:34816
    ds_read_b128 v[44:47], v2 offset:35840
    s_waitcnt lgkmcnt(3)
    v_mfma_f32_16x16x32_bf16 v[64:67], v[32:35], a[128:131], 0
    v_mfma_f32_16x16x32_bf16 v[68:71], v[32:35], a[132:135], 0
    v_mfma_f32_16x16x32_bf16 v[72:75], v[32:35], a[136:139], 0
    v_mfma_f32_16x16x32_bf16 v[76:79], v[32:35], a[140:143], 0
    v_mfma_f32_16x16x32_bf16 v[80:83], v[32:35], a[144:147], 0
    v_mfma_f32_16x16x32_bf16 v[84:87], v[32:35], a[148:151], 0
    v_mfma_f32_16x16x32_bf16 v[88:91], v[32:35], a[152:155], 0
    v_mfma_f32_16x16x32_bf16 v[92:95], v[32:35], a[156:159], 0
    s_waitcnt lgkmcnt(2)
    v_mfma_f32_16x16x32_bf16 v[64:67], v[36:39], a[160:163], v[64:67]
    v_mfma_f32_16x16x32_bf16 v[68:71], v[36:39], a[164:167], v[68:71]
    v_mfma_f32_16x16x32_bf16 v[72:75], v[36:39], a[168:171], v[72:75]
    v_mfma_f32_16x16x32_bf16 v[76:79], v[36:39], a[172:175], v[76:79]
    v_mfma_f32_16x16x32_bf16 v[80:83], v[36:39], a[176:179], v[80:83]
    v_mfma_f32_16x16x32_bf16 v[84:87], v[36:39], a[180:183], v[84:87]
    v_mfma_f32_16x16x32_bf16 v[88:91], v[36:39], a[184:187], v[88:91]
    v_mfma_f32_16x16x32_bf16 v[92:95], v[36:39], a[188:191], v[92:95]
    s_waitcnt lgkmcnt(1)
    v_mfma_f32_16x16x32_bf16 v[96:99], v[40:43], a[128:131], 0
    v_mfma_f32_16x16x32_bf16 v[100:103], v[40:43], a[132:135], 0
    buffer_load_dword v13, v11, s[4:7], s20 offen sc1
    v_mfma_f32_16x16x32_bf16 v[104:107], v[40:43], a[136:139], 0
    v_cvt_pk_bf16_f32 v128, v64, v68
    v_cvt_pk_bf16_f32 v129, v72, v76
    v_mfma_f32_16x16x32_bf16 v[108:111], v[40:43], a[140:143], 0
    v_cvt_pk_bf16_f32 v130, v80, v84
    v_cvt_pk_bf16_f32 v131, v88, v92
    v_mfma_f32_16x16x32_bf16 v[112:115], v[40:43], a[144:147], 0
    buffer_store_dwordx4 v[128:131], v10, s[4:7], s23 offen offset:0 sc1
    v_mfma_f32_16x16x32_bf16 v[116:119], v[40:43], a[148:151], 0
    v_cvt_pk_bf16_f32 v132, v65, v69
    v_cvt_pk_bf16_f32 v133, v73, v77
    v_mfma_f32_16x16x32_bf16 v[120:123], v[40:43], a[152:155], 0
    v_cvt_pk_bf16_f32 v134, v81, v85
    v_cvt_pk_bf16_f32 v135, v89, v93
    v_mfma_f32_16x16x32_bf16 v[124:127], v[40:43], a[156:159], 0
    buffer_store_dwordx4 v[132:135], v10, s[4:7], s23 offen offset:1024 sc1
    s_waitcnt lgkmcnt(0)
    v_mfma_f32_16x16x32_bf16 v[96:99], v[44:47], a[160:163], v[96:99]
    v_cvt_pk_bf16_f32 v136, v66, v70
    v_cvt_pk_bf16_f32 v137, v74, v78
    v_mfma_f32_16x16x32_bf16 v[100:103], v[44:47], a[164:167], v[100:103]
    v_cvt_pk_bf16_f32 v138, v82, v86
    v_cvt_pk_bf16_f32 v139, v90, v94
    v_mfma_f32_16x16x32_bf16 v[104:107], v[44:47], a[168:171], v[104:107]
    buffer_store_dwordx4 v[136:139], v10, s[4:7], s23 offen offset:2048 sc1
    v_mfma_f32_16x16x32_bf16 v[108:111], v[44:47], a[172:175], v[108:111]
    v_cvt_pk_bf16_f32 v140, v67, v71
    v_cvt_pk_bf16_f32 v141, v75, v79
    v_mfma_f32_16x16x32_bf16 v[112:115], v[44:47], a[176:179], v[112:115]
    v_cvt_pk_bf16_f32 v142, v83, v87
    v_cvt_pk_bf16_f32 v143, v91, v95
    v_mfma_f32_16x16x32_bf16 v[116:119], v[44:47], a[180:183], v[116:119]
    buffer_store_dwordx4 v[140:143], v10, s[4:7], s23 offen offset:3072 sc1
    v_mfma_f32_16x16x32_bf16 v[120:123], v[44:47], a[184:187], v[120:123]
    v_mfma_f32_16x16x32_bf16 v[124:127], v[44:47], a[188:191], v[124:127]
    v_cvt_pk_bf16_f32 v144, v96, v100
    v_cvt_pk_bf16_f32 v145, v104, v108
    v_cvt_pk_bf16_f32 v146, v112, v116
    s_nop 4
    v_cvt_pk_bf16_f32 v147, v120, v124
    buffer_store_dwordx4 v[144:147], v10, s[4:7], s24 offen offset:0 sc1
    v_cvt_pk_bf16_f32 v148, v97, v101
    v_cvt_pk_bf16_f32 v149, v105, v109
    v_cvt_pk_bf16_f32 v150, v113, v117
    v_cvt_pk_bf16_f32 v151, v121, v125
    buffer_store_dwordx4 v[148:151], v10, s[4:7], s24 offen offset:1024 sc1
    v_cvt_pk_bf16_f32 v152, v98, v102
    v_cvt_pk_bf16_f32 v153, v106, v110
    v_cvt_pk_bf16_f32 v154, v114, v118
    v_cvt_pk_bf16_f32 v155, v122, v126
    buffer_store_dwordx4 v[152:155], v10, s[4:7], s24 offen offset:2048 sc1
    v_cvt_pk_bf16_f32 v156, v99, v103
    v_cvt_pk_bf16_f32 v157, v107, v111
    v_cvt_pk_bf16_f32 v158, v115, v119
    v_cvt_pk_bf16_f32 v159, v123, v127
    buffer_store_dwordx4 v[156:159], v10, s[4:7], s24 offen offset:3072 sc1
    s_add_u32 s23, s23, 1441792
    s_add_u32 s64, s21, 2
    s_cmp_lt_u32 s12, 56
    s_cselect_b32 s16, s22, 0x80000000
    s_cmp_eq_u32 s13, 0
    s_cselect_b32 s16, s16, 0x80000000
    s_waitcnt vmcnt(8)
    v_cmp_gt_u32 vcc, s64, v13
    s_cbranch_vccz L_ffn_q
    s_cmp_lt_u32 s12, 56
    s_cbranch_scc0 L_ffn_e
    s_waitcnt vmcnt(0)
    s_barrier
    s_cmp_eq_u32 s13, 0
    s_cbranch_scc0 L_pf_53
    v_mov_b32 v4, s21
    s_mov_b64 exec, 0x1
    buffer_store_dword v4, v8, s[4:7], s22 offen sc1
    s_mov_b64 exec, -1
L_pf_53:
L_ffn_e:
    s_add_u32 s12, s12, 2
    s_cmp_lt_u32 s12, 64
    s_cbranch_scc1 L_ffn
    s_branch L_done
L_ffn_r:
    s_add_u32 s42, s42, 1
    s_cmp_lt_u32 s42, 2097152
    s_cbranch_scc1 L_ffn_g
    s_branch L_fail
L_ffn_q:
    buffer_load_dwordx4 v[192:195], v6, s[4:7], s18 offen offset:0 sc1
    buffer_load_dwordx4 v[196:199], v6, s[4:7], s18 offen offset:128 sc1
    buffer_load_dwordx4 v[200:203], v6, s[4:7], s18 offen offset:256 sc1
    buffer_load_dwordx4 v[204:207], v6, s[4:7], s18 offen offset:384 sc1
    buffer_load_dwordx4 v[208:211], v6, s[4:7], s18 offen offset:512 sc1
    buffer_load_dwordx4 v[212:215], v6, s[4:7], s18 offen offset:640 sc1
    buffer_load_dwordx4 v[216:219], v6, s[4:7], s18 offen offset:768 sc1
    buffer_load_dwordx4 v[220:223], v6, s[4:7], s18 offen offset:896 sc1
    s_cmp_lt_u32 s12, 56
    s_cbranch_scc0 L_ffn_q2
    s_waitcnt vmcnt(8)
    s_barrier
L_ffn_q2:
    v_mov_b32 v4, s21
    s_mov_b64 exec, 0x1
    buffer_store_dword v4, v8, s[4:7], s16 offen sc1
    s_mov_b64 exec, -1
    s_add_u32 s12, s12, 2
    s_mov_b32 s21, s64
    s_add_u32 s24, s23, 16384
    s_cmp_lt_u32 s12, 56
    s_cselect_b32 s26, 0x80000000, s22
    s_cmp_eq_u32 s13, 0
    s_cselect_b32 s26, s26, 0x80000000
    s_mov_b32 s42, 0
    s_waitcnt vmcnt(8)
    ds_write_b128 v14, v[192:195] offset:0
    s_waitcnt vmcnt(7)
    ds_write_b128 v14, v[196:199] offset:1024
    s_waitcnt vmcnt(6)
    ds_write_b128 v14, v[200:203] offset:2048
    v_max3_u32 v176, v192, v196, v200
    s_waitcnt vmcnt(5)
    ds_write_b128 v14, v[204:207] offset:3072
    s_waitcnt vmcnt(4)
    ds_write_b128 v14, v[208:211] offset:4096
    s_waitcnt vmcnt(3)
    ds_write_b128 v14, v[212:215] offset:5120
    v_max3_u32 v177, v204, v208, v212
    s_waitcnt vmcnt(2)
    ds_write_b128 v14, v[216:219] offset:6144
    s_waitcnt vmcnt(1)
    ds_write_b128 v14, v[220:223] offset:7168
    v_max3_u32 v176, v216, v220, v176
    v_max_u32 v176, v176, v177
    v_cmp_eq_u32 vcc, -1, v176
    s_branch L_ffn_h
L_fail:
    s_mov_b64 exec, -1
    v_mov_b32 v4, 0
    v_mov_b32 v5, 1
    s_mov_b64 exec, 1
    global_atomic_add v4, v5, s[92:93] offset:32
L_done:
    s_waitcnt vmcnt(0)
L_end:
    s_endpgm
L_codeend:
.section .rodata,"a"
.p2align 6
.amdhsa_kernel adaLN_cond__memory_aug_recurrent_mem_tr__glu_gated_swiglu__prompt_kernel
  .amdhsa_next_free_vgpr 512
  .amdhsa_next_free_sgpr 102
  .amdhsa_accum_offset 256
  .amdhsa_group_segment_fixed_size 0
  .amdhsa_kernarg_size 128
  .amdhsa_user_sgpr_count 2
  .amdhsa_user_sgpr_kernarg_segment_ptr 1
  .amdhsa_system_sgpr_workgroup_id_x 1
.end_amdhsa_kernel
```
